```python
import torch

def _softmax(x, axis=-1):
    return torch.softmax(x, dim=axis)
def _gelu(x):
    return torch.nn.functional.gelu(x, approximate="tanh")
def _silu(x):
    return torch.nn.functional.silu(x)
def _sigmoid(x):
    return torch.sigmoid(x)
def _layernorm(x, axis=-1, eps=1e-5):
    m = x.mean(dim=axis, keepdim=True)
    v = x.var(dim=axis, keepdim=True, unbiased=False)
    return (x - m) / torch.sqrt(v + eps)
def _scatter_add(tgt, idx, src, axis=0):
    return tgt.clone().index_add_(axis, idx, src)
def _segment_sum(src, seg, n):
    out = torch.zeros((n,) + src.shape[1:], dtype=src.dtype)
    return out.index_add_(0, seg, src)
def _pad(x, pw):
    flat = tuple(v for pair in reversed(pw) for v in pair)
    return torch.nn.functional.pad(x, flat)

kernel_name = 'interleave_layers__ssm_conv_h3__geglu_ffn__prompt'

def setup_inputs():

    _w = (lambda a: (lambda t: t.to(torch.bfloat16) if t.is_floating_point() else t)(torch.as_tensor(a)))
    def _A_setup():
        B, S, D = 1, 2048, 640
        ks = 4
        return {
            "q": _w((lambda *s: torch.randn(*s, dtype=torch.bfloat16) * 0.05)(B, S, D)),
            "k": _w((lambda *s: torch.randn(*s, dtype=torch.bfloat16) * 1.6)(B, S, D)),
            "v": _w((lambda *s: torch.randn(*s, dtype=torch.bfloat16) * 1.6)(B, S, D)),
            "shift_k": _w((lambda *s: torch.randn(*s, dtype=torch.bfloat16) * 1.6)(D, ks) * 0.5),
            "ssm_k": _w((lambda *s: torch.randn(*s, dtype=torch.bfloat16) * 1.6)(D, S) * (1.0 / S ** 0.5)),
            "ssm_D": _w((lambda *s: torch.randn(*s, dtype=torch.bfloat16) * 1.6)(D)),
        }
    _A_in = _A_setup()

    def _B_setup():
        B, S, D, F = 1, 2048, 640, 1728
        return {
            "x": _w((lambda *s: torch.randn(*s, dtype=torch.bfloat16) * 0.05)(B, S, D)),
            "w_gate": _w((lambda *s: torch.randn(*s, dtype=torch.bfloat16) * 0.2)(D, F)),
            "w_up": _w((lambda *s: torch.randn(*s, dtype=torch.bfloat16) * 0.2)(D, F)),
            "w_down": _w((lambda *s: torch.randn(*s, dtype=torch.bfloat16) * 0.2)(F, D)),
        }
    _B_in = _B_setup()

    return {
        "A_q": _A_in["q"],
        "A_k": _A_in["k"],
        "A_v": _A_in["v"],
        "A_shift_k": _A_in["shift_k"],
        "A_ssm_k": _A_in["ssm_k"],
        "A_ssm_D": _A_in["ssm_D"],
        "B_x": _B_in["x"],
        "B_w_gate": _B_in["w_gate"],
        "B_w_up": _B_in["w_up"],
        "B_w_down": _B_in["w_down"],
    }

def reference(A_q, A_k, A_v, A_shift_k, A_ssm_k, A_ssm_D, B_x, B_w_gate, B_w_up, B_w_down):
    def _A_ref(q, k, v, shift_k, ssm_k, ssm_D):
        B, S, D = q.shape
        ks = shift_k.shape[-1]
        k_pad = _pad(k, ((0, 0), (ks - 1, 0), (0, 0)))
        k_shift = torch.zeros_like(k)
        for t in range(ks):
            k_shift = k_shift + k_pad[:, t:t + S, :] * shift_k[:, ks - 1 - t][None, None, :]
        kv = k_shift * v
        L = 2 * S
        kv_pad = _pad(kv, ((0, 0), (0, S), (0, 0)))
        kf_pad = _pad(ssm_k, ((0, 0), (0, S)))
        kv_f = (lambda x, axes=(-2,-1): torch.fft.rfft2(x.float(), dim=axes))(kv_pad[:, None, :, :], axes=(1, 2))
        kf_f = (lambda x, axes=(-2,-1): torch.fft.rfft2(x.float(), dim=axes))(kf_pad[:, None, :], axes=(1, 2))
        kf_f = (lambda x, *d: x.permute(*d))(kf_f, 1, 2, 0)
        y_f = kv_f * kf_f[None, :, :, :]
        y = (lambda x, s, axes=(-2,-1): torch.fft.irfft2(x, s=s, dim=axes).to(torch.bfloat16))(y_f, (1, L), axes=(1, 2))[:, 0, :S, :]
        y = y + kv * ssm_D[None, None, :]
        return q * y

    def _B_ref(x, w_gate, w_up, w_down):
        return (_gelu(x @ w_gate) * (x @ w_up)) @ w_down

    x = A_q
    x = x + _A_ref(_layernorm(x, axis=-1), A_k, A_v, A_shift_k, A_ssm_k, A_ssm_D)
    x = x + _B_ref(_layernorm(x, axis=-1), B_w_gate, B_w_up, B_w_down)
    x = x + _A_ref(_layernorm(x, axis=-1), A_k, A_v, A_shift_k, A_ssm_k, A_ssm_D)
    x = x + _B_ref(_layernorm(x, axis=-1), B_w_gate, B_w_up, B_w_down)
    return x
```

```asm
; @launch grid=(256,1,1) block=(256,1,1) lds=163840
.amdgcn_target "amdgcn-amd-amdhsa--gfx950"
.text
.globl interleave_layers__ssm_conv_h3__geglu_ffn__prompt_kernel
.p2align 8
.type interleave_layers__ssm_conv_h3__geglu_ffn__prompt_kernel,@function
interleave_layers__ssm_conv_h3__geglu_ffn__prompt_kernel:
  s_cmp_ge_u32 s2, 256
  s_cbranch_scc1 L_end
  s_load_dwordx16 s[4:19], s[0:1], 0
  s_load_dwordx8 s[20:27], s[0:1], 64
  s_load_dwordx2 s[28:29], s[0:1], 96
  v_lshrrev_b32 v8, 6, v0
  v_and_b32 v1, 63, v0
  s_and_b32 s30, s2, 7
  s_lshr_b32 s31, s2, 3
  v_readfirstlane_b32 s32, v8
  s_lshr_b32 s90, s30, 2
  s_lshl_b32 s90, s90, 2
  s_lshr_b32 s80, s31, 3
  s_add_u32 s90, s90, s80
  s_and_b32 s91, s30, 3
  s_lshl_b32 s91, s91, 3
  s_and_b32 s80, s31, 7
  s_add_u32 s91, s91, s80
  s_mul_i32 s95, s91, 7
  s_mul_i32 s80, s91, 6
  s_add_u32 s80, s80, 24
  s_min_u32 s95, s95, s80
  s_lshr_b32 s100, s31, 3
  s_and_b32 s101, s31, 7
  s_mov_b32 s60, 0
  s_mov_b32 s61, 8192
  s_mov_b32 s62, 16384
  s_mov_b32 s63, 24576
  s_mov_b32 s64, 32768
  s_mov_b32 s65, 40960
  s_mov_b32 s66, 49152
  s_mov_b32 s67, 57344
  s_mov_b32 s68, 65536
  s_mov_b32 s69, 73728
  s_mov_b32 s70, 81920
  s_mov_b32 s71, 90112
  s_mov_b32 s72, 98304
  s_mov_b32 s73, 106496
  s_mov_b32 s74, 114688
  s_mov_b32 s75, 122880
  s_mov_b32 s76, 131072
  s_mov_b32 s77, 139264
  s_mov_b32 s78, 147456
  s_mov_b32 s79, 155648
  s_movk_i32 s35, 5120
  s_waitcnt lgkmcnt(0)
  s_mov_b32 s36, s28
  s_mov_b32 s37, s29
  s_mov_b32 s38, 0x10000000
  s_mov_b32 s39, 0x00020000
  s_mov_b32 s96, s26
  s_mov_b32 s97, s27
  s_mov_b32 s98, 0x100
  s_mov_b32 s99, 0x00020000
  v_mov_b32 v164, 0
  v_mov_b32 v165, 0
  v_mov_b32 v166, 0
  v_mov_b32 v167, 0
  s_lshl_b32 s80, s90, 12
  s_lshr_b32 s81, s32, 1
  s_lshl_b32 s82, s81, 10
  s_add_u32 s80, s80, s82
  s_lshl_b32 s82, s91, 5
  s_add_u32 s80, s80, s82
  s_and_b32 s83, s32, 1
  s_lshl_b32 s82, s83, 4
  s_add_u32 s80, s80, s82
  s_add_u32 s80, s80, 0x2a00000
  v_lshl_add_u32 v8, v1, 11, s80
  s_lshl_b32 s80, s30, 14
  s_lshl_b32 s82, s81, 13
  s_add_u32 s80, s80, s82
  s_lshl_b32 s82, s31, 8
  s_add_u32 s80, s80, s82
  s_lshl_b32 s82, s83, 7
  s_add_u32 s80, s80, s82
  s_add_u32 s80, s80, 0x2a7ff80
  v_lshl_add_u32 v9, v1, 4, s80
  v_cmp_gt_u32 vcc, 2, v1
  s_nop 1
  v_cndmask_b32 v9, v9, v8, vcc
  v_subrev_u32 v168, 2, v1
  v_cmp_gt_u32 vcc, 6, v168
  v_mov_b32 v8, 0x80000000
  s_nop 0
  v_cndmask_b32 v9, v9, v8, vcc
  v_cmp_lt_u32 vcc, 15, v1
  s_nop 1
  v_cndmask_b32 v9, v9, v8, vcc
  buffer_store_dwordx4 v[164:167], v9, s[36:39], 0 offen sc1
  s_cmp_ge_u32 s2, 160
  s_cbranch_scc1 L_prep
  s_mov_b32 s40, s6
  s_mov_b32 s41, s7
  s_mov_b32 s42, 0x280000
  s_mov_b32 s43, 0x00020000
  s_mov_b32 s44, s8
  s_mov_b32 s45, s9
  s_mov_b32 s46, 0x280000
  s_mov_b32 s47, 0x00020000
  s_mov_b32 s48, s10
  s_mov_b32 s49, s11
  s_mov_b32 s50, 0x1400
  s_mov_b32 s51, 0x00020000
  s_lshr_b32 s83, s2, 5
  s_and_b32 s81, s2, 31
  s_lshl_b32 s83, s83, 8
  s_and_b32 s85, s32, 1
  s_lshl_b32 s82, s85, 7
  s_add_u32 s80, s83, s82
  s_lshr_b32 s86, s32, 1
  s_lshl_b32 s82, s81, 1
  s_add_u32 s82, s82, s86
  s_mul_i32 s82, s82, 40960
  s_add_u32 s82, s82, s80
  v_lshrrev_b32 v8, 4, v1
  v_and_b32 v9, 15, v1
  v_mul_u32_u24 v2, 10240, v8
  v_lshl_add_u32 v2, v9, 3, v2
  v_add_u32 v2, s82, v2
  v_subrev_u32 v3, 3840, v2
  s_lshl_b32 s82, s80, 2
  v_lshl_add_u32 v4, v9, 5, s82
  buffer_load_dwordx4 v[48:51], v4, s[48:51], 0 offen
  buffer_load_dwordx4 v[52:55], v4, s[48:51], 0 offen offset:16
  buffer_load_dwordx2 v[10:11], v3, s[40:43], 0 offen offset:0 nt
  buffer_load_dwordx2 v[12:13], v3, s[40:43], 0 offen offset:1280 nt
  buffer_load_dwordx2 v[14:15], v3, s[40:43], 0 offen offset:2560 nt
  buffer_load_dwordx2 v[16:17], v2, s[40:43], 0 offen offset:0 nt
  buffer_load_dwordx2 v[32:33], v2, s[44:47], 0 offen offset:0 nt
  buffer_load_dwordx2 v[18:19], v2, s[40:43], 0 offen offset:1280 nt
  buffer_load_dwordx2 v[34:35], v2, s[44:47], 0 offen offset:1280 nt
  buffer_load_dwordx2 v[20:21], v2, s[40:43], 0 offen offset:2560 nt
  buffer_load_dwordx2 v[36:37], v2, s[44:47], 0 offen offset:2560 nt
  buffer_load_dwordx2 v[22:23], v2, s[40:43], 0 offen offset:3840 nt
  buffer_load_dwordx2 v[38:39], v2, s[44:47], 0 offen offset:3840 nt
  buffer_load_dwordx2 v[24:25], v2, s[40:43], s35 offen offset:0 nt
  buffer_load_dwordx2 v[40:41], v2, s[44:47], s35 offen offset:0 nt
  buffer_load_dwordx2 v[26:27], v2, s[40:43], s35 offen offset:1280 nt
  buffer_load_dwordx2 v[42:43], v2, s[44:47], s35 offen offset:1280 nt
  buffer_load_dwordx2 v[28:29], v2, s[40:43], s35 offen offset:2560 nt
  buffer_load_dwordx2 v[44:45], v2, s[44:47], s35 offen offset:2560 nt
  buffer_load_dwordx2 v[30:31], v2, s[40:43], s35 offen offset:3840 nt
  buffer_load_dwordx2 v[46:47], v2, s[44:47], s35 offen offset:3840 nt
  s_lshl_b32 s86, s86, 2
  v_add_u32 v8, s86, v8
  v_and_b32 v7, 7, v1
  v_xor_b32 v5, v8, v7
  v_xor_b32 v5, 7, v5
  v_lshlrev_b32 v5, 4, v5
  v_lshl_add_u32 v5, v7, 7, v5
  v_bfe_u32 v8, v1, 3, 1
  v_mul_u32_u24 v8, 12480, v8
  s_mul_i32 s85, s85, 24960
  s_add_u32 s85, s85, 75008
  v_add3_u32 v5, v5, v8, s85
  v_lshrrev_b32 v8, 3, v1
  v_and_b32 v9, 7, v1
  s_lshl_b32 s80, s32, 6
  s_add_u32 s80, s80, s83
  s_lshl_b32 s80, s80, 11
  s_lshl_b32 s81, s81, 7
  s_sub_u32 s80, s80, s81
  s_add_u32 s80, s80, 0x100f80
  v_lshlrev_b32 v6, 14, v8
  v_lshl_add_u32 v6, v9, 4, v6
  v_add_u32 v6, s80, v6
  s_mul_i32 s80, s32, 12480
  s_add_u32 s80, s80, 75008
  v_xor_b32 v7, v8, v9
  v_lshlrev_b32 v7, 4, v7
  v_lshl_add_u32 v7, v8, 7, v7
  v_add_u32 v7, s80, v7
  s_lshl_b32 s84, s2, 2
  s_add_u32 s84, s84, s32
  s_mul_i32 s80, s32, 16640
  s_add_u32 s80, s80, 8448
  v_and_b32 v130, 3, v1
  v_bfe_u32 v131, v1, 2, 2
  v_lshrrev_b32 v132, 4, v1
  v_add_u32 v133, v131, v132
  v_mul_u32_u24 v94, 260, v130
  v_add_u32 v94, v94, v133
  v_lshl_add_u32 v94, v94, 4, s80
  v_and_b32 v130, 15, v1
  v_subrev_u32 v131, 4, v130
  v_cmp_gt_u32 vcc, 8, v131
  v_and_b32 v133, 7, v130
  s_nop 0
  v_cndmask_b32 v131, v133, v131, vcc
  v_cndmask_b32 v133, 0, 1, vcc
  s_mul_i32 s81, s32, 12480
  s_add_u32 s81, s81, 76128
  v_mul_u32_u24 v134, 10, v131
  v_sub_u32 v134, v132, v134
  v_lshlrev_b32 v134, 4, v134
  v_add_u32 v134, s81, v134
  v_mov_b32 v135, 6240
  v_cndmask_b32 v135, v135, 0, vcc
  v_add_u32 v95, v134, v135
  v_lshrrev_b32 v134, 1, v131
  v_and_b32 v135, 1, v131
  v_lshlrev_b32 v134, 8, v134
  v_lshl_add_u32 v134, v135, 6, v134
  v_lshl_add_u32 v134, v132, 3, v134
  v_lshl_add_u32 v134, v133, 2, v134
  s_mul_i32 s81, s32, 2112
  s_add_u32 s81, s81, 0
  v_add_u32 v96, s81, v134
  v_add_u32 v97, 1024, v96
  v_bfe_u32 v134, v1, 2, 2
  v_mul_u32_u24 v134, 2112, v134
  v_lshl_add_u32 v134, v132, 5, v134
  v_and_b32 v135, 3, v1
  v_lshl_add_u32 v134, v135, 3, v134
  s_lshl_b32 s81, s32, 8
  s_add_u32 s81, s81, 0
  v_add_u32 v98, s81, v134
  v_lshrrev_b32 v134, 3, v1
  v_and_b32 v135, 7, v1
  v_mul_u32_u24 v134, 20480, v134
  v_lshl_add_u32 v134, v135, 4, v134
  s_mul_i32 s81, s32, 163840
  s_lshl_b32 s83, s2, 7
  s_add_u32 s81, s81, s83
  s_add_u32 s81, s81, 0x400000
  v_add_u32 v99, s81, v134
  s_lshl_b32 s81, s32, 10
  s_add_u32 s81, s81, 0x700000
  v_lshl_add_u32 v101, v1, 4, s81
  s_mul_i32 s81, s32, 327680
  s_lshl_b32 s83, s2, 10
  s_add_u32 s81, s81, s83
  s_add_u32 s81, s81, 0x1200000
  v_lshl_add_u32 v100, v1, 4, s81
  v_add_u32 v134, 0, v1
  v_mul_u32_u24 v135, 205, v134
  v_lshrrev_b32 v135, 11, v135
  v_mul_u32_u24 v136, 10, v135
  v_sub_u32 v136, v134, v136
  v_lshl_add_u32 v135, v135, 3, v136
  v_lshlrev_b32 v135, 4, v135
  v_cmp_gt_u32 vcc, 8, v136
  v_mov_b32 v136, 0x80000000
  s_nop 0
  v_cndmask_b32 v112, v136, v135, vcc
  v_add_u32 v113, 8, v112
  v_add_u32 v134, 64, v1
  v_mul_u32_u24 v135, 205, v134
  v_lshrrev_b32 v135, 11, v135
  v_mul_u32_u24 v136, 10, v135
  v_sub_u32 v136, v134, v136
  v_lshl_add_u32 v135, v135, 3, v136
  v_lshlrev_b32 v135, 4, v135
  v_cmp_gt_u32 vcc, 8, v136
  v_mov_b32 v136, 0x80000000
  s_nop 0
  v_cndmask_b32 v114, v136, v135, vcc
  v_add_u32 v115, 8, v114
  v_add_u32 v134, 128, v1
  v_mul_u32_u24 v135, 205, v134
  v_lshrrev_b32 v135, 11, v135
  v_mul_u32_u24 v136, 10, v135
  v_sub_u32 v136, v134, v136
  v_lshl_add_u32 v135, v135, 3, v136
  v_lshlrev_b32 v135, 4, v135
  v_cmp_gt_u32 vcc, 8, v136
  v_mov_b32 v136, 0x80000000
  s_nop 0
  v_cndmask_b32 v116, v136, v135, vcc
  v_add_u32 v117, 8, v116
  v_add_u32 v134, 192, v1
  v_mul_u32_u24 v135, 205, v134
  v_lshrrev_b32 v135, 11, v135
  v_mul_u32_u24 v136, 10, v135
  v_sub_u32 v136, v134, v136
  v_lshl_add_u32 v135, v135, 3, v136
  v_lshlrev_b32 v135, 4, v135
  v_cmp_gt_u32 vcc, 8, v136
  v_mov_b32 v136, 0x80000000
  s_nop 0
  v_cndmask_b32 v118, v136, v135, vcc
  v_add_u32 v119, 8, v118
  v_add_u32 v134, 256, v1
  v_mul_u32_u24 v135, 205, v134
  v_lshrrev_b32 v135, 11, v135
  v_mul_u32_u24 v136, 10, v135
  v_sub_u32 v136, v134, v136
  v_lshl_add_u32 v135, v135, 3, v136
  v_lshlrev_b32 v135, 4, v135
  v_cmp_gt_u32 vcc, 8, v136
  v_mov_b32 v136, 0x80000000
  s_nop 0
  v_cndmask_b32 v120, v136, v135, vcc
  v_add_u32 v121, 8, v120
  v_mov_b32 v111, 0x80000000
  v_lshlrev_b32 v102, 7, v1
  v_cmp_gt_u32 vcc, 16, v1
  s_nop 1
  v_cndmask_b32 v102, v111, v102, vcc
  v_cmp_eq_u32 vcc, 0, v1
  s_nop 1
  v_cndmask_b32 v111, v111, 0, vcc
  s_mul_i32 s80, s95, 20480
  s_lshl_b32 s81, s32, 10
  s_add_u32 s80, s80, s81
  s_add_u32 s80, s80, 0xa00000
  v_lshrrev_b32 v138, 4, v1
  v_lshl_add_u32 v138, v138, 8, s80
  v_bfe_u32 v139, v1, 3, 1
  v_mul_u32_u24 v139, 20480, v139
  v_and_b32 v140, 7, v1
  v_lshl_add_u32 v139, v140, 4, v139
  v_add_u32 v109, v138, v139
  v_bfe_u32 v139, v1, 1, 1
  v_bfe_u32 v140, v1, 2, 2
  v_lshl_add_u32 v139, v139, 2, v140
  v_and_b32 v140, 1, v1
  v_lshl_add_u32 v139, v139, 1, v140
  v_lshl_add_u32 v110, v139, 4, v138
  s_mul_i32 s89, s32, 7168
  s_waitcnt vmcnt(20)
  v_lshlrev_b32 v208, 16, v48
  v_and_b32 v212, 0xffff0000, v48
  v_lshlrev_b32 v216, 16, v49
  v_and_b32 v220, 0xffff0000, v49
  v_lshlrev_b32 v209, 16, v50
  v_and_b32 v213, 0xffff0000, v50
  v_lshlrev_b32 v217, 16, v51
  v_and_b32 v221, 0xffff0000, v51
  s_waitcnt vmcnt(19)
  v_lshlrev_b32 v210, 16, v52
  v_and_b32 v214, 0xffff0000, v52
  v_lshlrev_b32 v218, 16, v53
  v_and_b32 v222, 0xffff0000, v53
  v_lshlrev_b32 v211, 16, v54
  v_and_b32 v215, 0xffff0000, v54
  v_lshlrev_b32 v219, 16, v55
  v_and_b32 v223, 0xffff0000, v55
  s_waitcnt vmcnt(18)
  v_lshlrev_b32 v164, 16, v10
  v_and_b32 v165, 0xffff0000, v10
  v_lshlrev_b32 v166, 16, v11
  v_and_b32 v167, 0xffff0000, v11
  s_waitcnt vmcnt(17)
  v_lshlrev_b32 v168, 16, v12
  v_and_b32 v169, 0xffff0000, v12
  v_lshlrev_b32 v170, 16, v13
  v_and_b32 v171, 0xffff0000, v13
  s_waitcnt vmcnt(16)
  v_lshlrev_b32 v172, 16, v14
  v_and_b32 v173, 0xffff0000, v14
  v_lshlrev_b32 v174, 16, v15
  v_and_b32 v175, 0xffff0000, v15
  s_waitcnt vmcnt(15)
  v_lshlrev_b32 v176, 16, v16
  v_and_b32 v177, 0xffff0000, v16
  v_lshlrev_b32 v178, 16, v17
  v_and_b32 v179, 0xffff0000, v17
  v_pk_mul_f32 v[224:225], v[164:165], v[220:221]
  v_pk_mul_f32 v[226:227], v[166:167], v[222:223]
  v_pk_fma_f32 v[224:225], v[168:169], v[216:217], v[224:225]
  v_pk_fma_f32 v[226:227], v[170:171], v[218:219], v[226:227]
  v_pk_fma_f32 v[224:225], v[172:173], v[212:213], v[224:225]
  v_pk_fma_f32 v[226:227], v[174:175], v[214:215], v[226:227]
  v_pk_fma_f32 v[224:225], v[176:177], v[208:209], v[224:225]
  v_pk_fma_f32 v[226:227], v[178:179], v[210:211], v[226:227]
  s_waitcnt vmcnt(14)
  v_lshlrev_b32 v164, 16, v32
  v_and_b32 v165, 0xffff0000, v32
  v_lshlrev_b32 v166, 16, v33
  v_and_b32 v167, 0xffff0000, v33
  v_pk_mul_f32 v[224:225], v[224:225], v[164:165]
  v_pk_mul_f32 v[226:227], v[226:227], v[166:167]
  s_waitcnt vmcnt(13)
  v_lshlrev_b32 v180, 16, v18
  v_and_b32 v181, 0xffff0000, v18
  v_lshlrev_b32 v182, 16, v19
  v_and_b32 v183, 0xffff0000, v19
  v_pk_mul_f32 v[228:229], v[168:169], v[220:221]
  v_pk_mul_f32 v[230:231], v[170:171], v[222:223]
  v_pk_fma_f32 v[228:229], v[172:173], v[216:217], v[228:229]
  v_pk_fma_f32 v[230:231], v[174:175], v[218:219], v[230:231]
  v_pk_fma_f32 v[228:229], v[176:177], v[212:213], v[228:229]
  v_pk_fma_f32 v[230:231], v[178:179], v[214:215], v[230:231]
  v_pk_fma_f32 v[228:229], v[180:181], v[208:209], v[228:229]
  v_pk_fma_f32 v[230:231], v[182:183], v[210:211], v[230:231]
  s_waitcnt vmcnt(12)
  v_lshlrev_b32 v168, 16, v34
  v_and_b32 v169, 0xffff0000, v34
  v_lshlrev_b32 v170, 16, v35
  v_and_b32 v171, 0xffff0000, v35
  v_pk_mul_f32 v[228:229], v[228:229], v[168:169]
  v_pk_mul_f32 v[230:231], v[230:231], v[170:171]
  s_waitcnt vmcnt(11)
  v_lshlrev_b32 v184, 16, v20
  v_and_b32 v185, 0xffff0000, v20
  v_lshlrev_b32 v186, 16, v21
  v_and_b32 v187, 0xffff0000, v21
  v_pk_mul_f32 v[232:233], v[172:173], v[220:221]
  v_pk_mul_f32 v[234:235], v[174:175], v[222:223]
  v_pk_fma_f32 v[232:233], v[176:177], v[216:217], v[232:233]
  v_pk_fma_f32 v[234:235], v[178:179], v[218:219], v[234:235]
  v_pk_fma_f32 v[232:233], v[180:181], v[212:213], v[232:233]
  v_pk_fma_f32 v[234:235], v[182:183], v[214:215], v[234:235]
  v_pk_fma_f32 v[232:233], v[184:185], v[208:209], v[232:233]
  v_pk_fma_f32 v[234:235], v[186:187], v[210:211], v[234:235]
  s_waitcnt vmcnt(10)
  v_lshlrev_b32 v172, 16, v36
  v_and_b32 v173, 0xffff0000, v36
  v_lshlrev_b32 v174, 16, v37
  v_and_b32 v175, 0xffff0000, v37
  v_pk_mul_f32 v[232:233], v[232:233], v[172:173]
  v_pk_mul_f32 v[234:235], v[234:235], v[174:175]
  s_waitcnt vmcnt(9)
  v_lshlrev_b32 v188, 16, v22
  v_and_b32 v189, 0xffff0000, v22
  v_lshlrev_b32 v190, 16, v23
  v_and_b32 v191, 0xffff0000, v23
  v_pk_mul_f32 v[236:237], v[176:177], v[220:221]
  v_pk_mul_f32 v[238:239], v[178:179], v[222:223]
  v_pk_fma_f32 v[236:237], v[180:181], v[216:217], v[236:237]
  v_pk_fma_f32 v[238:239], v[182:183], v[218:219], v[238:239]
  v_pk_fma_f32 v[236:237], v[184:185], v[212:213], v[236:237]
  v_pk_fma_f32 v[238:239], v[186:187], v[214:215], v[238:239]
  v_pk_fma_f32 v[236:237], v[188:189], v[208:209], v[236:237]
  v_pk_fma_f32 v[238:239], v[190:191], v[210:211], v[238:239]
  s_waitcnt vmcnt(8)
  v_lshlrev_b32 v176, 16, v38
  v_and_b32 v177, 0xffff0000, v38
  v_lshlrev_b32 v178, 16, v39
  v_and_b32 v179, 0xffff0000, v39
  v_pk_mul_f32 v[236:237], v[236:237], v[176:177]
  v_pk_mul_f32 v[238:239], v[238:239], v[178:179]
  s_waitcnt vmcnt(7)
  v_lshlrev_b32 v192, 16, v24
  v_and_b32 v193, 0xffff0000, v24
  v_lshlrev_b32 v194, 16, v25
  v_and_b32 v195, 0xffff0000, v25
  v_pk_mul_f32 v[240:241], v[180:181], v[220:221]
  v_pk_mul_f32 v[242:243], v[182:183], v[222:223]
  v_pk_fma_f32 v[240:241], v[184:185], v[216:217], v[240:241]
  v_pk_fma_f32 v[242:243], v[186:187], v[218:219], v[242:243]
  v_pk_fma_f32 v[240:241], v[188:189], v[212:213], v[240:241]
  v_pk_fma_f32 v[242:243], v[190:191], v[214:215], v[242:243]
  v_pk_fma_f32 v[240:241], v[192:193], v[208:209], v[240:241]
  v_pk_fma_f32 v[242:243], v[194:195], v[210:211], v[242:243]
  s_waitcnt vmcnt(6)
  v_lshlrev_b32 v180, 16, v40
  v_and_b32 v181, 0xffff0000, v40
  v_lshlrev_b32 v182, 16, v41
  v_and_b32 v183, 0xffff0000, v41
  v_pk_mul_f32 v[240:241], v[240:241], v[180:181]
  v_pk_mul_f32 v[242:243], v[242:243], v[182:183]
  s_waitcnt vmcnt(5)
  v_lshlrev_b32 v196, 16, v26
  v_and_b32 v197, 0xffff0000, v26
  v_lshlrev_b32 v198, 16, v27
  v_and_b32 v199, 0xffff0000, v27
  v_pk_mul_f32 v[244:245], v[184:185], v[220:221]
  v_pk_mul_f32 v[246:247], v[186:187], v[222:223]
  v_pk_fma_f32 v[244:245], v[188:189], v[216:217], v[244:245]
  v_pk_fma_f32 v[246:247], v[190:191], v[218:219], v[246:247]
  v_pk_fma_f32 v[244:245], v[192:193], v[212:213], v[244:245]
  v_pk_fma_f32 v[246:247], v[194:195], v[214:215], v[246:247]
  v_pk_fma_f32 v[244:245], v[196:197], v[208:209], v[244:245]
  v_pk_fma_f32 v[246:247], v[198:199], v[210:211], v[246:247]
  s_waitcnt vmcnt(4)
  v_lshlrev_b32 v184, 16, v42
  v_and_b32 v185, 0xffff0000, v42
  v_lshlrev_b32 v186, 16, v43
  v_and_b32 v187, 0xffff0000, v43
  v_pk_mul_f32 v[244:245], v[244:245], v[184:185]
  v_pk_mul_f32 v[246:247], v[246:247], v[186:187]
  s_waitcnt vmcnt(3)
  v_lshlrev_b32 v200, 16, v28
  v_and_b32 v201, 0xffff0000, v28
  v_lshlrev_b32 v202, 16, v29
  v_and_b32 v203, 0xffff0000, v29
  v_pk_mul_f32 v[248:249], v[188:189], v[220:221]
  v_pk_mul_f32 v[250:251], v[190:191], v[222:223]
  v_pk_fma_f32 v[248:249], v[192:193], v[216:217], v[248:249]
  v_pk_fma_f32 v[250:251], v[194:195], v[218:219], v[250:251]
  v_pk_fma_f32 v[248:249], v[196:197], v[212:213], v[248:249]
  v_pk_fma_f32 v[250:251], v[198:199], v[214:215], v[250:251]
  v_pk_fma_f32 v[248:249], v[200:201], v[208:209], v[248:249]
  v_pk_fma_f32 v[250:251], v[202:203], v[210:211], v[250:251]
  s_waitcnt vmcnt(2)
  v_lshlrev_b32 v188, 16, v44
  v_and_b32 v189, 0xffff0000, v44
  v_lshlrev_b32 v190, 16, v45
  v_and_b32 v191, 0xffff0000, v45
  v_pk_mul_f32 v[248:249], v[248:249], v[188:189]
  v_pk_mul_f32 v[250:251], v[250:251], v[190:191]
  s_waitcnt vmcnt(1)
  v_lshlrev_b32 v204, 16, v30
  v_and_b32 v205, 0xffff0000, v30
  v_lshlrev_b32 v206, 16, v31
  v_and_b32 v207, 0xffff0000, v31
  v_pk_mul_f32 v[252:253], v[192:193], v[220:221]
  v_pk_mul_f32 v[254:255], v[194:195], v[222:223]
  v_pk_fma_f32 v[252:253], v[196:197], v[216:217], v[252:253]
  v_pk_fma_f32 v[254:255], v[198:199], v[218:219], v[254:255]
  v_pk_fma_f32 v[252:253], v[200:201], v[212:213], v[252:253]
  v_pk_fma_f32 v[254:255], v[202:203], v[214:215], v[254:255]
  v_pk_fma_f32 v[252:253], v[204:205], v[208:209], v[252:253]
  v_pk_fma_f32 v[254:255], v[206:207], v[210:211], v[254:255]
  s_waitcnt vmcnt(0)
  v_lshlrev_b32 v192, 16, v46
  v_and_b32 v193, 0xffff0000, v46
  v_lshlrev_b32 v194, 16, v47
  v_and_b32 v195, 0xffff0000, v47
  s_lshl_b32 s82, s84, 12
  s_add_u32 s56, s12, s82
  s_addc_u32 s57, s13, 0
  s_mov_b32 s58, 0x1000
  s_mov_b32 s59, 0x00020000
  v_lshlrev_b32 v92, 4, v1
  v_subrev_u32 v93, 8, v92
  buffer_load_dwordx4 v[68:71], v92, s[56:59], 0 offen offset:0 nt
  buffer_load_dwordx4 v[72:75], v92, s[56:59], 0 offen offset:1024 nt
  buffer_load_dwordx4 v[76:79], v92, s[56:59], 0 offen offset:2048 nt
  buffer_load_dwordx4 v[80:83], v92, s[56:59], 0 offen offset:3072 nt
  buffer_load_dwordx2 v[84:85], v93, s[56:59], 0 offen nt
  v_add_u32 v93, 1016, v92
  buffer_load_dwordx2 v[86:87], v93, s[56:59], 0 offen offset:0 nt
  buffer_load_dwordx2 v[88:89], v93, s[56:59], 0 offen offset:1024 nt
  buffer_load_dwordx2 v[90:91], v93, s[56:59], 0 offen offset:2048 nt
  s_mov_b32 s52, s14
  s_mov_b32 s53, s15
  s_mov_b32 s54, 0x500
  s_mov_b32 s55, 0x00020000
  s_lshl_b32 s82, s84, 1
  v_mov_b32 v92, s82
  buffer_load_ushort v92, v92, s[52:55], 0 offen
  v_pk_mul_f32 v[252:253], v[252:253], v[192:193]
  v_pk_mul_f32 v[254:255], v[254:255], v[194:195]
  v_cvt_pk_bf16_f32 v12, v252, v248
  v_cvt_pk_bf16_f32 v13, v244, v240
  v_cvt_pk_bf16_f32 v14, v236, v232
  v_cvt_pk_bf16_f32 v15, v228, v224
  ds_write_b128 v5, v[12:15] offset:0
  v_cvt_pk_bf16_f32 v16, v253, v249
  v_cvt_pk_bf16_f32 v17, v245, v241
  v_cvt_pk_bf16_f32 v18, v237, v233
  v_cvt_pk_bf16_f32 v19, v229, v225
  ds_write_b128 v5, v[16:19] offset:1024
  v_cvt_pk_bf16_f32 v20, v254, v250
  v_cvt_pk_bf16_f32 v21, v246, v242
  v_cvt_pk_bf16_f32 v22, v238, v234
  v_cvt_pk_bf16_f32 v23, v230, v226
  ds_write_b128 v5, v[20:23] offset:2048
  v_cvt_pk_bf16_f32 v24, v255, v251
  v_cvt_pk_bf16_f32 v25, v247, v243
  v_cvt_pk_bf16_f32 v26, v239, v235
  v_cvt_pk_bf16_f32 v27, v231, v227
  ds_write_b128 v5, v[24:27] offset:3072
  v_mov_b32 v66, 0
  buffer_load_dword v66, v66, s[96:99], 0 offen sc1
  s_waitcnt lgkmcnt(0)
  s_barrier
  ds_read_b128 v[32:35], v7 offset:0
  ds_read_b128 v[36:39], v7 offset:1024
  ds_read_b128 v[40:43], v7 offset:2048
  ds_read_b128 v[44:47], v7 offset:3072
  s_waitcnt lgkmcnt(3)
  buffer_store_dwordx4 v[32:35], v6, s[36:39], 0 offen sc1
  s_nop 1
  v_add_u32 v6, 4096, v6
  s_waitcnt lgkmcnt(2)
  buffer_store_dwordx4 v[36:39], v6, s[36:39], 0 offen sc1
  s_nop 1
  v_add_u32 v6, 4096, v6
  s_waitcnt lgkmcnt(1)
  buffer_store_dwordx4 v[40:43], v6, s[36:39], 0 offen sc1
  s_nop 1
  v_add_u32 v6, 4096, v6
  s_waitcnt lgkmcnt(0)
  buffer_store_dwordx4 v[44:47], v6, s[36:39], 0 offen sc1
  s_mov_b32 s48, s22
  s_mov_b32 s49, s23
  s_mov_b32 s50, 0x21c000
  s_mov_b32 s51, 0x00020000
  v_lshrrev_b32 v145, 3, v1
  v_and_b32 v146, 7, v1
  v_mul_u32_u24 v144, 1280, v145
  v_bfe_u32 v145, v145, 1, 1
  v_lshlrev_b32 v145, 2, v145
  v_xor_b32 v145, v145, v146
  v_lshl_add_u32 v144, v145, 4, v144
  v_lshrrev_b32 v146, 4, v1
  v_and_b32 v147, 15, v1
  v_lshlrev_b32 v147, 4, v147
  s_lshl_b32 s85, s32, 12
  s_add_u32 s85, s85, 135168
  s_mov_b32 s88, 271360
  s_lshl_b32 s80, s84, 2
  s_add_u32 s80, s80, 0
  s_cmp_lt_u32 s80, 2160
  s_cselect_b32 s86, 0, 0x80000000
  s_mul_i32 s81, s80, 52429
  s_lshr_b32 s81, s81, 19
  s_mul_i32 s82, s81, 10
  s_sub_u32 s80, s80, s82
  s_mul_i32 s82, s81, 10240
  s_lshl_b32 s83, s80, 7
  s_add_u32 s82, s82, s83
  s_or_b32 s82, s82, s86
  s_add_u32 m0, s85, 0
  s_lshl_b32 s80, s80, 2
  buffer_load_dwordx4 v144, s[48:51], s82 offen nt lds
  s_lshr_b32 s82, s81, 2
  s_mul_i32 s82, s82, 5120
  s_and_b32 s81, s81, 3
  s_lshl_b32 s81, s81, 8
  s_add_u32 s82, s82, s81
  s_add_u32 s82, s82, 0xf00000
  s_or_b32 s82, s82, s86
  v_add_u32 v145, s80, v146
  v_mul_u32_u24 v148, 52, v145
  v_lshrrev_b32 v148, 8, v148
  v_lshl_add_u32 v145, v145, 10, v147
  v_mad_u32_u24 v145, v148, s88, v145
  v_add_u32 v140, s82, v145
  s_lshl_b32 s80, s84, 2
  s_add_u32 s80, s80, 1
  s_cmp_lt_u32 s80, 2160
  s_cselect_b32 s86, 0, 0x80000000
  s_mul_i32 s81, s80, 52429
  s_lshr_b32 s81, s81, 19
  s_mul_i32 s82, s81, 10
  s_sub_u32 s80, s80, s82
  s_mul_i32 s82, s81, 10240
  s_lshl_b32 s83, s80, 7
  s_add_u32 s82, s82, s83
  s_or_b32 s82, s82, s86
  s_add_u32 m0, s85, 1024
  s_lshl_b32 s80, s80, 2
  buffer_load_dwordx4 v144, s[48:51], s82 offen nt lds
  s_lshr_b32 s82, s81, 2
  s_mul_i32 s82, s82, 5120
  s_and_b32 s81, s81, 3
  s_lshl_b32 s81, s81, 8
  s_add_u32 s82, s82, s81
  s_add_u32 s82, s82, 0xf00000
  s_or_b32 s82, s82, s86
  v_add_u32 v145, s80, v146
  v_mul_u32_u24 v148, 52, v145
  v_lshrrev_b32 v148, 8, v148
  v_lshl_add_u32 v145, v145, 10, v147
  v_mad_u32_u24 v145, v148, s88, v145
  v_add_u32 v141, s82, v145
  s_lshl_b32 s80, s84, 2
  s_add_u32 s80, s80, 2
  s_cmp_lt_u32 s80, 2160
  s_cselect_b32 s86, 0, 0x80000000
  s_mul_i32 s81, s80, 52429
  s_lshr_b32 s81, s81, 19
  s_mul_i32 s82, s81, 10
  s_sub_u32 s80, s80, s82
  s_mul_i32 s82, s81, 10240
  s_lshl_b32 s83, s80, 7
  s_add_u32 s82, s82, s83
  s_or_b32 s82, s82, s86
  s_add_u32 m0, s85, 2048
  s_lshl_b32 s80, s80, 2
  buffer_load_dwordx4 v144, s[48:51], s82 offen nt lds
  s_lshr_b32 s82, s81, 2
  s_mul_i32 s82, s82, 5120
  s_and_b32 s81, s81, 3
  s_lshl_b32 s81, s81, 8
  s_add_u32 s82, s82, s81
  s_add_u32 s82, s82, 0xf00000
  s_or_b32 s82, s82, s86
  v_add_u32 v145, s80, v146
  v_mul_u32_u24 v148, 52, v145
  v_lshrrev_b32 v148, 8, v148
  v_lshl_add_u32 v145, v145, 10, v147
  v_mad_u32_u24 v145, v148, s88, v145
  v_add_u32 v142, s82, v145
  s_lshl_b32 s80, s84, 2
  s_add_u32 s80, s80, 3
  s_cmp_lt_u32 s80, 2160
  s_cselect_b32 s86, 0, 0x80000000
  s_mul_i32 s81, s80, 52429
  s_lshr_b32 s81, s81, 19
  s_mul_i32 s82, s81, 10
  s_sub_u32 s80, s80, s82
  s_mul_i32 s82, s81, 10240
  s_lshl_b32 s83, s80, 7
  s_add_u32 s82, s82, s83
  s_or_b32 s82, s82, s86
  s_add_u32 m0, s85, 3072
  s_lshl_b32 s80, s80, 2
  buffer_load_dwordx4 v144, s[48:51], s82 offen nt lds
  s_lshr_b32 s82, s81, 2
  s_mul_i32 s82, s82, 5120
  s_and_b32 s81, s81, 3
  s_lshl_b32 s81, s81, 8
  s_add_u32 s82, s82, s81
  s_add_u32 s82, s82, 0xf00000
  s_or_b32 s82, s82, s86
  v_add_u32 v145, s80, v146
  v_mul_u32_u24 v148, 52, v145
  v_lshrrev_b32 v148, 8, v148
  v_lshl_add_u32 v145, v145, 10, v147
  v_mad_u32_u24 v145, v148, s88, v145
  v_add_u32 v143, s82, v145
  v_bfe_u32 v145, v1, 2, 2
  v_bfe_u32 v147, v1, 1, 1
  v_lshl_add_u32 v146, v146, 1, v147
  v_and_b32 v147, 2, v145
  v_lshlrev_b32 v147, 1, v147
  v_xor_b32 v146, v146, v147
  v_and_b32 v147, 1, v1
  v_lshlrev_b32 v147, 3, v147
  v_lshl_add_u32 v146, v146, 4, v147
  v_lshl_add_u32 v146, v145, 7, v146
  v_add_u32 v145, s85, v146
  s_mul_i32 s80, s32, 16640
  s_add_u32 s80, s80, 8448
  v_lshl_add_u32 v8, v1, 4, s80
  v_mov_b32 v164, 0
  v_mov_b32 v165, 0
  v_mov_b32 v166, 0
  v_mov_b32 v167, 0
  v_and_b32 v9, 3, v1
  v_bfe_u32 v168, v1, 2, 2
  v_mul_u32_u24 v168, 260, v168
  v_add_u32 v9, v9, v168
  v_lshl_add_u32 v9, v9, 4, s80
  ds_write_b128 v9, v[164:167]
  s_mul_i32 s81, s32, 12480
  s_add_u32 s81, s81, 80128
  v_lshl_add_u32 v9, v1, 4, s81
  ds_write_b128 v9, v[164:167] offset:0
  ds_write_b128 v9, v[164:167] offset:96
  ds_write_b128 v9, v[164:167] offset:6240
  ds_write_b128 v9, v[164:167] offset:6336
  s_lshl_b32 s81, s84, 12
  s_add_u32 s81, s81, 0x100000
  s_add_u32 s40, s28, s81
  s_addc_u32 s41, s29, 0
  s_mov_b32 s42, 0x1000
  s_mov_b32 s43, 0x00020000
  s_waitcnt vmcnt(4)
  v_readfirstlane_b32 s80, v66
  s_nop 0
  s_cmp_eq_u32 s80, 0
  s_cbranch_scc1 L_rc_1
L_rcb_2:
  s_lshr_b32 s81, s2, 5
  s_lshl_b32 s81, s81, 4
  s_bfe_u32 s82, s2, 0x20003
  s_lshl_b32 s80, s32, 2
  s_add_u32 s80, s80, s81
  s_add_u32 s80, s80, s82
  s_lshl_b32 s80, s80, 7
  v_or_b32 v64, s80, v111
  v_mov_b32 v65, 1
  buffer_atomic_add v65, v64, s[36:39], 0 offen sc1
  s_lshl_b32 s82, s82, 2
  s_add_u32 s81, s81, s82
  s_add_u32 s81, s81, s32
  s_lshl_b32 s81, s81, 7
  v_add_u32 v66, s81, v111
  buffer_load_dword v67, v66, s[36:39], 0 offen sc1
  v_alignbit_b32 v172, v85, v84, 16
  v_alignbit_b32 v173, v68, v85, 16
  v_alignbit_b32 v174, v69, v68, 16
  v_alignbit_b32 v175, v70, v69, 16
  v_mov_b32 v176, v85
  v_mov_b32 v177, v68
  v_mov_b32 v178, v69
  v_mov_b32 v179, v70
  v_alignbit_b32 v180, v68, v85, 16
  v_alignbit_b32 v181, v69, v68, 16
  v_alignbit_b32 v182, v70, v69, 16
  v_alignbit_b32 v183, v71, v70, 16
  ds_write_b128 v8, v[172:175] offset:48
  ds_write_b128 v8, v[176:179] offset:4208
  ds_write_b128 v8, v[180:183] offset:8368
  ds_write_b128 v8, v[68:71] offset:12528
  v_alignbit_b32 v184, v87, v86, 16
  v_alignbit_b32 v185, v72, v87, 16
  v_alignbit_b32 v186, v73, v72, 16
  v_alignbit_b32 v187, v74, v73, 16
  v_mov_b32 v188, v87
  v_mov_b32 v189, v72
  v_mov_b32 v190, v73
  v_mov_b32 v191, v74
  v_alignbit_b32 v192, v72, v87, 16
  v_alignbit_b32 v193, v73, v72, 16
  v_alignbit_b32 v194, v74, v73, 16
  v_alignbit_b32 v195, v75, v74, 16
  ds_write_b128 v8, v[184:187] offset:1072
  ds_write_b128 v8, v[188:191] offset:5232
  ds_write_b128 v8, v[192:195] offset:9392
  ds_write_b128 v8, v[72:75] offset:13552
  v_alignbit_b32 v172, v89, v88, 16
  v_alignbit_b32 v173, v76, v89, 16
  v_alignbit_b32 v174, v77, v76, 16
  v_alignbit_b32 v175, v78, v77, 16
  v_mov_b32 v176, v89
  v_mov_b32 v177, v76
  v_mov_b32 v178, v77
  v_mov_b32 v179, v78
  v_alignbit_b32 v180, v76, v89, 16
  v_alignbit_b32 v181, v77, v76, 16
  v_alignbit_b32 v182, v78, v77, 16
  v_alignbit_b32 v183, v79, v78, 16
  ds_write_b128 v8, v[172:175] offset:2096
  ds_write_b128 v8, v[176:179] offset:6256
  ds_write_b128 v8, v[180:183] offset:10416
  ds_write_b128 v8, v[76:79] offset:14576
  v_alignbit_b32 v184, v91, v90, 16
  v_alignbit_b32 v185, v80, v91, 16
  v_alignbit_b32 v186, v81, v80, 16
  v_alignbit_b32 v187, v82, v81, 16
  v_mov_b32 v188, v91
  v_mov_b32 v189, v80
  v_mov_b32 v190, v81
  v_mov_b32 v191, v82
  v_alignbit_b32 v192, v80, v91, 16
  v_alignbit_b32 v193, v81, v80, 16
  v_alignbit_b32 v194, v82, v81, 16
  v_alignbit_b32 v195, v83, v82, 16
  ds_write_b128 v8, v[184:187] offset:3120
  ds_write_b128 v8, v[188:191] offset:7280
  ds_write_b128 v8, v[192:195] offset:11440
  ds_write_b128 v8, v[80:83] offset:15600
  v_and_b32 v164, 3, v1
  v_bfe_u32 v165, v1, 2, 2
  v_lshrrev_b32 v166, 4, v1
  v_add_u32 v167, v165, v166
  v_lshlrev_b32 v168, 16, v92
  v_and_b32 v169, 1, v164
  v_cmp_eq_u32 vcc, 0, v169
  s_nop 1
  v_cndmask_b32 v168, v92, v168, vcc
  v_cmp_eq_u32 vcc, 3, v167
  s_nop 1
  v_cndmask_b32 v168, 0, v168, vcc
  v_cmp_gt_u32 vcc, 2, v164
  s_nop 1
  v_cndmask_b32 v12, v168, 0, vcc
  v_cndmask_b32 v13, 0, v168, vcc
  v_mov_b32 v14, 0
  v_mov_b32 v15, 0
  s_waitcnt vmcnt(2)
  ds_read_b64_tr_b16 v[124:125], v145 offset:0
  ds_read_b64_tr_b16 v[126:127], v145 offset:512
  ds_read_b64_tr_b16 v[128:129], v145 offset:1024
  ds_read_b64_tr_b16 v[130:131], v145 offset:1536
  ds_read_b64_tr_b16 v[132:133], v145 offset:2048
  ds_read_b64_tr_b16 v[134:135], v145 offset:2560
  ds_read_b64_tr_b16 v[136:137], v145 offset:3072
  ds_read_b64_tr_b16 v[138:139], v145 offset:3584
  s_waitcnt lgkmcnt(6)
  buffer_store_dwordx4 v[124:127], v140, s[36:39], 0 offen sc1
  s_waitcnt lgkmcnt(4)
  buffer_store_dwordx4 v[128:131], v141, s[36:39], 0 offen sc1
  s_waitcnt lgkmcnt(2)
  buffer_store_dwordx4 v[132:135], v142, s[36:39], 0 offen sc1
  s_waitcnt lgkmcnt(0)
  buffer_store_dwordx4 v[136:139], v143, s[36:39], 0 offen sc1
  s_mul_i32 s80, s101, 276480
  s_mul_i32 s81, s32, 71680
  s_add_u32 s80, s80, s81
  s_add_u32 s80, s80, 0xf00000
  v_lshl_add_u32 v68, v1, 4, s80
  v_add_u32 v255, 4096, v68
  s_xor_b32 s81, s32, 0
  s_lshl_b32 s81, s81, 10
  v_add_u32 v251, s81, v68
  s_xor_b32 s81, s32, 1
  s_lshl_b32 s81, s81, 10
  v_add_u32 v252, s81, v68
  s_xor_b32 s81, s32, 2
  s_lshl_b32 s81, s81, 10
  v_add_u32 v253, s81, v68
  s_xor_b32 s81, s32, 3
  s_lshl_b32 s81, s81, 10
  v_add_u32 v254, s81, v68
  s_and_b32 s83, s84, 63
  s_lshl_b32 s83, s83, 7
  s_add_u32 s83, s83, 147456
  s_waitcnt vmcnt(4)
  v_cmp_gt_u32 vcc, 8, v67
  s_nop 0
  s_and_b32 vcc_lo, vcc_lo, 0x1
  s_cbranch_scc1 L_cp_3
L_cpb_4:
  s_barrier
  s_mul_i32 s80, s32, 12480
  s_add_u32 m0, s80, 77056
  s_nop 0
  buffer_load_dwordx4 v116, s[40:43], 0 offen sc1 lds
  s_mul_i32 s80, s32, 12480
  s_add_u32 m0, s80, 83296
  s_nop 0
  buffer_load_dwordx4 v117, s[40:43], 0 offen sc1 lds
  s_mul_i32 s80, s32, 12480
  s_add_u32 m0, s80, 78080
  s_nop 0
  buffer_load_dwordx4 v118, s[40:43], 0 offen sc1 lds
  s_mul_i32 s80, s32, 12480
  s_add_u32 m0, s80, 84320
  s_nop 0
  buffer_load_dwordx4 v119, s[40:43], 0 offen sc1 lds
  s_mul_i32 s80, s32, 12480
  s_add_u32 m0, s80, 79104
  s_nop 0
  buffer_load_dwordx4 v120, s[40:43], 0 offen sc1 lds
  s_mul_i32 s80, s32, 12480
  s_add_u32 m0, s80, 85344
  s_nop 0
  buffer_load_dwordx4 v121, s[40:43], 0 offen sc1 lds
  s_mul_i32 s80, s32, 12480
  s_add_u32 m0, s80, 76032
  s_nop 0
  buffer_load_dwordx4 v114, s[40:43], 0 offen sc1 lds
  s_mul_i32 s80, s32, 12480
  s_add_u32 m0, s80, 82272
  s_nop 0
  buffer_load_dwordx4 v115, s[40:43], 0 offen sc1 lds
  s_mul_i32 s80, s32, 12480
  s_add_u32 m0, s80, 75008
  s_nop 0
  buffer_load_dwordx4 v112, s[40:43], 0 offen sc1 lds
  s_mul_i32 s80, s32, 12480
  s_add_u32 m0, s80, 81248
  s_nop 0
  buffer_load_dwordx4 v113, s[40:43], 0 offen sc1 lds
  s_waitcnt vmcnt(10)
  v_or_b32 v64, s83, v111
  v_mov_b32 v65, 1
  buffer_atomic_add v65, v64, s[36:39], 0 offen sc1
  s_waitcnt vmcnt(5)
  ds_read_b128 v[124:127], v94 offset:0
  ds_read_b128 v[128:131], v95 offset:2560
  ds_read_b128 v[132:135], v95 offset:3840
  ds_read_b128 v[136:139], v94 offset:64
  ds_read_b128 v[140:143], v95 offset:2624
  ds_read_b128 v[144:147], v95 offset:3904
  ds_read_b128 v[148:151], v94 offset:128
  ds_read_b128 v[152:155], v95 offset:2720
  s_waitcnt lgkmcnt(6)
  v_mfma_f32_16x16x32_bf16 v[28:31], v[124:127], v[128:131], 0
  ds_read_b128 v[156:159], v95 offset:4000
  s_waitcnt lgkmcnt(6)
  v_mfma_f32_16x16x32_bf16 v[20:23], v[124:127], v[132:135], 0
  ds_read_b128 v[160:163], v94 offset:192
  v_mfma_f32_16x16x32_bf16 v[28:31], v[12:15], v[128:131], v[28:31]
  ds_read_b128 v[164:167], v95 offset:2784
  v_mfma_f32_16x16x32_bf16 v[20:23], v[12:15], v[132:135], v[20:23]
  ds_read_b128 v[168:171], v95 offset:4064
  s_waitcnt lgkmcnt(7)
  v_mfma_f32_16x16x32_bf16 v[28:31], v[136:139], v[140:143], v[28:31]
  ds_read_b128 v[172:175], v94 offset:256
  v_mfma_f32_16x16x32_bf16 v[24:27], v[124:127], v[140:143], 0
  ds_read_b128 v[176:179], v95 offset:2880
  s_waitcnt lgkmcnt(8)
  v_mfma_f32_16x16x32_bf16 v[20:23], v[136:139], v[144:147], v[20:23]
  ds_read_b128 v[180:183], v95 offset:4160
  v_mfma_f32_16x16x32_bf16 v[16:19], v[124:127], v[144:147], 0
  ds_read_b128 v[184:187], v94 offset:320
  v_mfma_f32_16x16x32_bf16 v[24:27], v[12:15], v[140:143], v[24:27]
  ds_read_b128 v[188:191], v95 offset:2944
  v_mfma_f32_16x16x32_bf16 v[16:19], v[12:15], v[144:147], v[16:19]
  ds_read_b128 v[192:195], v95 offset:4224
  s_waitcnt lgkmcnt(10)
  v_mfma_f32_16x16x32_bf16 v[28:31], v[148:151], v[152:155], v[28:31]
  ds_read_b128 v[196:199], v94 offset:384
  v_mfma_f32_16x16x32_bf16 v[24:27], v[136:139], v[152:155], v[24:27]
  ds_read_b128 v[200:203], v95 offset:3040
  s_waitcnt lgkmcnt(11)
  v_mfma_f32_16x16x32_bf16 v[20:23], v[148:151], v[156:159], v[20:23]
  ds_read_b128 v[204:207], v95 offset:4320
  v_mfma_f32_16x16x32_bf16 v[16:19], v[136:139], v[156:159], v[16:19]
  ds_read_b128 v[208:211], v94 offset:448
  s_waitcnt lgkmcnt(11)
  v_mfma_f32_16x16x32_bf16 v[28:31], v[160:163], v[164:167], v[28:31]
  ds_read_b128 v[212:215], v95 offset:3104
  v_mfma_f32_16x16x32_bf16 v[24:27], v[148:151], v[164:167], v[24:27]
  ds_read_b128 v[216:219], v95 offset:4384
  s_waitcnt lgkmcnt(12)
  v_mfma_f32_16x16x32_bf16 v[20:23], v[160:163], v[168:171], v[20:23]
  ds_read_b128 v[220:223], v94 offset:512
  v_mfma_f32_16x16x32_bf16 v[16:19], v[148:151], v[168:171], v[16:19]
  ds_read_b128 v[224:227], v95 offset:3200
  s_waitcnt lgkmcnt(12)
  v_mfma_f32_16x16x32_bf16 v[28:31], v[172:175], v[176:179], v[28:31]
  ds_read_b128 v[228:231], v95 offset:4480
  v_mfma_f32_16x16x32_bf16 v[24:27], v[160:163], v[176:179], v[24:27]
  ds_read_b128 v[176:179], v94 offset:576
  s_waitcnt lgkmcnt(13)
  v_mfma_f32_16x16x32_bf16 v[20:23], v[172:175], v[180:183], v[20:23]
  ds_read_b128 v[164:167], v95 offset:3264
  v_mfma_f32_16x16x32_bf16 v[16:19], v[160:163], v[180:183], v[16:19]
  ds_read_b128 v[152:155], v95 offset:4544
  s_waitcnt lgkmcnt(13)
  v_mfma_f32_16x16x32_bf16 v[28:31], v[184:187], v[188:191], v[28:31]
  ds_read_b128 v[140:143], v94 offset:640
  v_mfma_f32_16x16x32_bf16 v[24:27], v[172:175], v[188:191], v[24:27]
  ds_read_b128 v[188:191], v95 offset:3360
  s_waitcnt lgkmcnt(14)
  v_mfma_f32_16x16x32_bf16 v[20:23], v[184:187], v[192:195], v[20:23]
  ds_read_b128 v[128:131], v95 offset:4640
  v_mfma_f32_16x16x32_bf16 v[16:19], v[172:175], v[192:195], v[16:19]
  ds_read_b128 v[172:175], v94 offset:704
  s_waitcnt lgkmcnt(14)
  v_mfma_f32_16x16x32_bf16 v[28:31], v[196:199], v[200:203], v[28:31]
  ds_read_b128 v[160:163], v95 offset:3424
  v_mfma_f32_16x16x32_bf16 v[24:27], v[184:187], v[200:203], v[24:27]
  ds_read_b128 v[200:203], v95 offset:4704
  s_waitcnt lgkmcnt(15)
  v_mfma_f32_16x16x32_bf16 v[20:23], v[196:199], v[204:207], v[20:23]
  ds_read_b128 v[148:151], v94 offset:768
  s_and_b32 s80, s2, 15
  v_mfma_f32_16x16x32_bf16 v[16:19], v[184:187], v[204:207], v[16:19]
  ds_read_b128 v[184:187], v95 offset:3520
  s_lshl_b32 s80, s80, 7
  s_waitcnt lgkmcnt(15)
  v_mfma_f32_16x16x32_bf16 v[28:31], v[208:211], v[212:215], v[28:31]
  ds_read_b128 v[136:139], v95 offset:4800
  s_add_u32 s80, s80, 159744
  v_mfma_f32_16x16x32_bf16 v[24:27], v[196:199], v[212:215], v[24:27]
  ds_read_b128 v[212:215], v94 offset:832
  v_add_u32 v122, s80, v111
  s_waitcnt lgkmcnt(15)
  v_mfma_f32_16x16x32_bf16 v[20:23], v[208:211], v[216:219], v[20:23]
  ds_read_b128 v[124:127], v95 offset:3584
  buffer_load_dword v123, v122, s[36:39], 0 offen sc1
  v_mfma_f32_16x16x32_bf16 v[16:19], v[196:199], v[216:219], v[16:19]
  ds_read_b128 v[196:199], v95 offset:4864
  s_waitcnt lgkmcnt(15)
  v_mfma_f32_16x16x32_bf16 v[28:31], v[220:223], v[224:227], v[28:31]
  ds_read_b128 v[216:219], v94 offset:896
  v_mfma_f32_16x16x32_bf16 v[24:27], v[208:211], v[224:227], v[24:27]
  ds_read_b128 v[224:227], v95 offset:3680
  s_waitcnt lgkmcnt(15)
  v_mfma_f32_16x16x32_bf16 v[20:23], v[220:223], v[228:231], v[20:23]
  ds_read_b128 v[204:207], v95 offset:4960
  v_mfma_f32_16x16x32_bf16 v[16:19], v[208:211], v[228:231], v[16:19]
  s_waitcnt lgkmcnt(15)
  v_mfma_f32_16x16x32_bf16 v[28:31], v[176:179], v[164:167], v[28:31]
  ds_read_b128 v[208:211], v94 offset:960
  v_mfma_f32_16x16x32_bf16 v[24:27], v[220:223], v[164:167], v[24:27]
  ds_read_b128 v[164:167], v95 offset:3744
  s_waitcnt lgkmcnt(15)
  v_mfma_f32_16x16x32_bf16 v[20:23], v[176:179], v[152:155], v[20:23]
  ds_read_b128 v[228:231], v95 offset:5024
  v_mfma_f32_16x16x32_bf16 v[16:19], v[220:223], v[152:155], v[16:19]
  s_waitcnt lgkmcnt(15)
  v_mfma_f32_16x16x32_bf16 v[28:31], v[140:143], v[188:191], v[28:31]
  ds_read_b128 v[220:223], v94 offset:1024
  v_mfma_f32_16x16x32_bf16 v[24:27], v[176:179], v[188:191], v[24:27]
  s_waitcnt lgkmcnt(15)
  v_mfma_f32_16x16x32_bf16 v[20:23], v[140:143], v[128:131], v[20:23]
  ds_read_b128 v[188:191], v94 offset:1088
  v_mfma_f32_16x16x32_bf16 v[16:19], v[176:179], v[128:131], v[16:19]
  s_waitcnt lgkmcnt(15)
  v_mfma_f32_16x16x32_bf16 v[28:31], v[172:175], v[160:163], v[28:31]
  ds_read_b128 v[176:179], v94 offset:1152
  v_mfma_f32_16x16x32_bf16 v[24:27], v[140:143], v[160:163], v[24:27]
  s_waitcnt lgkmcnt(15)
  v_mfma_f32_16x16x32_bf16 v[20:23], v[172:175], v[200:203], v[20:23]
  ds_read_b128 v[160:163], v94 offset:1216
  v_mfma_f32_16x16x32_bf16 v[16:19], v[140:143], v[200:203], v[16:19]
  s_waitcnt lgkmcnt(14)
  v_mfma_f32_16x16x32_bf16 v[28:31], v[148:151], v[184:187], v[28:31]
  ds_read_b128 v[140:143], v94 offset:1280
  v_mfma_f32_16x16x32_bf16 v[24:27], v[172:175], v[184:187], v[24:27]
  s_waitcnt lgkmcnt(14)
  v_mfma_f32_16x16x32_bf16 v[20:23], v[148:151], v[136:139], v[20:23]
  ds_read_b128 v[184:187], v94 offset:1344
  v_mfma_f32_16x16x32_bf16 v[16:19], v[172:175], v[136:139], v[16:19]
  s_waitcnt lgkmcnt(13)
  v_mfma_f32_16x16x32_bf16 v[28:31], v[212:215], v[124:127], v[28:31]
  ds_read_b128 v[172:175], v94 offset:1408
  v_mfma_f32_16x16x32_bf16 v[24:27], v[148:151], v[124:127], v[24:27]
  ds_read_b128 v[124:127], v95 offset:4320
  s_waitcnt lgkmcnt(14)
  v_mfma_f32_16x16x32_bf16 v[20:23], v[212:215], v[196:199], v[20:23]
  ds_read_b128 v[136:139], v94 offset:1472
  v_mfma_f32_16x16x32_bf16 v[16:19], v[148:151], v[196:199], v[16:19]
  ds_read_b128 v[148:151], v95 offset:4384
  s_waitcnt lgkmcnt(14)
  v_mfma_f32_16x16x32_bf16 v[28:31], v[216:219], v[224:227], v[28:31]
  ds_read_b128 v[196:199], v94 offset:1536
  v_mfma_f32_16x16x32_bf16 v[24:27], v[212:215], v[224:227], v[24:27]
  ds_read_b128 v[224:227], v95 offset:4480
  s_waitcnt lgkmcnt(15)
  v_mfma_f32_16x16x32_bf16 v[20:23], v[216:219], v[204:207], v[20:23]
  ds_read_b128 v[200:203], v94 offset:1600
  v_mfma_f32_16x16x32_bf16 v[16:19], v[212:215], v[204:207], v[16:19]
  s_waitcnt lgkmcnt(14)
  v_mfma_f32_16x16x32_bf16 v[28:31], v[208:211], v[164:167], v[28:31]
  ds_read_b128 v[212:215], v94 offset:1664
  v_mfma_f32_16x16x32_bf16 v[24:27], v[216:219], v[164:167], v[24:27]
  s_waitcnt lgkmcnt(14)
  v_mfma_f32_16x16x32_bf16 v[20:23], v[208:211], v[228:231], v[20:23]
  ds_read_b128 v[164:167], v94 offset:1728
  v_mfma_f32_16x16x32_bf16 v[16:19], v[216:219], v[228:231], v[16:19]
  ds_read_b128 v[216:219], v95 offset:4704
  s_waitcnt lgkmcnt(15)
  v_mfma_f32_16x16x32_bf16 v[28:31], v[220:223], v[132:135], v[28:31]
  ds_read_b128 v[228:231], v94 offset:1792
  v_mfma_f32_16x16x32_bf16 v[24:27], v[208:211], v[132:135], v[24:27]
  ds_read_b128 v[132:135], v95 offset:4800
  s_waitcnt vmcnt(2)
  s_waitcnt lgkmcnt(15)
  v_mfma_f32_16x16x32_bf16 v[28:31], v[188:191], v[144:147], v[28:31]
  ds_read_b128 v[208:211], v94 offset:1856
  s_waitcnt vmcnt(0)
  v_cmp_gt_u32 vcc, 42, v123
  v_mfma_f32_16x16x32_bf16 v[24:27], v[220:223], v[144:147], v[24:27]
  ds_read_b128 v[144:147], v95 offset:4864
  s_and_b32 vcc_lo, vcc_lo, 0x1
  s_waitcnt lgkmcnt(15)
  v_mfma_f32_16x16x32_bf16 v[28:31], v[176:179], v[156:159], v[28:31]
  ds_read_b128 v[220:223], v94 offset:1920
  s_cbranch_scc1 L_cp_5
L_cpb_6:
  v_mfma_f32_16x16x32_bf16 v[24:27], v[188:191], v[156:159], v[24:27]
  s_mov_b32 s80, 0
  buffer_load_dwordx4 v[48:51], v99, s[36:39], s80 offen sc1
  s_waitcnt lgkmcnt(15)
  v_mfma_f32_16x16x32_bf16 v[28:31], v[160:163], v[168:171], v[28:31]
  ds_read_b128 v[156:159], v94 offset:1984
  s_mov_b32 s80, 0
  v_mfma_f32_16x16x32_bf16 v[24:27], v[176:179], v[168:171], v[24:27]
  ds_read_b128 v[168:171], v95 offset:5024
  buffer_load_dwordx4 v[52:55], v101, s[36:39], s80 offen sc1
  s_waitcnt lgkmcnt(15)
  v_mfma_f32_16x16x32_bf16 v[28:31], v[140:143], v[180:183], v[28:31]
  ds_read_b128 v[176:179], v94 offset:0
  s_mov_b32 s80, 655360
  v_mfma_f32_16x16x32_bf16 v[24:27], v[160:163], v[180:183], v[24:27]
  ds_read_b128 v[180:183], v95 offset:0
  buffer_load_dwordx4 v[56:59], v99, s[36:39], s80 offen sc1
  s_waitcnt lgkmcnt(15)
  v_mfma_f32_16x16x32_bf16 v[28:31], v[184:187], v[192:195], v[28:31]
  ds_read_b128 v[160:163], v95 offset:1280
  s_mov_b32 s80, 4096
  v_mfma_f32_16x16x32_bf16 v[24:27], v[140:143], v[192:195], v[24:27]
  buffer_load_dwordx4 v[60:63], v101, s[36:39], s80 offen sc1
  s_waitcnt lgkmcnt(15)
  v_mfma_f32_16x16x32_bf16 v[28:31], v[172:175], v[124:127], v[28:31]
  ds_read_b128 v[192:195], v94 offset:64
  v_mfma_f32_16x16x32_bf16 v[24:27], v[184:187], v[124:127], v[24:27]
  ds_read_b128 v[124:127], v95 offset:64
  s_waitcnt lgkmcnt(15)
  v_mfma_f32_16x16x32_bf16 v[28:31], v[136:139], v[148:151], v[28:31]
  ds_read_b128 v[184:187], v95 offset:1344
  v_mfma_f32_16x16x32_bf16 v[24:27], v[172:175], v[148:151], v[24:27]
  s_waitcnt lgkmcnt(15)
  v_mfma_f32_16x16x32_bf16 v[28:31], v[196:199], v[224:227], v[28:31]
  v_mfma_f32_16x16x32_bf16 v[24:27], v[136:139], v[224:227], v[24:27]
  s_waitcnt lgkmcnt(15)
  v_mfma_f32_16x16x32_bf16 v[28:31], v[200:203], v[152:155], v[28:31]
  ds_read_b128 v[224:227], v94 offset:128
  v_mfma_f32_16x16x32_bf16 v[24:27], v[196:199], v[152:155], v[24:27]
  ds_read_b128 v[152:155], v95 offset:160
  s_waitcnt lgkmcnt(15)
  v_mfma_f32_16x16x32_bf16 v[28:31], v[212:215], v[128:131], v[28:31]
  ds_read_b128 v[148:151], v95 offset:1440
  v_mfma_f32_16x16x32_bf16 v[24:27], v[200:203], v[128:131], v[24:27]
  s_waitcnt lgkmcnt(15)
  v_mfma_f32_16x16x32_bf16 v[28:31], v[164:167], v[216:219], v[28:31]
  ds_read_b128 v[128:131], v94 offset:192
  v_mfma_f32_16x16x32_bf16 v[24:27], v[212:215], v[216:219], v[24:27]
  ds_read_b128 v[216:219], v95 offset:224
  s_waitcnt lgkmcnt(15)
  v_mfma_f32_16x16x32_bf16 v[28:31], v[228:231], v[132:135], v[28:31]
  ds_read_b128 v[212:215], v95 offset:1504
  v_mfma_f32_16x16x32_bf16 v[24:27], v[164:167], v[132:135], v[24:27]
  s_waitcnt lgkmcnt(15)
  v_mfma_f32_16x16x32_bf16 v[28:31], v[208:211], v[144:147], v[28:31]
  ds_read_b128 v[132:135], v94 offset:256
  v_mfma_f32_16x16x32_bf16 v[24:27], v[228:231], v[144:147], v[24:27]
  ds_read_b128 v[144:147], v95 offset:320
  s_waitcnt lgkmcnt(15)
  v_mfma_f32_16x16x32_bf16 v[28:31], v[220:223], v[204:207], v[28:31]
  ds_read_b128 v[228:231], v95 offset:1600
  v_mfma_f32_16x16x32_bf16 v[24:27], v[208:211], v[204:207], v[24:27]
  s_waitcnt lgkmcnt(15)
  v_mfma_f32_16x16x32_bf16 v[28:31], v[156:159], v[168:171], v[28:31]
  ds_read_b128 v[204:207], v94 offset:320
  v_mfma_f32_16x16x32_bf16 v[24:27], v[220:223], v[168:171], v[24:27]
  ds_read_b128 v[168:171], v95 offset:384
  s_waitcnt lgkmcnt(15)
  v_mfma_f32_16x16x32_bf16 v[44:47], v[176:179], v[180:183], 0
  ds_read_b128 v[156:159], v95 offset:1664
  s_waitcnt lgkmcnt(15)
  v_mfma_f32_16x16x32_bf16 v[36:39], v[176:179], v[160:163], 0
  v_mfma_f32_16x16x32_bf16 v[44:47], v[12:15], v[180:183], v[44:47]
  ds_read_b128 v[180:183], v94 offset:384
  v_cvt_pk_bf16_f32 v64, v16, v18
  v_cvt_pk_bf16_f32 v65, v17, v19
  v_mfma_f32_16x16x32_bf16 v[36:39], v[12:15], v[160:163], v[36:39]
  ds_read_b128 v[220:223], v95 offset:480
  ds_write2_b32 v96, v64, v65 offset0:0 offset1:32
  v_cvt_pk_bf16_f32 v66, v20, v22
  s_waitcnt lgkmcnt(15)
  v_mfma_f32_16x16x32_bf16 v[44:47], v[192:195], v[124:127], v[44:47]
  ds_read_b128 v[208:211], v95 offset:1760
  v_cvt_pk_bf16_f32 v67, v21, v23
  ds_write2_b32 v96, v66, v67 offset0:8 offset1:40
  v_mfma_f32_16x16x32_bf16 v[40:43], v[176:179], v[124:127], 0
  v_cvt_pk_bf16_f32 v68, v24, v26
  v_cvt_pk_bf16_f32 v69, v25, v27
  ds_write2_b32 v97, v68, v69 offset0:0 offset1:32
  s_waitcnt lgkmcnt(15)
  v_mfma_f32_16x16x32_bf16 v[36:39], v[192:195], v[184:187], v[36:39]
  ds_read_b128 v[164:167], v94 offset:448
  v_cvt_pk_bf16_f32 v70, v28, v30
  v_cvt_pk_bf16_f32 v71, v29, v31
  v_mfma_f32_16x16x32_bf16 v[32:35], v[176:179], v[184:187], 0
  ds_read_b128 v[176:179], v95 offset:544
  ds_write2_b32 v97, v70, v71 offset0:8 offset1:40
  s_waitcnt lgkmcnt(0)
  s_barrier
  v_mfma_f32_16x16x32_bf16 v[40:43], v[12:15], v[124:127], v[40:43]
  ds_read_b128 v[124:127], v95 offset:1824
  ds_read_b64_tr_b16 v[72:73], v98 offset:0
  ds_read_b64_tr_b16 v[74:75], v98 offset:128
  v_mfma_f32_16x16x32_bf16 v[32:35], v[12:15], v[184:187], v[32:35]
  ds_read_b64_tr_b16 v[76:77], v98 offset:1024
  ds_read_b64_tr_b16 v[78:79], v98 offset:1152
  s_mov_b32 s80, 3145728
  v_mfma_f32_16x16x32_bf16 v[44:47], v[224:227], v[152:155], v[44:47]
  ds_read_b128 v[200:203], v94 offset:512
  s_waitcnt lgkmcnt(3)
  buffer_store_dwordx4 v[72:75], v100, s[36:39], s80 offen sc1
  s_waitcnt vmcnt(4)
  v_lshlrev_b32 v80, 16, v48
  v_mfma_f32_16x16x32_bf16 v[40:43], v[192:195], v[152:155], v[40:43]
  ds_read_b128 v[152:155], v95 offset:640
  v_and_b32 v81, 0xffff0000, v48
  v_lshlrev_b32 v84, 16, v72
  v_mfma_f32_16x16x32_bf16 v[36:39], v[224:227], v[148:151], v[36:39]
  ds_read_b128 v[196:199], v95 offset:1920
  v_and_b32 v85, 0xffff0000, v72
  s_waitcnt vmcnt(3)
  v_fma_f32 v82, v80, v52, v53
  v_mfma_f32_16x16x32_bf16 v[32:35], v[192:195], v[148:151], v[32:35]
  v_fma_f32 v83, v81, v52, v53
  v_fmac_f32 v80, v82, v84
  v_fmac_f32 v81, v83, v85
  v_mfma_f32_16x16x32_bf16 v[44:47], v[128:131], v[216:219], v[44:47]
  ds_read_b128 v[192:195], v94 offset:576
  v_cvt_pk_bf16_f32 v64, v80, v81
  v_lshlrev_b32 v86, 16, v49
  v_mfma_f32_16x16x32_bf16 v[40:43], v[224:227], v[216:219], v[40:43]
  ds_read_b128 v[216:219], v95 offset:704
  v_and_b32 v87, 0xffff0000, v49
  v_lshlrev_b32 v90, 16, v73
  v_mfma_f32_16x16x32_bf16 v[36:39], v[128:131], v[212:215], v[36:39]
  ds_read_b128 v[136:139], v95 offset:1984
  v_and_b32 v91, 0xffff0000, v73
  v_fma_f32 v88, v86, v52, v53
  v_mfma_f32_16x16x32_bf16 v[32:35], v[224:227], v[212:215], v[32:35]
  v_fma_f32 v89, v87, v52, v53
  v_fmac_f32 v86, v88, v90
  v_fmac_f32 v87, v89, v91
  v_mfma_f32_16x16x32_bf16 v[44:47], v[132:135], v[144:147], v[44:47]
  ds_read_b128 v[224:227], v94 offset:640
  v_cvt_pk_bf16_f32 v65, v86, v87
  v_lshlrev_b32 v80, 16, v50
  v_mfma_f32_16x16x32_bf16 v[40:43], v[128:131], v[144:147], v[40:43]
  ds_read_b128 v[144:147], v95 offset:800
  v_and_b32 v81, 0xffff0000, v50
  v_lshlrev_b32 v84, 16, v74
  v_mfma_f32_16x16x32_bf16 v[36:39], v[132:135], v[228:231], v[36:39]
  ds_read_b128 v[172:175], v95 offset:2080
  v_and_b32 v85, 0xffff0000, v74
  v_fma_f32 v82, v80, v54, v55
  v_mfma_f32_16x16x32_bf16 v[32:35], v[128:131], v[228:231], v[32:35]
  v_fma_f32 v83, v81, v54, v55
  v_fmac_f32 v80, v82, v84
  v_fmac_f32 v81, v83, v85
  v_mfma_f32_16x16x32_bf16 v[44:47], v[204:207], v[168:171], v[44:47]
  ds_read_b128 v[128:131], v94 offset:704
  v_cvt_pk_bf16_f32 v66, v80, v81
  v_lshlrev_b32 v86, 16, v51
  v_mfma_f32_16x16x32_bf16 v[40:43], v[132:135], v[168:171], v[40:43]
  ds_read_b128 v[168:171], v95 offset:864
  v_and_b32 v87, 0xffff0000, v51
  v_lshlrev_b32 v90, 16, v75
  v_mfma_f32_16x16x32_bf16 v[36:39], v[204:207], v[156:159], v[36:39]
  ds_read_b128 v[140:143], v95 offset:2144
  v_and_b32 v91, 0xffff0000, v75
  v_fma_f32 v88, v86, v54, v55
  v_mfma_f32_16x16x32_bf16 v[32:35], v[132:135], v[156:159], v[32:35]
  v_fma_f32 v89, v87, v54, v55
  v_fmac_f32 v86, v88, v90
  v_fmac_f32 v87, v89, v91
  v_mfma_f32_16x16x32_bf16 v[44:47], v[180:183], v[220:223], v[44:47]
  ds_read_b128 v[132:135], v94 offset:768
  v_cvt_pk_bf16_f32 v67, v86, v87
  s_mov_b32 s81, 0
  v_mfma_f32_16x16x32_bf16 v[40:43], v[204:207], v[220:223], v[40:43]
  ds_read_b128 v[220:223], v95 offset:960
  buffer_store_dwordx4 v[64:67], v100, s[36:39], s81 offen sc1
  s_mov_b32 s80, 4456448
  v_mfma_f32_16x16x32_bf16 v[36:39], v[180:183], v[208:211], v[36:39]
  ds_read_b128 v[156:159], v95 offset:2240
  s_waitcnt lgkmcnt(15)
  buffer_store_dwordx4 v[76:79], v100, s[36:39], s80 offen sc1
  s_waitcnt vmcnt(4)
  v_lshlrev_b32 v80, 16, v56
  v_mfma_f32_16x16x32_bf16 v[32:35], v[204:207], v[208:211], v[32:35]
  v_and_b32 v81, 0xffff0000, v56
  v_lshlrev_b32 v84, 16, v76
  v_and_b32 v85, 0xffff0000, v76
  v_mfma_f32_16x16x32_bf16 v[44:47], v[164:167], v[176:179], v[44:47]
  ds_read_b128 v[204:207], v94 offset:832
  s_waitcnt vmcnt(3)
  v_fma_f32 v82, v80, v60, v61
  v_fma_f32 v83, v81, v60, v61
  v_mfma_f32_16x16x32_bf16 v[40:43], v[180:183], v[176:179], v[40:43]
  ds_read_b128 v[176:179], v95 offset:1024
  v_fmac_f32 v80, v82, v84
  v_fmac_f32 v81, v83, v85
  v_mfma_f32_16x16x32_bf16 v[36:39], v[164:167], v[124:127], v[36:39]
  ds_read_b128 v[208:211], v95 offset:2304
  v_cvt_pk_bf16_f32 v68, v80, v81
  v_lshlrev_b32 v86, 16, v57
  v_mfma_f32_16x16x32_bf16 v[32:35], v[180:183], v[124:127], v[32:35]
  v_and_b32 v87, 0xffff0000, v57
  v_lshlrev_b32 v90, 16, v77
  v_and_b32 v91, 0xffff0000, v77
  s_waitcnt lgkmcnt(15)
  v_mfma_f32_16x16x32_bf16 v[44:47], v[200:203], v[152:155], v[44:47]
  ds_read_b128 v[180:183], v94 offset:896
  v_fma_f32 v88, v86, v60, v61
  v_fma_f32 v89, v87, v60, v61
  v_mfma_f32_16x16x32_bf16 v[40:43], v[164:167], v[152:155], v[40:43]
  ds_read_b128 v[152:155], v95 offset:1120
  v_fmac_f32 v86, v88, v90
  v_fmac_f32 v87, v89, v91
  s_waitcnt lgkmcnt(15)
  v_mfma_f32_16x16x32_bf16 v[36:39], v[200:203], v[196:199], v[36:39]
  ds_read_b128 v[124:127], v95 offset:2400
  v_cvt_pk_bf16_f32 v69, v86, v87
  v_lshlrev_b32 v80, 16, v58
  v_mfma_f32_16x16x32_bf16 v[32:35], v[164:167], v[196:199], v[32:35]
  v_and_b32 v81, 0xffff0000, v58
  v_lshlrev_b32 v84, 16, v78
  v_and_b32 v85, 0xffff0000, v78
  s_waitcnt lgkmcnt(15)
  v_mfma_f32_16x16x32_bf16 v[44:47], v[192:195], v[216:219], v[44:47]
  ds_read_b128 v[164:167], v94 offset:960
  v_fma_f32 v82, v80, v62, v63
  v_fma_f32 v83, v81, v62, v63
  v_mfma_f32_16x16x32_bf16 v[40:43], v[200:203], v[216:219], v[40:43]
  ds_read_b128 v[216:219], v95 offset:1184
  v_fmac_f32 v80, v82, v84
  v_fmac_f32 v81, v83, v85
  s_waitcnt lgkmcnt(15)
  v_mfma_f32_16x16x32_bf16 v[36:39], v[192:195], v[136:139], v[36:39]
  ds_read_b128 v[196:199], v95 offset:2464
  v_cvt_pk_bf16_f32 v70, v80, v81
  v_lshlrev_b32 v86, 16, v59
  v_mfma_f32_16x16x32_bf16 v[32:35], v[200:203], v[136:139], v[32:35]
  v_and_b32 v87, 0xffff0000, v59
  v_lshlrev_b32 v90, 16, v79
  v_and_b32 v91, 0xffff0000, v79
  s_waitcnt lgkmcnt(15)
  v_mfma_f32_16x16x32_bf16 v[44:47], v[224:227], v[144:147], v[44:47]
  ds_read_b128 v[200:203], v94 offset:1024
  v_fma_f32 v88, v86, v62, v63
  v_fma_f32 v89, v87, v62, v63
  v_mfma_f32_16x16x32_bf16 v[40:43], v[192:195], v[144:147], v[40:43]
  v_fmac_f32 v86, v88, v90
  v_fmac_f32 v87, v89, v91
  v_cvt_pk_bf16_f32 v71, v86, v87
  s_waitcnt lgkmcnt(15)
  v_mfma_f32_16x16x32_bf16 v[36:39], v[224:227], v[172:175], v[36:39]
  ds_read_b128 v[144:147], v95 offset:2560
  s_mov_b32 s81, 1310720
  buffer_store_dwordx4 v[68:71], v100, s[36:39], s81 offen sc1
  v_mfma_f32_16x16x32_bf16 v[32:35], v[192:195], v[172:175], v[32:35]
  v_add_u32 v96, 124928, v96
  v_add_u32 v97, 124928, v97
  v_add_u32 v98, 124928, v98
  s_waitcnt lgkmcnt(15)
  v_mfma_f32_16x16x32_bf16 v[44:47], v[128:131], v[168:171], v[44:47]
  s_and_b32 s80, s2, 15
  s_lshl_b32 s80, s80, 7
  v_mfma_f32_16x16x32_bf16 v[40:43], v[224:227], v[168:171], v[40:43]
  s_add_u32 s80, s80, 155648
  v_add_u32 v122, s80, v111
  s_waitcnt lgkmcnt(14)
  v_mfma_f32_16x16x32_bf16 v[36:39], v[128:131], v[140:143], v[36:39]
  ds_read_b128 v[192:195], v95 offset:2624
  buffer_load_dword v123, v122, s[36:39], 0 offen sc1
  v_mfma_f32_16x16x32_bf16 v[32:35], v[224:227], v[140:143], v[32:35]
  s_waitcnt lgkmcnt(13)
  v_mfma_f32_16x16x32_bf16 v[44:47], v[132:135], v[220:223], v[44:47]
  ds_read_b128 v[224:227], v94 offset:1152
  v_mfma_f32_16x16x32_bf16 v[40:43], v[128:131], v[220:223], v[40:43]
  s_waitcnt lgkmcnt(13)
  v_mfma_f32_16x16x32_bf16 v[36:39], v[132:135], v[156:159], v[36:39]
  ds_read_b128 v[168:171], v95 offset:2720
  v_mfma_f32_16x16x32_bf16 v[32:35], v[128:131], v[156:159], v[32:35]
  s_waitcnt lgkmcnt(12)
  v_mfma_f32_16x16x32_bf16 v[44:47], v[204:207], v[176:179], v[44:47]
  ds_read_b128 v[128:131], v94 offset:1216
  v_mfma_f32_16x16x32_bf16 v[40:43], v[132:135], v[176:179], v[40:43]
  s_waitcnt lgkmcnt(12)
  v_mfma_f32_16x16x32_bf16 v[36:39], v[204:207], v[208:211], v[36:39]
  ds_read_b128 v[220:223], v95 offset:2784
  v_mfma_f32_16x16x32_bf16 v[32:35], v[132:135], v[208:211], v[32:35]
  s_waitcnt lgkmcnt(11)
  v_mfma_f32_16x16x32_bf16 v[44:47], v[180:183], v[152:155], v[44:47]
  ds_read_b128 v[132:135], v94 offset:1280
  v_mfma_f32_16x16x32_bf16 v[40:43], v[204:207], v[152:155], v[40:43]
  s_waitcnt lgkmcnt(11)
  v_mfma_f32_16x16x32_bf16 v[36:39], v[180:183], v[124:127], v[36:39]
  ds_read_b128 v[176:179], v95 offset:2880
  v_mfma_f32_16x16x32_bf16 v[32:35], v[204:207], v[124:127], v[32:35]
  s_waitcnt lgkmcnt(10)
  v_mfma_f32_16x16x32_bf16 v[44:47], v[164:167], v[216:219], v[44:47]
  ds_read_b128 v[204:207], v94 offset:1344
  v_mfma_f32_16x16x32_bf16 v[40:43], v[180:183], v[216:219], v[40:43]
  ds_read_b128 v[152:155], v95 offset:1664
  s_waitcnt lgkmcnt(11)
  v_mfma_f32_16x16x32_bf16 v[36:39], v[164:167], v[196:199], v[36:39]
  ds_read_b128 v[216:219], v95 offset:2944
  v_mfma_f32_16x16x32_bf16 v[32:35], v[180:183], v[196:199], v[32:35]
  s_waitcnt lgkmcnt(11)
  v_mfma_f32_16x16x32_bf16 v[44:47], v[200:203], v[160:163], v[44:47]
  ds_read_b128 v[180:183], v94 offset:1408
  v_mfma_f32_16x16x32_bf16 v[40:43], v[164:167], v[160:163], v[40:43]
  ds_read_b128 v[160:163], v95 offset:1760
  s_waitcnt lgkmcnt(12)
  v_mfma_f32_16x16x32_bf16 v[36:39], v[200:203], v[144:147], v[36:39]
  ds_read_b128 v[196:199], v95 offset:3040
  v_mfma_f32_16x16x32_bf16 v[32:35], v[164:167], v[144:147], v[32:35]
  v_mfma_f32_16x16x32_bf16 v[44:47], v[188:191], v[184:187], v[44:47]
  ds_read_b128 v[164:167], v94 offset:1472
  s_waitcnt vmcnt(0)
  v_cmp_gt_u32 vcc, 1, v123
  v_mfma_f32_16x16x32_bf16 v[40:43], v[200:203], v[184:187], v[40:43]
  ds_read_b128 v[184:187], v95 offset:1824
  s_and_b32 vcc_lo, vcc_lo, 0x1
  s_waitcnt lgkmcnt(14)
  v_mfma_f32_16x16x32_bf16 v[36:39], v[188:191], v[192:195], v[36:39]
  ds_read_b128 v[144:147], v95 offset:3104
  s_cbranch_scc1 L_cp_9
L_cpb_10:
  s_mov_b32 s86, 0
  v_mfma_f32_16x16x32_bf16 v[32:35], v[200:203], v[192:195], v[32:35]
  buffer_load_dwordx4 a[0:3], v251, s[36:39], s86 offen sc1
  s_waitcnt lgkmcnt(14)
  v_mfma_f32_16x16x32_bf16 v[44:47], v[224:227], v[148:151], v[44:47]
  ds_read_b128 v[200:203], v94 offset:1536
  v_mfma_f32_16x16x32_bf16 v[40:43], v[188:191], v[148:151], v[40:43]
  ds_read_b128 v[148:151], v95 offset:1920
  buffer_load_dwordx4 a[4:7], v252, s[36:39], s86 offen sc1
  s_waitcnt lgkmcnt(15)
  v_mfma_f32_16x16x32_bf16 v[36:39], v[224:227], v[168:171], v[36:39]
  ds_read_b128 v[192:195], v95 offset:3200
  v_mfma_f32_16x16x32_bf16 v[32:35], v[188:191], v[168:171], v[32:35]
  s_waitcnt lgkmcnt(15)
  v_mfma_f32_16x16x32_bf16 v[44:47], v[128:131], v[212:215], v[44:47]
  ds_read_b128 v[188:191], v94 offset:1600
  v_mfma_f32_16x16x32_bf16 v[40:43], v[224:227], v[212:215], v[40:43]
  s_waitcnt lgkmcnt(15)
  v_mfma_f32_16x16x32_bf16 v[36:39], v[128:131], v[220:223], v[36:39]
  ds_read_b128 v[212:215], v95 offset:3264
  buffer_load_dwordx4 a[8:11], v253, s[36:39], s86 offen sc1
  v_mfma_f32_16x16x32_bf16 v[32:35], v[224:227], v[220:223], v[32:35]
  s_waitcnt lgkmcnt(15)
  v_mfma_f32_16x16x32_bf16 v[44:47], v[132:135], v[228:231], v[44:47]
  ds_read_b128 v[224:227], v94 offset:1664
  v_mfma_f32_16x16x32_bf16 v[40:43], v[128:131], v[228:231], v[40:43]
  s_waitcnt lgkmcnt(15)
  v_mfma_f32_16x16x32_bf16 v[36:39], v[132:135], v[176:179], v[36:39]
  ds_read_b128 v[228:231], v95 offset:3360
  v_mfma_f32_16x16x32_bf16 v[32:35], v[128:131], v[176:179], v[32:35]
  buffer_load_dwordx4 a[12:15], v254, s[36:39], s86 offen sc1
  s_waitcnt lgkmcnt(14)
  v_mfma_f32_16x16x32_bf16 v[44:47], v[204:207], v[152:155], v[44:47]
  ds_read_b128 v[128:131], v94 offset:1728
  v_mfma_f32_16x16x32_bf16 v[40:43], v[132:135], v[152:155], v[40:43]
  s_waitcnt lgkmcnt(14)
  v_mfma_f32_16x16x32_bf16 v[36:39], v[204:207], v[216:219], v[36:39]
  ds_read_b128 v[152:155], v95 offset:3424
  v_mfma_f32_16x16x32_bf16 v[32:35], v[132:135], v[216:219], v[32:35]
  buffer_load_dwordx4 a[16:19], v255, s[36:39], s86 offen sc1
  s_waitcnt lgkmcnt(13)
  v_mfma_f32_16x16x32_bf16 v[44:47], v[180:183], v[160:163], v[44:47]
  ds_read_b128 v[132:135], v94 offset:1792
  v_mfma_f32_16x16x32_bf16 v[40:43], v[204:207], v[160:163], v[40:43]
  s_waitcnt lgkmcnt(13)
  v_mfma_f32_16x16x32_bf16 v[36:39], v[180:183], v[196:199], v[36:39]
  ds_read_b128 v[160:163], v95 offset:3520
  v_mfma_f32_16x16x32_bf16 v[32:35], v[204:207], v[196:199], v[32:35]
  s_waitcnt lgkmcnt(12)
  v_mfma_f32_16x16x32_bf16 v[44:47], v[164:167], v[184:187], v[44:47]
  ds_read_b128 v[204:207], v94 offset:1856
  s_mov_b32 s86, 5120
  buffer_load_dwordx4 a[20:23], v251, s[36:39], s86 offen sc1
  v_mfma_f32_16x16x32_bf16 v[40:43], v[180:183], v[184:187], v[40:43]
  s_waitcnt lgkmcnt(12)
  v_mfma_f32_16x16x32_bf16 v[36:39], v[164:167], v[144:147], v[36:39]
  ds_read_b128 v[184:187], v95 offset:3584
  v_mfma_f32_16x16x32_bf16 v[32:35], v[180:183], v[144:147], v[32:35]
  s_waitcnt lgkmcnt(11)
  v_mfma_f32_16x16x32_bf16 v[44:47], v[200:203], v[148:151], v[44:47]
  ds_read_b128 v[180:183], v94 offset:1920
  v_mfma_f32_16x16x32_bf16 v[40:43], v[164:167], v[148:151], v[40:43]
  buffer_load_dwordx4 a[24:27], v252, s[36:39], s86 offen sc1
  s_waitcnt lgkmcnt(11)
  v_mfma_f32_16x16x32_bf16 v[36:39], v[200:203], v[192:195], v[36:39]
  ds_read_b128 v[148:151], v95 offset:3680
  v_mfma_f32_16x16x32_bf16 v[32:35], v[164:167], v[192:195], v[32:35]
  s_waitcnt lgkmcnt(11)
  v_mfma_f32_16x16x32_bf16 v[44:47], v[188:191], v[136:139], v[44:47]
  ds_read_b128 v[164:167], v94 offset:1984
  v_mfma_f32_16x16x32_bf16 v[40:43], v[200:203], v[136:139], v[40:43]
  ds_read_b128 v[136:139], v95 offset:2464
  buffer_load_dwordx4 a[28:31], v253, s[36:39], s86 offen sc1
  s_waitcnt lgkmcnt(12)
  v_mfma_f32_16x16x32_bf16 v[36:39], v[188:191], v[212:215], v[36:39]
  ds_read_b128 v[192:195], v95 offset:3744
  v_mfma_f32_16x16x32_bf16 v[32:35], v[200:203], v[212:215], v[32:35]
  s_waitcnt lgkmcnt(12)
  v_mfma_f32_16x16x32_bf16 v[44:47], v[224:227], v[172:175], v[44:47]
  ds_read_b128 v[200:203], v94 offset:2048
  v_mfma_f32_16x16x32_bf16 v[40:43], v[188:191], v[172:175], v[40:43]
  ds_read_b128 v[172:175], v95 offset:2560
  s_waitcnt lgkmcnt(13)
  v_mfma_f32_16x16x32_bf16 v[36:39], v[224:227], v[228:231], v[36:39]
  ds_read_b128 v[212:215], v95 offset:3840
  buffer_load_dwordx4 a[32:35], v254, s[36:39], s86 offen sc1
  v_mfma_f32_16x16x32_bf16 v[32:35], v[188:191], v[228:231], v[32:35]
  s_waitcnt lgkmcnt(13)
  v_mfma_f32_16x16x32_bf16 v[44:47], v[128:131], v[140:143], v[44:47]
  ds_read_b128 v[188:191], v94 offset:2112
  v_mfma_f32_16x16x32_bf16 v[40:43], v[224:227], v[140:143], v[40:43]
  ds_read_b128 v[140:143], v95 offset:2624
  s_waitcnt lgkmcnt(14)
  v_mfma_f32_16x16x32_bf16 v[36:39], v[128:131], v[152:155], v[36:39]
  ds_read_b128 v[228:231], v95 offset:3904
  v_mfma_f32_16x16x32_bf16 v[32:35], v[224:227], v[152:155], v[32:35]
  buffer_load_dwordx4 a[36:39], v255, s[36:39], s86 offen sc1
  s_waitcnt lgkmcnt(14)
  v_mfma_f32_16x16x32_bf16 v[44:47], v[132:135], v[156:159], v[44:47]
  ds_read_b128 v[224:227], v94 offset:2176
  v_mfma_f32_16x16x32_bf16 v[40:43], v[128:131], v[156:159], v[40:43]
  s_waitcnt lgkmcnt(14)
  v_mfma_f32_16x16x32_bf16 v[36:39], v[132:135], v[160:163], v[36:39]
  ds_read_b128 v[156:159], v95 offset:4000
  v_mfma_f32_16x16x32_bf16 v[32:35], v[128:131], v[160:163], v[32:35]
  s_mov_b32 s86, 10240
  buffer_load_dwordx4 a[40:43], v251, s[36:39], s86 offen sc1
  s_waitcnt lgkmcnt(14)
  v_mfma_f32_16x16x32_bf16 v[44:47], v[204:207], v[208:211], v[44:47]
  ds_read_b128 v[128:131], v94 offset:2240
  v_mfma_f32_16x16x32_bf16 v[40:43], v[132:135], v[208:211], v[40:43]
  s_waitcnt lgkmcnt(14)
  v_mfma_f32_16x16x32_bf16 v[36:39], v[204:207], v[184:187], v[36:39]
  ds_read_b128 v[208:211], v95 offset:4064
  v_mfma_f32_16x16x32_bf16 v[32:35], v[132:135], v[184:187], v[32:35]
  s_waitcnt lgkmcnt(14)
  v_mfma_f32_16x16x32_bf16 v[44:47], v[180:183], v[124:127], v[44:47]
  ds_read_b128 v[132:135], v94 offset:2304
  buffer_load_dwordx4 a[44:47], v252, s[36:39], s86 offen sc1
  v_mfma_f32_16x16x32_bf16 v[40:43], v[204:207], v[124:127], v[40:43]
  s_waitcnt lgkmcnt(14)
  v_mfma_f32_16x16x32_bf16 v[36:39], v[180:183], v[148:151], v[36:39]
  ds_read_b128 v[124:127], v95 offset:4160
  v_mfma_f32_16x16x32_bf16 v[32:35], v[204:207], v[148:151], v[32:35]
  s_and_b32 s80, s2, 15
  s_lshl_b32 s81, s32, 4
  s_waitcnt lgkmcnt(13)
  v_mfma_f32_16x16x32_bf16 v[44:47], v[164:167], v[136:139], v[44:47]
  ds_read_b128 v[204:207], v94 offset:2368
  s_add_u32 s80, s80, s81
  v_mfma_f32_16x16x32_bf16 v[40:43], v[180:183], v[136:139], v[40:43]
  s_lshl_b32 s80, s80, 7
  s_add_u32 s80, s80, 16384
  s_waitcnt lgkmcnt(13)
  v_mfma_f32_16x16x32_bf16 v[36:39], v[164:167], v[192:195], v[36:39]
  ds_read_b128 v[136:139], v95 offset:4224
  s_cmp_ge_u32 s2, 160
  v_mfma_f32_16x16x32_bf16 v[32:35], v[180:183], v[192:195], v[32:35]
  s_cselect_b32 s81, 0x80000000, 0
  s_or_b32 s80, s80, s81
  s_waitcnt lgkmcnt(12)
  v_mfma_f32_16x16x32_bf16 v[44:47], v[200:203], v[172:175], v[44:47]
  ds_read_b128 v[180:183], v94 offset:2432
  v_or_b32 v122, s80, v111
  v_mfma_f32_16x16x32_bf16 v[40:43], v[164:167], v[172:175], v[40:43]
  v_mov_b32 v123, 1
  buffer_atomic_add v123, v122, s[36:39], 0 offen sc1
  buffer_load_dwordx4 a[48:51], v253, s[36:39], s86 offen sc1
  s_waitcnt lgkmcnt(12)
  v_mfma_f32_16x16x32_bf16 v[36:39], v[200:203], v[212:215], v[36:39]
  ds_read_b128 v[172:175], v95 offset:4320
  s_and_b32 s80, s2, 15
  v_mfma_f32_16x16x32_bf16 v[32:35], v[164:167], v[212:215], v[32:35]
  s_lshl_b32 s80, s80, 7
  s_add_u32 s80, s80, 157696
  s_waitcnt lgkmcnt(11)
  v_mfma_f32_16x16x32_bf16 v[44:47], v[188:191], v[140:143], v[44:47]
  ds_read_b128 v[164:167], v94 offset:2496
  v_add_u32 v122, s80, v111
  v_mfma_f32_16x16x32_bf16 v[40:43], v[200:203], v[140:143], v[40:43]
  buffer_load_dword v123, v122, s[36:39], 0 offen sc1
  buffer_load_dwordx4 a[52:55], v254, s[36:39], s86 offen sc1
  s_waitcnt lgkmcnt(11)
  v_mfma_f32_16x16x32_bf16 v[36:39], v[188:191], v[228:231], v[36:39]
  ds_read_b128 v[140:143], v95 offset:4384
  buffer_load_dwordx4 a[56:59], v255, s[36:39], s86 offen sc1
  v_mfma_f32_16x16x32_bf16 v[32:35], v[200:203], v[228:231], v[32:35]
  s_waitcnt lgkmcnt(11)
  v_mfma_f32_16x16x32_bf16 v[44:47], v[224:227], v[168:171], v[44:47]
  ds_read_b128 v[200:203], v94 offset:2560
  v_mfma_f32_16x16x32_bf16 v[40:43], v[188:191], v[168:171], v[40:43]
  ds_read_b128 v[168:171], v95 offset:3200
  s_waitcnt lgkmcnt(12)
  v_mfma_f32_16x16x32_bf16 v[36:39], v[224:227], v[156:159], v[36:39]
  ds_read_b128 v[228:231], v95 offset:4480
  v_mfma_f32_16x16x32_bf16 v[32:35], v[188:191], v[156:159], v[32:35]
  s_mov_b32 s86, 15360
  buffer_load_dwordx4 a[60:63], v251, s[36:39], s86 offen sc1
  s_waitcnt lgkmcnt(12)
  v_mfma_f32_16x16x32_bf16 v[44:47], v[128:131], v[220:223], v[44:47]
  ds_read_b128 v[188:191], v94 offset:2624
  v_mfma_f32_16x16x32_bf16 v[40:43], v[224:227], v[220:223], v[40:43]
  ds_read_b128 v[220:223], v95 offset:3264
  s_waitcnt lgkmcnt(13)
  v_mfma_f32_16x16x32_bf16 v[36:39], v[128:131], v[208:211], v[36:39]
  ds_read_b128 v[156:159], v95 offset:4544
  v_mfma_f32_16x16x32_bf16 v[32:35], v[224:227], v[208:211], v[32:35]
  s_waitcnt lgkmcnt(13)
  v_mfma_f32_16x16x32_bf16 v[44:47], v[132:135], v[176:179], v[44:47]
  ds_read_b128 v[224:227], v94 offset:2688
  buffer_load_dwordx4 a[64:67], v252, s[36:39], s86 offen sc1
  v_mfma_f32_16x16x32_bf16 v[40:43], v[128:131], v[176:179], v[40:43]
  ds_read_b128 v[176:179], v95 offset:3360
  s_waitcnt lgkmcnt(14)
  v_mfma_f32_16x16x32_bf16 v[36:39], v[132:135], v[124:127], v[36:39]
  ds_read_b128 v[208:211], v95 offset:4640
  v_mfma_f32_16x16x32_bf16 v[32:35], v[128:131], v[124:127], v[32:35]
  s_waitcnt lgkmcnt(14)
  v_mfma_f32_16x16x32_bf16 v[44:47], v[204:207], v[216:219], v[44:47]
  ds_read_b128 v[128:131], v94 offset:2752
  s_mov_b32 s80, 1310720
  v_mfma_f32_16x16x32_bf16 v[40:43], v[132:135], v[216:219], v[40:43]
  buffer_load_dwordx4 v[48:51], v99, s[36:39], s80 offen sc1
  s_mov_b32 s80, 8192
  s_waitcnt lgkmcnt(14)
  v_mfma_f32_16x16x32_bf16 v[36:39], v[204:207], v[136:139], v[36:39]
  ds_read_b128 v[216:219], v95 offset:4704
  buffer_load_dwordx4 v[52:55], v101, s[36:39], s80 offen sc1
  v_mfma_f32_16x16x32_bf16 v[32:35], v[132:135], v[136:139], v[32:35]
  s_mov_b32 s80, 1966080
  buffer_load_dwordx4 v[56:59], v99, s[36:39], s80 offen sc1
  s_waitcnt lgkmcnt(14)
  v_mfma_f32_16x16x32_bf16 v[44:47], v[180:183], v[196:199], v[44:47]
  ds_read_b128 v[132:135], v94 offset:2816
  s_mov_b32 s80, 12288
  v_mfma_f32_16x16x32_bf16 v[40:43], v[204:207], v[196:199], v[40:43]
  buffer_load_dwordx4 v[60:63], v101, s[36:39], s80 offen sc1
  buffer_load_dwordx4 a[68:71], v253, s[36:39], s86 offen sc1
  buffer_load_dwordx4 a[72:75], v254, s[36:39], s86 offen sc1
  s_waitcnt lgkmcnt(14)
  v_mfma_f32_16x16x32_bf16 v[36:39], v[180:183], v[172:175], v[36:39]
  ds_read_b128 v[196:199], v95 offset:4800
  v_mfma_f32_16x16x32_bf16 v[32:35], v[204:207], v[172:175], v[32:35]
  s_waitcnt lgkmcnt(14)
  v_mfma_f32_16x16x32_bf16 v[44:47], v[164:167], v[144:147], v[44:47]
  ds_read_b128 v[204:207], v94 offset:2880
  v_mfma_f32_16x16x32_bf16 v[40:43], v[180:183], v[144:147], v[40:43]
  s_waitcnt lgkmcnt(14)
  v_mfma_f32_16x16x32_bf16 v[36:39], v[164:167], v[140:143], v[36:39]
  ds_read_b128 v[144:147], v95 offset:4864
  buffer_load_dwordx4 a[76:79], v255, s[36:39], s86 offen sc1
  v_mfma_f32_16x16x32_bf16 v[32:35], v[180:183], v[140:143], v[32:35]
  s_waitcnt lgkmcnt(13)
  v_mfma_f32_16x16x32_bf16 v[44:47], v[200:203], v[168:171], v[44:47]
  ds_read_b128 v[180:183], v94 offset:2944
  v_mfma_f32_16x16x32_bf16 v[40:43], v[164:167], v[168:171], v[40:43]
  s_waitcnt lgkmcnt(13)
  v_mfma_f32_16x16x32_bf16 v[36:39], v[200:203], v[228:231], v[36:39]
  ds_read_b128 v[168:171], v95 offset:4960
  s_mov_b32 s86, 20480
  buffer_load_dwordx4 a[80:83], v251, s[36:39], s86 offen sc1
  v_mfma_f32_16x16x32_bf16 v[32:35], v[164:167], v[228:231], v[32:35]
  s_waitcnt lgkmcnt(12)
  v_mfma_f32_16x16x32_bf16 v[44:47], v[188:191], v[220:223], v[44:47]
  ds_read_b128 v[164:167], v94 offset:3008
  v_mfma_f32_16x16x32_bf16 v[40:43], v[200:203], v[220:223], v[40:43]
  s_waitcnt lgkmcnt(12)
  v_mfma_f32_16x16x32_bf16 v[36:39], v[188:191], v[156:159], v[36:39]
  ds_read_b128 v[220:223], v95 offset:5024
  v_mfma_f32_16x16x32_bf16 v[32:35], v[200:203], v[156:159], v[32:35]
  buffer_load_dwordx4 a[84:87], v252, s[36:39], s86 offen sc1
  s_waitcnt lgkmcnt(11)
  v_mfma_f32_16x16x32_bf16 v[44:47], v[224:227], v[176:179], v[44:47]
  ds_read_b128 v[200:203], v94 offset:3072
  s_waitcnt vmcnt(13)
  v_cmp_gt_u32 vcc, 54, v123
  v_mfma_f32_16x16x32_bf16 v[40:43], v[188:191], v[176:179], v[40:43]
  s_and_b32 vcc_lo, vcc_lo, 0x1
  s_cbranch_scc1 L_cp_7
L_cpb_8:
  s_waitcnt lgkmcnt(11)
  v_mfma_f32_16x16x32_bf16 v[36:39], v[224:227], v[208:211], v[36:39]
  ds_read_b128 v[176:179], v94 offset:3136
  v_mfma_f32_16x16x32_bf16 v[32:35], v[188:191], v[208:211], v[32:35]
  ds_read_b128 v[188:191], v95 offset:3904
  s_add_u32 m0, s89, 135168
  s_mov_b32 s88, 0
  buffer_load_dwordx4 v109, s[36:39], s88 offen sc1 lds
  s_waitcnt lgkmcnt(12)
  v_mfma_f32_16x16x32_bf16 v[44:47], v[128:131], v[152:155], v[44:47]
  ds_read_b128 v[208:211], v94 offset:3200
  buffer_load_dwordx4 a[88:91], v253, s[36:39], s86 offen sc1
  v_mfma_f32_16x16x32_bf16 v[40:43], v[224:227], v[152:155], v[40:43]
  ds_read_b128 v[152:155], v95 offset:4000
  s_waitcnt lgkmcnt(13)
  v_mfma_f32_16x16x32_bf16 v[36:39], v[128:131], v[216:219], v[36:39]
  ds_read_b128 v[156:159], v94 offset:3264
  v_mfma_f32_16x16x32_bf16 v[32:35], v[224:227], v[216:219], v[32:35]
  ds_read_b128 v[224:227], v95 offset:4064
  s_add_u32 m0, s89, 136192
  s_mov_b32 s88, 128
  buffer_load_dwordx4 v109, s[36:39], s88 offen sc1 lds
  s_waitcnt lgkmcnt(14)
  v_mfma_f32_16x16x32_bf16 v[44:47], v[132:135], v[160:163], v[44:47]
  ds_read_b128 v[216:219], v94 offset:3328
  v_mfma_f32_16x16x32_bf16 v[40:43], v[128:131], v[160:163], v[40:43]
  buffer_load_dwordx4 a[92:95], v254, s[36:39], s86 offen sc1
  s_waitcnt lgkmcnt(14)
  v_mfma_f32_16x16x32_bf16 v[36:39], v[132:135], v[196:199], v[36:39]
  ds_read_b128 v[160:163], v94 offset:3392
  v_mfma_f32_16x16x32_bf16 v[32:35], v[128:131], v[196:199], v[32:35]
  s_add_u32 m0, s89, 137216
  s_mov_b32 s88, 40960
  buffer_load_dwordx4 v109, s[36:39], s88 offen sc1 lds
  s_waitcnt lgkmcnt(14)
  v_mfma_f32_16x16x32_bf16 v[44:47], v[204:207], v[184:187], v[44:47]
  ds_read_b128 v[128:131], v94 offset:3456
  v_mfma_f32_16x16x32_bf16 v[40:43], v[132:135], v[184:187], v[40:43]
  buffer_load_dwordx4 a[96:99], v255, s[36:39], s86 offen sc1
  s_waitcnt lgkmcnt(14)
  v_mfma_f32_16x16x32_bf16 v[36:39], v[204:207], v[144:147], v[36:39]
  ds_read_b128 v[184:187], v94 offset:3520
  v_mfma_f32_16x16x32_bf16 v[32:35], v[132:135], v[144:147], v[32:35]
  s_add_u32 m0, s89, 138240
  s_mov_b32 s88, 41088
  buffer_load_dwordx4 v109, s[36:39], s88 offen sc1 lds
  s_waitcnt lgkmcnt(14)
  v_mfma_f32_16x16x32_bf16 v[44:47], v[180:183], v[148:151], v[44:47]
  ds_read_b128 v[132:135], v94 offset:3584
  v_mfma_f32_16x16x32_bf16 v[40:43], v[204:207], v[148:151], v[40:43]
  s_waitcnt lgkmcnt(14)
  v_mfma_f32_16x16x32_bf16 v[36:39], v[180:183], v[168:171], v[36:39]
  ds_read_b128 v[148:151], v94 offset:3648
  s_mov_b32 s86, 25600
  buffer_load_dwordx4 a[100:103], v251, s[36:39], s86 offen sc1
  v_mfma_f32_16x16x32_bf16 v[32:35], v[204:207], v[168:171], v[32:35]
  ds_read_b128 v[204:207], v95 offset:4544
  s_add_u32 m0, s89, 139264
  s_mov_b32 s88, 81920
  buffer_load_dwordx4 v109, s[36:39], s88 offen sc1 lds
  s_waitcnt lgkmcnt(15)
  v_mfma_f32_16x16x32_bf16 v[44:47], v[164:167], v[192:195], v[44:47]
  ds_read_b128 v[168:171], v94 offset:3712
  v_mfma_f32_16x16x32_bf16 v[40:43], v[180:183], v[192:195], v[40:43]
  ds_read_b128 v[192:195], v95 offset:4640
  s_waitcnt lgkmcnt(15)
  v_mfma_f32_16x16x32_bf16 v[36:39], v[164:167], v[220:223], v[36:39]
  ds_read_b128 v[144:147], v94 offset:3776
  v_mfma_f32_16x16x32_bf16 v[32:35], v[180:183], v[220:223], v[32:35]
  ds_read_b128 v[180:183], v95 offset:4704
  s_add_u32 m0, s89, 140288
  s_mov_b32 s88, 82048
  buffer_load_dwordx4 v109, s[36:39], s88 offen sc1 lds
  s_waitcnt lgkmcnt(15)
  v_mfma_f32_16x16x32_bf16 v[44:47], v[200:203], v[212:215], v[44:47]
  ds_read_b128 v[220:223], v94 offset:3840
  buffer_load_dwordx4 a[104:107], v252, s[36:39], s86 offen sc1
  v_mfma_f32_16x16x32_bf16 v[40:43], v[164:167], v[212:215], v[40:43]
  s_waitcnt lgkmcnt(15)
  v_mfma_f32_16x16x32_bf16 v[44:47], v[176:179], v[188:191], v[44:47]
  ds_read_b128 v[212:215], v94 offset:3904
  v_mfma_f32_16x16x32_bf16 v[40:43], v[200:203], v[188:191], v[40:43]
  ds_read_b128 v[164:167], v95 offset:4864
  s_add_u32 m0, s89, 141312
  s_mov_b32 s88, 122880
  buffer_load_dwordx4 v110, s[36:39], s88 offen sc1 lds
  s_waitcnt lgkmcnt(15)
  v_mfma_f32_16x16x32_bf16 v[44:47], v[208:211], v[152:155], v[44:47]
  ds_read_b128 v[200:203], v94 offset:3968
  buffer_load_dwordx4 a[108:111], v253, s[36:39], s86 offen sc1
  v_mfma_f32_16x16x32_bf16 v[40:43], v[176:179], v[152:155], v[40:43]
  ds_read_b128 v[176:179], v95 offset:4960
  s_waitcnt lgkmcnt(15)
  v_mfma_f32_16x16x32_bf16 v[44:47], v[156:159], v[224:227], v[44:47]
  ds_read_b128 v[188:191], v94 offset:4032
  v_mfma_f32_16x16x32_bf16 v[40:43], v[208:211], v[224:227], v[40:43]
  ds_read_b128 v[208:211], v95 offset:5024
  s_waitcnt lgkmcnt(15)
  v_mfma_f32_16x16x32_bf16 v[44:47], v[216:219], v[124:127], v[44:47]
  buffer_load_dwordx4 a[112:115], v254, s[36:39], s86 offen sc1
  v_mfma_f32_16x16x32_bf16 v[40:43], v[156:159], v[124:127], v[40:43]
  s_waitcnt lgkmcnt(15)
  v_mfma_f32_16x16x32_bf16 v[44:47], v[160:163], v[136:139], v[44:47]
  v_mfma_f32_16x16x32_bf16 v[40:43], v[216:219], v[136:139], v[40:43]
  s_and_b32 s80, s90, 3
  s_lshl_b32 s80, s80, 2
  s_waitcnt lgkmcnt(15)
  v_mfma_f32_16x16x32_bf16 v[44:47], v[128:131], v[172:175], v[44:47]
  s_add_u32 s80, s80, s32
  s_lshl_b32 s80, s80, 9
  v_mfma_f32_16x16x32_bf16 v[40:43], v[160:163], v[172:175], v[40:43]
  s_add_u32 s80, s80, 16384
  v_and_b32 v122, 0x80000180, v102
  s_waitcnt lgkmcnt(14)
  v_mfma_f32_16x16x32_bf16 v[44:47], v[184:187], v[140:143], v[44:47]
  v_add_u32 v122, s80, v122
  buffer_load_dword v123, v122, s[36:39], 0 offen sc1
  buffer_load_dwordx4 a[116:119], v255, s[36:39], s86 offen sc1
  v_mfma_f32_16x16x32_bf16 v[40:43], v[128:131], v[140:143], v[40:43]
  s_waitcnt lgkmcnt(13)
  v_mfma_f32_16x16x32_bf16 v[44:47], v[132:135], v[228:231], v[44:47]
  v_mfma_f32_16x16x32_bf16 v[40:43], v[184:187], v[228:231], v[40:43]
  s_mov_b32 s86, 30720
  buffer_load_dwordx4 a[120:123], v251, s[36:39], s86 offen sc1
  s_waitcnt lgkmcnt(11)
  v_mfma_f32_16x16x32_bf16 v[44:47], v[148:151], v[204:207], v[44:47]
  v_mfma_f32_16x16x32_bf16 v[40:43], v[132:135], v[204:207], v[40:43]
  s_waitcnt lgkmcnt(9)
  v_mfma_f32_16x16x32_bf16 v[44:47], v[168:171], v[192:195], v[44:47]
  v_mfma_f32_16x16x32_bf16 v[40:43], v[148:151], v[192:195], v[40:43]
  s_waitcnt lgkmcnt(7)
  v_mfma_f32_16x16x32_bf16 v[44:47], v[144:147], v[180:183], v[44:47]
  buffer_load_dwordx4 a[124:127], v252, s[36:39], s86 offen sc1
  v_mfma_f32_16x16x32_bf16 v[40:43], v[168:171], v[180:183], v[40:43]
  s_waitcnt lgkmcnt(6)
  v_mfma_f32_16x16x32_bf16 v[44:47], v[220:223], v[196:199], v[44:47]
  v_mfma_f32_16x16x32_bf16 v[40:43], v[144:147], v[196:199], v[40:43]
  s_waitcnt lgkmcnt(4)
  v_mfma_f32_16x16x32_bf16 v[44:47], v[212:215], v[164:167], v[44:47]
  v_mfma_f32_16x16x32_bf16 v[40:43], v[220:223], v[164:167], v[40:43]
  buffer_load_dwordx4 a[128:131], v253, s[36:39], s86 offen sc1
  s_waitcnt lgkmcnt(2)
  v_mfma_f32_16x16x32_bf16 v[44:47], v[200:203], v[176:179], v[44:47]
  v_mfma_f32_16x16x32_bf16 v[40:43], v[212:215], v[176:179], v[40:43]
  s_waitcnt lgkmcnt(0)
  v_mfma_f32_16x16x32_bf16 v[44:47], v[188:191], v[208:211], v[44:47]
  v_mfma_f32_16x16x32_bf16 v[40:43], v[200:203], v[208:211], v[40:43]
  v_cvt_pk_bf16_f32 v64, v32, v34
  v_cvt_pk_bf16_f32 v65, v33, v35
  ds_write2_b32 v96, v64, v65 offset0:0 offset1:32
  v_cvt_pk_bf16_f32 v66, v36, v38
  v_cvt_pk_bf16_f32 v67, v37, v39
  ds_write2_b32 v96, v66, v67 offset0:8 offset1:40
  s_nop 1
  v_cvt_pk_bf16_f32 v68, v40, v42
  v_cvt_pk_bf16_f32 v69, v41, v43
  ds_write2_b32 v97, v68, v69 offset0:0 offset1:32
  v_cvt_pk_bf16_f32 v70, v44, v46
  v_cvt_pk_bf16_f32 v71, v45, v47
  ds_write2_b32 v97, v70, v71 offset0:8 offset1:40
  s_mov_b32 s42, 0x00800000
  s_mov_b32 s43, 0x00020000
  s_mov_b32 s46, 0x00800000
  s_mov_b32 s47, 0x00020000
  s_add_u32 s40, s28, 0x1200000
  s_addc_u32 s41, s29, 0
  v_and_b32 v212, 15, v1
  v_lshrrev_b32 v213, 4, v1
  v_lshlrev_b32 v14, 4, v1
  v_lshlrev_b32 v212, 4, v212
  v_lshl_add_u32 v214, v213, 11, v212
  s_lshl_b32 s80, s32, 8
  s_mul_i32 s81, s90, 327680
  s_add_u32 s81, s81, s80
  v_add_u32 v2, s81, v214
  s_waitcnt vmcnt(7)
  s_waitcnt lgkmcnt(0)
  s_waitcnt vmcnt(4)
  v_cmp_gt_u32 vcc, 10, v123
  s_nop 0
  s_and_b32 vcc_lo, vcc_lo, 0xf
  s_cbranch_scc1 L_cp_11
L_cpb_12:
  s_barrier
  buffer_load_dwordx4 v[128:131], v2, s[40:43], s60 offen sc1
  ds_read_b64_tr_b16 v[72:73], v98 offset:0
  ds_read_b64_tr_b16 v[74:75], v98 offset:128
  ds_read_b64_tr_b16 v[76:77], v98 offset:1024
  ds_read_b64_tr_b16 v[78:79], v98 offset:1152
  s_mov_b32 s80, 3309568
  s_waitcnt lgkmcnt(2)
  buffer_store_dwordx4 v[72:75], v100, s[36:39], s80 offen sc1
  v_lshlrev_b32 v80, 16, v48
  v_and_b32 v81, 0xffff0000, v48
  v_lshlrev_b32 v84, 16, v72
  buffer_load_dwordx4 v[132:135], v2, s[40:43], s60 offen offset:1024 sc1
  v_and_b32 v85, 0xffff0000, v72
  v_fma_f32 v82, v80, v52, v53
  v_fma_f32 v83, v81, v52, v53
  v_fmac_f32 v80, v82, v84
  v_fmac_f32 v81, v83, v85
  v_cvt_pk_bf16_f32 v64, v80, v81
  v_lshlrev_b32 v86, 16, v49
  v_and_b32 v87, 0xffff0000, v49
  v_lshlrev_b32 v90, 16, v73
  buffer_load_dwordx4 v[136:139], v2, s[40:43], s61 offen sc1
  v_and_b32 v91, 0xffff0000, v73
  v_fma_f32 v88, v86, v52, v53
  v_fma_f32 v89, v87, v52, v53
  v_fmac_f32 v86, v88, v90
  v_fmac_f32 v87, v89, v91
  v_cvt_pk_bf16_f32 v65, v86, v87
  v_lshlrev_b32 v80, 16, v50
  v_and_b32 v81, 0xffff0000, v50
  v_lshlrev_b32 v84, 16, v74
  buffer_load_dwordx4 v[140:143], v2, s[40:43], s61 offen offset:1024 sc1
  v_and_b32 v85, 0xffff0000, v74
  v_fma_f32 v82, v80, v54, v55
  v_fma_f32 v83, v81, v54, v55
  v_fmac_f32 v80, v82, v84
  v_fmac_f32 v81, v83, v85
  v_cvt_pk_bf16_f32 v66, v80, v81
  v_lshlrev_b32 v86, 16, v51
  v_and_b32 v87, 0xffff0000, v51
  v_lshlrev_b32 v90, 16, v75
  s_add_u32 m0, s89, 20480
  s_mov_b32 s88, 4096
  buffer_load_dwordx4 v109, s[36:39], s88 offen sc1 lds
  v_and_b32 v91, 0xffff0000, v75
  v_fma_f32 v88, v86, v54, v55
  v_fma_f32 v89, v87, v54, v55
  v_fmac_f32 v86, v88, v90
  v_fmac_f32 v87, v89, v91
  v_cvt_pk_bf16_f32 v67, v86, v87
  s_mov_b32 s81, 163840
  buffer_store_dwordx4 v[64:67], v100, s[36:39], s81 offen sc1
  s_mov_b32 s80, 4620288
  buffer_load_dwordx4 v[144:147], v2, s[40:43], s62 offen sc1
  s_waitcnt lgkmcnt(0)
  buffer_store_dwordx4 v[76:79], v100, s[36:39], s80 offen sc1
  v_lshlrev_b32 v80, 16, v56
  v_and_b32 v81, 0xffff0000, v56
  v_lshlrev_b32 v84, 16, v76
  v_and_b32 v85, 0xffff0000, v76
  v_fma_f32 v82, v80, v60, v61
  v_fma_f32 v83, v81, v60, v61
  v_fmac_f32 v80, v82, v84
  v_fmac_f32 v81, v83, v85
  s_add_u32 m0, s89, 21504
  s_mov_b32 s88, 4224
  buffer_load_dwordx4 v109, s[36:39], s88 offen sc1 lds
  v_cvt_pk_bf16_f32 v68, v80, v81
  v_lshlrev_b32 v86, 16, v57
  v_and_b32 v87, 0xffff0000, v57
  v_lshlrev_b32 v90, 16, v77
  v_and_b32 v91, 0xffff0000, v77
  v_fma_f32 v88, v86, v60, v61
  v_fma_f32 v89, v87, v60, v61
  v_fmac_f32 v86, v88, v90
  v_fmac_f32 v87, v89, v91
  buffer_load_dwordx4 v[148:151], v2, s[40:43], s62 offen offset:1024 sc1
  v_cvt_pk_bf16_f32 v69, v86, v87
  v_lshlrev_b32 v80, 16, v58
  v_and_b32 v81, 0xffff0000, v58
  v_lshlrev_b32 v84, 16, v78
  v_and_b32 v85, 0xffff0000, v78
  v_fma_f32 v82, v80, v62, v63
  v_fma_f32 v83, v81, v62, v63
  v_fmac_f32 v80, v82, v84
  v_fmac_f32 v81, v83, v85
  s_add_u32 m0, s89, 22528
  s_mov_b32 s88, 45056
  buffer_load_dwordx4 v109, s[36:39], s88 offen sc1 lds
  v_cvt_pk_bf16_f32 v70, v80, v81
  v_lshlrev_b32 v86, 16, v59
  v_and_b32 v87, 0xffff0000, v59
  v_lshlrev_b32 v90, 16, v79
  v_and_b32 v91, 0xffff0000, v79
  v_fma_f32 v88, v86, v62, v63
  v_fma_f32 v89, v87, v62, v63
  v_fmac_f32 v86, v88, v90
  v_fmac_f32 v87, v89, v91
  buffer_load_dwordx4 v[152:155], v2, s[40:43], s63 offen sc1
  v_cvt_pk_bf16_f32 v71, v86, v87
  s_mov_b32 s81, 1474560
  buffer_store_dwordx4 v[68:71], v100, s[36:39], s81 offen sc1
  s_lshl_b32 s80, s32, 8
  s_mul_i32 s81, s32, 114688
  s_lshl_b32 s82, s100, 8
  s_add_u32 s81, s81, s82
  s_mul_i32 s83, s30, 917504
  s_add_u32 s81, s81, s83
  s_add_u32 m0, s89, 23552
  s_mov_b32 s88, 45184
  buffer_load_dwordx4 v109, s[36:39], s88 offen sc1 lds
  v_add_u32 v3, s81, v214
  s_cmp_eq_u32 s32, 3
  s_cselect_b32 s81, 0x80000000, 0
  v_or_b32 v15, s81, v3
  v_add_u32 v5, 20480, v14
  v_add_u32 v6, 84992, v14
  v_add_u32 v7, 149504, v14
  s_lshl_b32 s81, s95, 11
  s_add_u32 s81, s81, s80
  buffer_load_dwordx4 v[156:159], v2, s[40:43], s63 offen offset:1024 sc1
  s_mul_i32 s83, s90, 917504
  s_add_u32 s81, s81, s83
  v_lshl_add_u32 v214, v213, 10, v212
  v_add_u32 v8, s81, v214
  s_add_u32 s81, s81, 12288
  s_cmp_lt_u32 s91, 24
  s_cselect_b32 s81, s81, 0x80000000
  v_lshrrev_b32 v215, 1, v213
  v_lshl_add_u32 v9, v215, 10, v212
  s_add_u32 m0, s89, 24576
  s_mov_b32 s88, 86016
  buffer_load_dwordx4 v109, s[36:39], s88 offen sc1 lds
  v_and_b32 v215, 1, v213
  v_lshl_add_u32 v9, v215, 3, v9
  v_add_u32 v9, s81, v9
  s_mul_i32 s81, s101, 20480
  s_add_u32 s81, s81, s82
  s_mul_i32 s83, s30, 327680
  s_add_u32 s81, s81, s83
  s_lshl_b32 s83, s32, 12
  s_add_u32 s83, s83, s81
  buffer_load_dwordx4 v[160:163], v2, s[40:43], s64 offen sc1
  v_add_u32 v10, s83, v214
  s_lshl_b32 s83, s32, 10
  s_add_u32 s81, s81, s83
  s_add_u32 s81, s81, 16384
  v_lshl_add_u32 v4, v213, 2, v212
  v_add_u32 v4, s81, v4
  s_lshl_b32 s81, s90, 12
  s_add_u32 s81, s81, s80
  s_add_u32 s81, s81, 0x2a00000
  s_add_u32 m0, s89, 25600
  s_mov_b32 s88, 86144
  buffer_load_dwordx4 v109, s[36:39], s88 offen sc1 lds
  v_add_u32 v12, s81, v212
  s_lshl_b32 s81, s30, 14
  s_lshl_b32 s83, s100, 11
  s_add_u32 s81, s81, s83
  s_add_u32 s81, s81, 0x2a80000
  v_lshl_add_u32 v13, v213, 9, v212
  v_add_u32 v13, s81, v13
  v_mov_b32 v206, 0x80000000
  v_lshlrev_b32 v11, 7, v1
  buffer_load_dwordx4 v[164:167], v2, s[40:43], s64 offen offset:1024 sc1
  v_cmp_gt_u32 vcc, 16, v1
  s_nop 1
  v_cndmask_b32 v11, v206, v11, vcc
  v_cmp_eq_u32 vcc, 0, v1
  s_nop 1
  v_cndmask_b32 v206, v206, 0, vcc
  s_add_u32 m0, s89, 26624
  s_mov_b32 s88, 126976
  buffer_load_dwordx4 v110, s[36:39], s88 offen sc1 lds
L_g1:
  ds_read_b128 v[176:179], v6 offset:50176
  ds_read_b128 v[180:183], v6 offset:51200
  ds_read_b128 v[184:187], v6 offset:52224
  ds_read_b128 v[188:191], v6 offset:53248
  ds_read_b128 v[192:195], v6 offset:54272
  s_waitcnt vmcnt(18)
  v_swap_b32 v130, v132
  v_swap_b32 v131, v133
  s_waitcnt lgkmcnt(4)
  s_nop 0
  v_mfma_f32_16x16x32_bf16 v[16:19], v[176:179], v[128:131], 0
  ds_read_b128 v[196:199], v6 offset:55296
  s_lshr_b32 s80, s32, 1
  s_mul_i32 s81, s80, 81920
  v_mfma_f32_16x16x32_bf16 v[20:23], v[176:179], v[132:135], 0
  buffer_load_dwordx4 v[168:171], v2, s[40:43], s65 offen sc1
  buffer_load_dwordx4 v[172:175], v2, s[40:43], s65 offen offset:1024 sc1
  s_and_b32 s82, s32, 1
  s_waitcnt lgkmcnt(4)
  v_mfma_f32_16x16x32_bf16 v[24:27], v[180:183], v[128:131], 0
  ds_read_b128 v[176:179], v6 offset:56320
  s_lshl_b32 s82, s82, 4
  s_lshl_b32 s83, s91, 5
  v_mfma_f32_16x16x32_bf16 v[28:31], v[180:183], v[132:135], 0
  s_add_u32 s82, s82, s83
  s_add_u32 s81, s81, s82
  s_mul_i32 s83, s90, 327680
  s_waitcnt lgkmcnt(4)
  v_mfma_f32_16x16x32_bf16 v[32:35], v[184:187], v[128:131], 0
  ds_read_b128 v[180:183], v6 offset:57344
  s_add_u32 s81, s81, s83
  s_add_u32 s81, s81, 0x1200000
  v_mfma_f32_16x16x32_bf16 v[36:39], v[184:187], v[132:135], 0
  v_lshl_add_u32 v224, v1, 10, s81
  v_lshl_add_u32 v225, v11, 3, s81
  v_and_b32 v226, 0x80000000, v11
  s_waitcnt lgkmcnt(4)
  v_mfma_f32_16x16x32_bf16 v[40:43], v[188:191], v[128:131], 0
  ds_read_b128 v[184:187], v6 offset:58368
  v_or_b32 v225, v226, v225
  buffer_load_dwordx4 v[216:219], v224, s[36:39], 0 offen sc1
  v_mfma_f32_16x16x32_bf16 v[44:47], v[188:191], v[132:135], 0
  buffer_load_dwordx4 v[220:223], v225, s[36:39], s68 offen sc1
  s_lshl_b32 s80, s80, 10
  s_add_u32 s80, s80, s82
  s_waitcnt lgkmcnt(4)
  v_mfma_f32_16x16x32_bf16 v[48:51], v[192:195], v[128:131], 0
  ds_read_b128 v[188:191], v6 offset:59392
  s_lshl_b32 s81, s90, 12
  s_add_u32 s80, s80, s81
  v_mfma_f32_16x16x32_bf16 v[52:55], v[192:195], v[132:135], 0
  s_waitcnt vmcnt(20)
  v_swap_b32 v138, v140
  v_swap_b32 v139, v141
  s_add_u32 s85, s80, 0x2a00000
  s_waitcnt lgkmcnt(4)
  v_mfma_f32_16x16x32_bf16 v[56:59], v[196:199], v[128:131], 0
  ds_read_b128 v[192:195], v6 offset:60416
  v_mfma_f32_16x16x32_bf16 v[60:63], v[196:199], v[132:135], 0
  s_waitcnt lgkmcnt(4)
  v_mfma_f32_16x16x32_bf16 v[64:67], v[176:179], v[128:131], 0
  ds_read_b128 v[196:199], v6 offset:61440
  v_mfma_f32_16x16x32_bf16 v[68:71], v[176:179], v[132:135], 0
  s_waitcnt lgkmcnt(4)
  v_mfma_f32_16x16x32_bf16 v[16:19], v[180:183], v[136:139], v[16:19]
  ds_read_b128 v[176:179], v6 offset:62464
  s_add_u32 m0, s89, 49152
  s_mov_b32 s88, 8192
  buffer_load_dwordx4 v109, s[36:39], s88 offen sc1 lds
  v_mfma_f32_16x16x32_bf16 v[20:23], v[180:183], v[140:143], v[20:23]
  buffer_load_dwordx4 v[128:131], v2, s[40:43], s66 offen sc1
  buffer_load_dwordx4 v[132:135], v2, s[40:43], s66 offen offset:1024 sc1
  s_waitcnt lgkmcnt(4)
  v_mfma_f32_16x16x32_bf16 v[24:27], v[184:187], v[136:139], v[24:27]
  ds_read_b128 v[180:183], v6 offset:63488
  v_mfma_f32_16x16x32_bf16 v[28:31], v[184:187], v[140:143], v[28:31]
  s_waitcnt lgkmcnt(4)
  v_mfma_f32_16x16x32_bf16 v[32:35], v[188:191], v[136:139], v[32:35]
  ds_read_b128 v[184:187], v7 offset:0
  v_mfma_f32_16x16x32_bf16 v[36:39], v[188:191], v[140:143], v[36:39]
  s_waitcnt lgkmcnt(4)
  v_mfma_f32_16x16x32_bf16 v[40:43], v[192:195], v[136:139], v[40:43]
  ds_read_b128 v[188:191], v7 offset:1024
  v_mfma_f32_16x16x32_bf16 v[44:47], v[192:195], v[140:143], v[44:47]
  s_add_u32 m0, s89, 50176
  s_mov_b32 s88, 8320
  buffer_load_dwordx4 v109, s[36:39], s88 offen sc1 lds
  s_waitcnt lgkmcnt(4)
  v_mfma_f32_16x16x32_bf16 v[48:51], v[196:199], v[136:139], v[48:51]
  ds_read_b128 v[192:195], v7 offset:2048
  v_mfma_f32_16x16x32_bf16 v[52:55], v[196:199], v[140:143], v[52:55]
  s_waitcnt vmcnt(18)
  v_swap_b32 v146, v148
  v_swap_b32 v147, v149
  s_waitcnt lgkmcnt(4)
  v_mfma_f32_16x16x32_bf16 v[56:59], v[176:179], v[136:139], v[56:59]
  ds_read_b128 v[196:199], v7 offset:3072
  v_mfma_f32_16x16x32_bf16 v[60:63], v[176:179], v[140:143], v[60:63]
  s_waitcnt lgkmcnt(4)
  v_mfma_f32_16x16x32_bf16 v[64:67], v[180:183], v[136:139], v[64:67]
  ds_read_b128 v[176:179], v7 offset:4096
  v_mfma_f32_16x16x32_bf16 v[68:71], v[180:183], v[140:143], v[68:71]
  s_waitcnt lgkmcnt(4)
  v_mfma_f32_16x16x32_bf16 v[16:19], v[184:187], v[144:147], v[16:19]
  ds_read_b128 v[180:183], v7 offset:5120
  s_add_u32 m0, s89, 51200
  s_mov_b32 s88, 49152
  buffer_load_dwordx4 v109, s[36:39], s88 offen sc1 lds
  v_mfma_f32_16x16x32_bf16 v[20:23], v[184:187], v[148:151], v[20:23]
  buffer_load_dwordx4 v[136:139], v2, s[40:43], s67 offen sc1
  buffer_load_dwordx4 v[140:143], v2, s[40:43], s67 offen offset:1024 sc1
  s_waitcnt lgkmcnt(4)
  v_mfma_f32_16x16x32_bf16 v[24:27], v[188:191], v[144:147], v[24:27]
  ds_read_b128 v[184:187], v7 offset:6144
  v_mfma_f32_16x16x32_bf16 v[28:31], v[188:191], v[148:151], v[28:31]
  s_waitcnt lgkmcnt(4)
  v_mfma_f32_16x16x32_bf16 v[32:35], v[192:195], v[144:147], v[32:35]
  ds_read_b128 v[188:191], v7 offset:7168
  v_mfma_f32_16x16x32_bf16 v[36:39], v[192:195], v[148:151], v[36:39]
  s_waitcnt lgkmcnt(4)
  v_mfma_f32_16x16x32_bf16 v[40:43], v[196:199], v[144:147], v[40:43]
  ds_read_b128 v[192:195], v7 offset:8192
  v_mfma_f32_16x16x32_bf16 v[44:47], v[196:199], v[148:151], v[44:47]
  s_add_u32 m0, s89, 52224
  s_mov_b32 s88, 49280
  buffer_load_dwordx4 v109, s[36:39], s88 offen sc1 lds
  s_waitcnt lgkmcnt(4)
  v_mfma_f32_16x16x32_bf16 v[48:51], v[176:179], v[144:147], v[48:51]
  ds_read_b128 v[196:199], v7 offset:9216
  v_mfma_f32_16x16x32_bf16 v[52:55], v[176:179], v[148:151], v[52:55]
  s_waitcnt vmcnt(17)
  v_swap_b32 v154, v156
  v_swap_b32 v155, v157
  s_waitcnt lgkmcnt(4)
  v_mfma_f32_16x16x32_bf16 v[56:59], v[180:183], v[144:147], v[56:59]
  ds_read_b128 v[176:179], v7 offset:10240
  v_mfma_f32_16x16x32_bf16 v[60:63], v[180:183], v[148:151], v[60:63]
  s_waitcnt lgkmcnt(4)
  v_mfma_f32_16x16x32_bf16 v[64:67], v[184:187], v[144:147], v[64:67]
  ds_read_b128 v[180:183], v7 offset:11264
  v_mfma_f32_16x16x32_bf16 v[68:71], v[184:187], v[148:151], v[68:71]
  s_waitcnt lgkmcnt(4)
  v_mfma_f32_16x16x32_bf16 v[16:19], v[188:191], v[152:155], v[16:19]
  ds_read_b128 v[184:187], v7 offset:12288
  s_add_u32 m0, s89, 53248
  s_mov_b32 s88, 90112
  buffer_load_dwordx4 v109, s[36:39], s88 offen sc1 lds
  v_mfma_f32_16x16x32_bf16 v[20:23], v[188:191], v[156:159], v[20:23]
  buffer_load_dwordx4 v[144:147], v2, s[40:43], s68 offen sc1
  buffer_load_dwordx4 v[148:151], v2, s[40:43], s68 offen offset:1024 sc1
  s_waitcnt lgkmcnt(4)
  v_mfma_f32_16x16x32_bf16 v[24:27], v[192:195], v[152:155], v[24:27]
  ds_read_b128 v[188:191], v7 offset:13312
  v_mfma_f32_16x16x32_bf16 v[28:31], v[192:195], v[156:159], v[28:31]
  s_waitcnt lgkmcnt(4)
  v_mfma_f32_16x16x32_bf16 v[32:35], v[196:199], v[152:155], v[32:35]
  s_waitcnt vmcnt(15)
  s_barrier
  ds_read_b128 v[192:195], v5 offset:0
  v_mfma_f32_16x16x32_bf16 v[36:39], v[196:199], v[156:159], v[36:39]
  s_waitcnt lgkmcnt(4)
  v_mfma_f32_16x16x32_bf16 v[40:43], v[176:179], v[152:155], v[40:43]
  ds_read_b128 v[196:199], v5 offset:1024
  v_mfma_f32_16x16x32_bf16 v[44:47], v[176:179], v[156:159], v[44:47]
  s_add_u32 m0, s89, 54272
  s_mov_b32 s88, 90240
  buffer_load_dwordx4 v109, s[36:39], s88 offen sc1 lds
  s_waitcnt lgkmcnt(4)
  v_mfma_f32_16x16x32_bf16 v[48:51], v[180:183], v[152:155], v[48:51]
  ds_read_b128 v[176:179], v5 offset:2048
  v_mfma_f32_16x16x32_bf16 v[52:55], v[180:183], v[156:159], v[52:55]
  v_swap_b32 v162, v164
  v_swap_b32 v163, v165
  s_waitcnt lgkmcnt(4)
  v_mfma_f32_16x16x32_bf16 v[56:59], v[184:187], v[152:155], v[56:59]
  ds_read_b128 v[180:183], v5 offset:3072
  v_mfma_f32_16x16x32_bf16 v[60:63], v[184:187], v[156:159], v[60:63]
  s_waitcnt lgkmcnt(4)
  v_mfma_f32_16x16x32_bf16 v[64:67], v[188:191], v[152:155], v[64:67]
  ds_read_b128 v[184:187], v5 offset:4096
  v_mfma_f32_16x16x32_bf16 v[68:71], v[188:191], v[156:159], v[68:71]
  s_waitcnt lgkmcnt(4)
  v_mfma_f32_16x16x32_bf16 v[16:19], v[192:195], v[160:163], v[16:19]
  ds_read_b128 v[188:191], v5 offset:5120
  s_add_u32 m0, s89, 55296
  s_mov_b32 s88, 131072
  buffer_load_dwordx4 v110, s[36:39], s88 offen sc1 lds
  v_mfma_f32_16x16x32_bf16 v[20:23], v[192:195], v[164:167], v[20:23]
  buffer_load_dwordx4 v[152:155], v2, s[40:43], s69 offen sc1
  buffer_load_dwordx4 v[156:159], v2, s[40:43], s69 offen offset:1024 sc1
  s_waitcnt lgkmcnt(4)
  v_mfma_f32_16x16x32_bf16 v[24:27], v[196:199], v[160:163], v[24:27]
  ds_read_b128 v[192:195], v5 offset:6144
  s_mov_b32 s81, 0x3f803f80
  v_mfma_f32_16x16x32_bf16 v[28:31], v[196:199], v[164:167], v[28:31]
  s_waitcnt vmcnt(16)
  v_dot2_f32_bf16 v224, v216, s81, 0
  v_dot2_f32_bf16 v225, v216, v216, 0
  s_waitcnt lgkmcnt(4)
  v_mfma_f32_16x16x32_bf16 v[32:35], v[176:179], v[160:163], v[32:35]
  ds_read_b128 v[196:199], v5 offset:7168
  v_dot2_f32_bf16 v226, v218, s81, 0
  v_mfma_f32_16x16x32_bf16 v[36:39], v[176:179], v[164:167], v[36:39]
  v_dot2_f32_bf16 v227, v218, v218, 0
  v_dot2_f32_bf16 v224, v217, s81, v224
  s_waitcnt lgkmcnt(4)
  v_mfma_f32_16x16x32_bf16 v[40:43], v[180:183], v[160:163], v[40:43]
  ds_read_b128 v[176:179], v5 offset:8192
  v_dot2_f32_bf16 v225, v217, v217, v225
  v_mfma_f32_16x16x32_bf16 v[44:47], v[180:183], v[164:167], v[44:47]
  v_dot2_f32_bf16 v226, v219, s81, v226
  v_dot2_f32_bf16 v227, v219, v219, v227
  s_waitcnt lgkmcnt(4)
  v_mfma_f32_16x16x32_bf16 v[48:51], v[184:187], v[160:163], v[48:51]
  ds_read_b128 v[180:183], v5 offset:9216
  s_waitcnt vmcnt(15)
  v_dot2_f32_bf16 v224, v220, s81, v224
  v_mfma_f32_16x16x32_bf16 v[52:55], v[184:187], v[164:167], v[52:55]
  v_swap_b32 v170, v172
  v_swap_b32 v171, v173
  s_waitcnt lgkmcnt(4)
  v_mfma_f32_16x16x32_bf16 v[56:59], v[188:191], v[160:163], v[56:59]
  ds_read_b128 v[184:187], v5 offset:10240
  v_dot2_f32_bf16 v225, v220, v220, v225
  v_mfma_f32_16x16x32_bf16 v[60:63], v[188:191], v[164:167], v[60:63]
  v_dot2_f32_bf16 v226, v222, s81, v226
  v_dot2_f32_bf16 v227, v222, v222, v227
  s_waitcnt lgkmcnt(4)
  v_mfma_f32_16x16x32_bf16 v[64:67], v[192:195], v[160:163], v[64:67]
  ds_read_b128 v[188:191], v5 offset:11264
  v_dot2_f32_bf16 v224, v221, s81, v224
  v_mfma_f32_16x16x32_bf16 v[68:71], v[192:195], v[164:167], v[68:71]
  v_dot2_f32_bf16 v225, v221, v221, v225
  v_dot2_f32_bf16 v226, v223, s81, v226
  s_waitcnt lgkmcnt(4)
  v_mfma_f32_16x16x32_bf16 v[16:19], v[196:199], v[168:171], v[16:19]
  ds_read_b128 v[192:195], v5 offset:12288
  v_dot2_f32_bf16 v227, v223, v223, v227
  v_mfma_f32_16x16x32_bf16 v[20:23], v[196:199], v[172:175], v[20:23]
  buffer_load_dwordx4 v[160:163], v2, s[40:43], s70 offen sc1
  buffer_load_dwordx4 v[164:167], v2, s[40:43], s70 offen offset:1024 sc1
  s_waitcnt lgkmcnt(4)
  v_mfma_f32_16x16x32_bf16 v[24:27], v[176:179], v[168:171], v[24:27]
  ds_read_b128 v[196:199], v5 offset:13312
  v_lshrrev_b32 v216, 4, v1
  v_mfma_f32_16x16x32_bf16 v[28:31], v[176:179], v[172:175], v[28:31]
  v_lshl_add_u32 v216, v216, 2, s85
  v_and_b32 v217, 15, v1
  s_waitcnt lgkmcnt(4)
  v_mfma_f32_16x16x32_bf16 v[32:35], v[180:183], v[168:171], v[32:35]
  ds_read_b128 v[176:179], v5 offset:14336
  v_cmp_eq_u32 vcc, 0, v217
  v_mfma_f32_16x16x32_bf16 v[36:39], v[180:183], v[172:175], v[36:39]
  v_mov_b32 v217, 0x80000000
  v_cndmask_b32 v216, v217, v216, vcc
  s_waitcnt lgkmcnt(4)
  v_mfma_f32_16x16x32_bf16 v[40:43], v[184:187], v[168:171], v[40:43]
  ds_read_b128 v[180:183], v5 offset:15360
  v_permlane32_swap_b32 v224, v226
  v_mfma_f32_16x16x32_bf16 v[44:47], v[184:187], v[172:175], v[44:47]
  v_permlane32_swap_b32 v225, v227
  v_add_f32 v224, v224, v226
  s_waitcnt lgkmcnt(4)
  v_mfma_f32_16x16x32_bf16 v[48:51], v[188:191], v[168:171], v[48:51]
  ds_read_b128 v[184:187], v5 offset:16384
  v_add_f32 v225, v225, v227
  v_mfma_f32_16x16x32_bf16 v[52:55], v[188:191], v[172:175], v[52:55]
  s_waitcnt vmcnt(14)
  v_swap_b32 v130, v132
  v_swap_b32 v131, v133
  s_waitcnt lgkmcnt(4)
  v_mfma_f32_16x16x32_bf16 v[56:59], v[192:195], v[168:171], v[56:59]
  ds_read_b128 v[188:191], v5 offset:17408
  v_permlane16_swap_b32 v224, v225
  v_mfma_f32_16x16x32_bf16 v[60:63], v[192:195], v[172:175], v[60:63]
  v_add_f32 v224, v224, v225
  s_nop 1
  v_add_f32_dpp v224, v224, v224 row_ror:1 row_mask:0xf bank_mask:0xf
  s_waitcnt lgkmcnt(4)
  v_mfma_f32_16x16x32_bf16 v[64:67], v[196:199], v[168:171], v[64:67]
  ds_read_b128 v[192:195], v5 offset:18432
  v_add_f32_dpp v224, v224, v224 row_ror:2 row_mask:0xf bank_mask:0xf
  v_mfma_f32_16x16x32_bf16 v[68:71], v[196:199], v[172:175], v[68:71]
  s_nop 0
  v_add_f32_dpp v224, v224, v224 row_ror:4 row_mask:0xf bank_mask:0xf
  s_nop 1
  v_add_f32_dpp v224, v224, v224 row_ror:8 row_mask:0xf bank_mask:0xf
  s_waitcnt lgkmcnt(4)
  v_mfma_f32_16x16x32_bf16 v[16:19], v[176:179], v[128:131], v[16:19]
  ds_read_b128 v[196:199], v5 offset:19456
  v_or_b32 v224, 1, v224
  v_mfma_f32_16x16x32_bf16 v[20:23], v[176:179], v[132:135], v[20:23]
  buffer_load_dwordx4 v[168:171], v2, s[40:43], s71 offen sc1
  buffer_load_dwordx4 v[172:175], v2, s[40:43], s71 offen offset:1024 sc1
  s_waitcnt lgkmcnt(4)
  v_mfma_f32_16x16x32_bf16 v[24:27], v[180:183], v[128:131], v[24:27]
  ds_read_b128 v[176:179], v5 offset:20480
  buffer_store_dword v224, v216, s[36:39], 0 offen sc1
  v_mfma_f32_16x16x32_bf16 v[28:31], v[180:183], v[132:135], v[28:31]
  s_and_b32 s80, s2, 15
  s_lshl_b32 s81, s32, 4
  s_waitcnt lgkmcnt(4)
  v_mfma_f32_16x16x32_bf16 v[32:35], v[184:187], v[128:131], v[32:35]
  ds_read_b128 v[180:183], v5 offset:21504
  s_add_u32 s80, s80, s81
  v_mfma_f32_16x16x32_bf16 v[36:39], v[184:187], v[132:135], v[36:39]
  s_lshl_b32 s80, s80, 7
  s_add_u32 s80, s80, 24576
  s_waitcnt lgkmcnt(4)
  v_mfma_f32_16x16x32_bf16 v[40:43], v[188:191], v[128:131], v[40:43]
  ds_read_b128 v[184:187], v5 offset:22528
  s_cmp_ge_u32 s2, 160
  v_mfma_f32_16x16x32_bf16 v[44:47], v[188:191], v[132:135], v[44:47]
  s_cselect_b32 s81, 0x80000000, 0
  s_or_b32 s80, s80, s81
  s_waitcnt lgkmcnt(4)
  v_mfma_f32_16x16x32_bf16 v[48:51], v[192:195], v[128:131], v[48:51]
  ds_read_b128 v[188:191], v5 offset:23552
  v_or_b32 v230, s80, v206
  v_mfma_f32_16x16x32_bf16 v[52:55], v[192:195], v[132:135], v[52:55]
  s_waitcnt vmcnt(13)
  v_swap_b32 v138, v140
  v_swap_b32 v139, v141
  s_waitcnt lgkmcnt(4)
  v_mfma_f32_16x16x32_bf16 v[56:59], v[196:199], v[128:131], v[56:59]
  ds_read_b128 v[192:195], v5 offset:24576
  v_mov_b32 v231, 1
  v_mfma_f32_16x16x32_bf16 v[60:63], v[196:199], v[132:135], v[60:63]
  buffer_atomic_add v231, v230, s[36:39], 0 offen sc1
  s_add_u32 m0, s89, 77824
  s_mov_b32 s88, 12288
  buffer_load_dwordx4 v109, s[36:39], s88 offen sc1 lds
  s_waitcnt lgkmcnt(4)
  v_mfma_f32_16x16x32_bf16 v[64:67], v[176:179], v[128:131], v[64:67]
  ds_read_b128 v[196:199], v5 offset:25600
  s_add_u32 m0, s89, 78848
  s_mov_b32 s88, 12416
  buffer_load_dwordx4 v109, s[36:39], s88 offen sc1 lds
  v_mfma_f32_16x16x32_bf16 v[68:71], v[176:179], v[132:135], v[68:71]
  s_add_u32 m0, s89, 79872
  s_mov_b32 s88, 53248
  buffer_load_dwordx4 v109, s[36:39], s88 offen sc1 lds
  s_add_u32 m0, s89, 80896
  s_waitcnt lgkmcnt(4)
  v_mfma_f32_16x16x32_bf16 v[16:19], v[180:183], v[136:139], v[16:19]
  ds_read_b128 v[176:179], v5 offset:26624
  s_mov_b32 s88, 53376
  buffer_load_dwordx4 v109, s[36:39], s88 offen sc1 lds
  s_add_u32 m0, s89, 81920
  v_mfma_f32_16x16x32_bf16 v[20:23], v[180:183], v[140:143], v[20:23]
  buffer_load_dwordx4 v[128:131], v2, s[40:43], s72 offen sc1
  buffer_load_dwordx4 v[132:135], v2, s[40:43], s72 offen offset:1024 sc1
  s_mov_b32 s88, 94208
  buffer_load_dwordx4 v109, s[36:39], s88 offen sc1 lds
  s_waitcnt lgkmcnt(4)
  v_mfma_f32_16x16x32_bf16 v[24:27], v[184:187], v[136:139], v[24:27]
  ds_read_b128 v[180:183], v5 offset:27648
  s_add_u32 m0, s89, 82944
  s_mov_b32 s88, 94336
  buffer_load_dwordx4 v109, s[36:39], s88 offen sc1 lds
  v_mfma_f32_16x16x32_bf16 v[28:31], v[184:187], v[140:143], v[28:31]
  s_waitcnt lgkmcnt(4)
  v_mfma_f32_16x16x32_bf16 v[32:35], v[188:191], v[136:139], v[32:35]
  s_waitcnt vmcnt(16)
  s_barrier
  ds_read_b128 v[184:187], v5 offset:28672
  v_mfma_f32_16x16x32_bf16 v[36:39], v[188:191], v[140:143], v[36:39]
  s_waitcnt lgkmcnt(4)
  v_mfma_f32_16x16x32_bf16 v[40:43], v[192:195], v[136:139], v[40:43]
  ds_read_b128 v[188:191], v5 offset:29696
  v_mfma_f32_16x16x32_bf16 v[44:47], v[192:195], v[140:143], v[44:47]
  s_add_u32 m0, s89, 83968
  s_mov_b32 s88, 135168
  buffer_load_dwordx4 v110, s[36:39], s88 offen sc1 lds
  s_waitcnt lgkmcnt(4)
  v_mfma_f32_16x16x32_bf16 v[48:51], v[196:199], v[136:139], v[48:51]
  ds_read_b128 v[192:195], v5 offset:30720
  v_mfma_f32_16x16x32_bf16 v[52:55], v[196:199], v[140:143], v[52:55]
  v_swap_b32 v146, v148
  v_swap_b32 v147, v149
  s_waitcnt lgkmcnt(4)
  v_mfma_f32_16x16x32_bf16 v[56:59], v[176:179], v[136:139], v[56:59]
  ds_read_b128 v[196:199], v5 offset:31744
  v_mfma_f32_16x16x32_bf16 v[60:63], v[176:179], v[140:143], v[60:63]
  s_waitcnt lgkmcnt(4)
  v_mfma_f32_16x16x32_bf16 v[64:67], v[180:183], v[136:139], v[64:67]
  ds_read_b128 v[176:179], v5 offset:32768
  v_mfma_f32_16x16x32_bf16 v[68:71], v[180:183], v[140:143], v[68:71]
  s_waitcnt lgkmcnt(4)
  v_mfma_f32_16x16x32_bf16 v[16:19], v[184:187], v[144:147], v[16:19]
  ds_read_b128 v[180:183], v5 offset:33792
  s_add_u32 m0, s89, 106496
  s_mov_b32 s88, 16384
  buffer_load_dwordx4 v109, s[36:39], s88 offen sc1 lds
  v_mfma_f32_16x16x32_bf16 v[20:23], v[184:187], v[148:151], v[20:23]
  buffer_load_dwordx4 v[136:139], v2, s[40:43], s73 offen sc1
  buffer_load_dwordx4 v[140:143], v2, s[40:43], s73 offen offset:1024 sc1
  s_waitcnt lgkmcnt(4)
  v_mfma_f32_16x16x32_bf16 v[24:27], v[188:191], v[144:147], v[24:27]
  ds_read_b128 v[184:187], v5 offset:34816
  v_mfma_f32_16x16x32_bf16 v[28:31], v[188:191], v[148:151], v[28:31]
  s_waitcnt lgkmcnt(4)
  v_mfma_f32_16x16x32_bf16 v[32:35], v[192:195], v[144:147], v[32:35]
  ds_read_b128 v[188:191], v5 offset:35840
  v_mfma_f32_16x16x32_bf16 v[36:39], v[192:195], v[148:151], v[36:39]
  s_waitcnt lgkmcnt(4)
  v_mfma_f32_16x16x32_bf16 v[40:43], v[196:199], v[144:147], v[40:43]
  ds_read_b128 v[192:195], v5 offset:36864
  v_mfma_f32_16x16x32_bf16 v[44:47], v[196:199], v[148:151], v[44:47]
  s_add_u32 m0, s89, 107520
  s_mov_b32 s88, 16512
  buffer_load_dwordx4 v109, s[36:39], s88 offen sc1 lds
  s_waitcnt lgkmcnt(4)
  v_mfma_f32_16x16x32_bf16 v[48:51], v[176:179], v[144:147], v[48:51]
  ds_read_b128 v[196:199], v5 offset:37888
  v_mfma_f32_16x16x32_bf16 v[52:55], v[176:179], v[148:151], v[52:55]
  s_waitcnt vmcnt(19)
  v_swap_b32 v154, v156
  v_swap_b32 v155, v157
  s_waitcnt lgkmcnt(4)
  v_mfma_f32_16x16x32_bf16 v[56:59], v[180:183], v[144:147], v[56:59]
  ds_read_b128 v[176:179], v5 offset:38912
  v_mfma_f32_16x16x32_bf16 v[60:63], v[180:183], v[148:151], v[60:63]
  s_waitcnt lgkmcnt(4)
  v_mfma_f32_16x16x32_bf16 v[64:67], v[184:187], v[144:147], v[64:67]
  ds_read_b128 v[180:183], v5 offset:39936
  v_mfma_f32_16x16x32_bf16 v[68:71], v[184:187], v[148:151], v[68:71]
  s_waitcnt lgkmcnt(4)
  v_mfma_f32_16x16x32_bf16 v[16:19], v[188:191], v[152:155], v[16:19]
  ds_read_b128 v[184:187], v5 offset:40960
  s_add_u32 m0, s89, 108544
  s_mov_b32 s88, 57344
  buffer_load_dwordx4 v109, s[36:39], s88 offen sc1 lds
  v_mfma_f32_16x16x32_bf16 v[20:23], v[188:191], v[156:159], v[20:23]
  buffer_load_dwordx4 v[144:147], v2, s[40:43], s74 offen sc1
  buffer_load_dwordx4 v[148:151], v2, s[40:43], s74 offen offset:1024 sc1
  s_waitcnt lgkmcnt(4)
  v_mfma_f32_16x16x32_bf16 v[24:27], v[192:195], v[152:155], v[24:27]
  ds_read_b128 v[188:191], v5 offset:41984
  v_mfma_f32_16x16x32_bf16 v[28:31], v[192:195], v[156:159], v[28:31]
  s_waitcnt lgkmcnt(4)
  v_mfma_f32_16x16x32_bf16 v[32:35], v[196:199], v[152:155], v[32:35]
  ds_read_b128 v[192:195], v5 offset:43008
  v_mfma_f32_16x16x32_bf16 v[36:39], v[196:199], v[156:159], v[36:39]
  s_waitcnt lgkmcnt(4)
  v_mfma_f32_16x16x32_bf16 v[40:43], v[176:179], v[152:155], v[40:43]
  ds_read_b128 v[196:199], v5 offset:44032
  v_mfma_f32_16x16x32_bf16 v[44:47], v[176:179], v[156:159], v[44:47]
  s_add_u32 m0, s89, 109568
  s_mov_b32 s88, 57472
  buffer_load_dwordx4 v109, s[36:39], s88 offen sc1 lds
  s_waitcnt lgkmcnt(4)
  v_mfma_f32_16x16x32_bf16 v[48:51], v[180:183], v[152:155], v[48:51]
  ds_read_b128 v[176:179], v5 offset:45056
  v_mfma_f32_16x16x32_bf16 v[52:55], v[180:183], v[156:159], v[52:55]
  s_waitcnt vmcnt(21)
  v_swap_b32 v162, v164
  v_swap_b32 v163, v165
  s_waitcnt lgkmcnt(4)
  v_mfma_f32_16x16x32_bf16 v[56:59], v[184:187], v[152:155], v[56:59]
  ds_read_b128 v[180:183], v5 offset:46080
  v_mfma_f32_16x16x32_bf16 v[60:63], v[184:187], v[156:159], v[60:63]
  s_waitcnt lgkmcnt(4)
  v_mfma_f32_16x16x32_bf16 v[64:67], v[188:191], v[152:155], v[64:67]
  ds_read_b128 v[184:187], v5 offset:47104
  v_mfma_f32_16x16x32_bf16 v[68:71], v[188:191], v[156:159], v[68:71]
  s_waitcnt lgkmcnt(4)
  v_mfma_f32_16x16x32_bf16 v[16:19], v[192:195], v[160:163], v[16:19]
  ds_read_b128 v[188:191], v5 offset:48128
  s_add_u32 m0, s89, 110592
  s_mov_b32 s88, 98304
  buffer_load_dwordx4 v109, s[36:39], s88 offen sc1 lds
  v_mfma_f32_16x16x32_bf16 v[20:23], v[192:195], v[164:167], v[20:23]
  buffer_load_dwordx4 v[152:155], v2, s[40:43], s75 offen sc1
  buffer_load_dwordx4 v[156:159], v2, s[40:43], s75 offen offset:1024 sc1
  s_waitcnt lgkmcnt(4)
  v_mfma_f32_16x16x32_bf16 v[24:27], v[196:199], v[160:163], v[24:27]
  ds_read_b128 v[192:195], v5 offset:49152
  v_mfma_f32_16x16x32_bf16 v[28:31], v[196:199], v[164:167], v[28:31]
  s_waitcnt lgkmcnt(4)
  v_mfma_f32_16x16x32_bf16 v[32:35], v[176:179], v[160:163], v[32:35]
  ds_read_b128 v[196:199], v5 offset:50176
  v_mfma_f32_16x16x32_bf16 v[36:39], v[176:179], v[164:167], v[36:39]
  s_waitcnt lgkmcnt(4)
  v_mfma_f32_16x16x32_bf16 v[40:43], v[180:183], v[160:163], v[40:43]
  ds_read_b128 v[176:179], v5 offset:51200
  v_mfma_f32_16x16x32_bf16 v[44:47], v[180:183], v[164:167], v[44:47]
  s_add_u32 m0, s89, 111616
  s_mov_b32 s88, 98432
  buffer_load_dwordx4 v109, s[36:39], s88 offen sc1 lds
  s_waitcnt lgkmcnt(4)
  v_mfma_f32_16x16x32_bf16 v[48:51], v[184:187], v[160:163], v[48:51]
  ds_read_b128 v[180:183], v5 offset:52224
  v_mfma_f32_16x16x32_bf16 v[52:55], v[184:187], v[164:167], v[52:55]
  s_waitcnt vmcnt(23)
  v_swap_b32 v170, v172
  v_swap_b32 v171, v173
  s_waitcnt lgkmcnt(4)
  v_mfma_f32_16x16x32_bf16 v[56:59], v[188:191], v[160:163], v[56:59]
  ds_read_b128 v[184:187], v5 offset:53248
  v_mfma_f32_16x16x32_bf16 v[60:63], v[188:191], v[164:167], v[60:63]
  s_waitcnt lgkmcnt(4)
  v_mfma_f32_16x16x32_bf16 v[64:67], v[192:195], v[160:163], v[64:67]
  ds_read_b128 v[188:191], v5 offset:54272
  v_mfma_f32_16x16x32_bf16 v[68:71], v[192:195], v[164:167], v[68:71]
  s_waitcnt lgkmcnt(4)
  v_mfma_f32_16x16x32_bf16 v[16:19], v[196:199], v[168:171], v[16:19]
  ds_read_b128 v[192:195], v5 offset:55296
  s_add_u32 m0, s89, 112640
  s_mov_b32 s88, 139264
  buffer_load_dwordx4 v110, s[36:39], s88 offen sc1 lds
  v_mfma_f32_16x16x32_bf16 v[20:23], v[196:199], v[172:175], v[20:23]
  buffer_load_dwordx4 v[160:163], v2, s[40:43], s76 offen sc1
  buffer_load_dwordx4 v[164:167], v2, s[40:43], s76 offen offset:1024 sc1
  s_waitcnt lgkmcnt(4)
  v_mfma_f32_16x16x32_bf16 v[24:27], v[176:179], v[168:171], v[24:27]
  ds_read_b128 v[196:199], v5 offset:56320
  v_mfma_f32_16x16x32_bf16 v[28:31], v[176:179], v[172:175], v[28:31]
  s_waitcnt lgkmcnt(4)
  v_mfma_f32_16x16x32_bf16 v[32:35], v[180:183], v[168:171], v[32:35]
  s_waitcnt vmcnt(15)
  s_barrier
  ds_read_b128 v[176:179], v5 offset:57344
  v_mfma_f32_16x16x32_bf16 v[36:39], v[180:183], v[172:175], v[36:39]
  s_waitcnt lgkmcnt(4)
  v_mfma_f32_16x16x32_bf16 v[40:43], v[184:187], v[168:171], v[40:43]
  ds_read_b128 v[180:183], v5 offset:58368
  v_mfma_f32_16x16x32_bf16 v[44:47], v[184:187], v[172:175], v[44:47]
  s_waitcnt lgkmcnt(4)
  v_mfma_f32_16x16x32_bf16 v[48:51], v[188:191], v[168:171], v[48:51]
  ds_read_b128 v[184:187], v5 offset:59392
  v_mfma_f32_16x16x32_bf16 v[52:55], v[188:191], v[172:175], v[52:55]
  v_swap_b32 v130, v132
  v_swap_b32 v131, v133
  s_waitcnt lgkmcnt(4)
  v_mfma_f32_16x16x32_bf16 v[56:59], v[192:195], v[168:171], v[56:59]
  ds_read_b128 v[188:191], v5 offset:60416
  v_mfma_f32_16x16x32_bf16 v[60:63], v[192:195], v[172:175], v[60:63]
  s_and_b32 s80, s90, 3
  s_lshl_b32 s80, s80, 2
  s_waitcnt lgkmcnt(4)
  v_mfma_f32_16x16x32_bf16 v[64:67], v[196:199], v[168:171], v[64:67]
  ds_read_b128 v[192:195], v5 offset:61440
  s_add_u32 s80, s80, s32
  v_mfma_f32_16x16x32_bf16 v[68:71], v[196:199], v[172:175], v[68:71]
  s_lshl_b32 s80, s80, 9
  s_add_u32 s80, s80, 24576
  s_waitcnt lgkmcnt(4)
  v_mfma_f32_16x16x32_bf16 v[16:19], v[176:179], v[128:131], v[16:19]
  ds_read_b128 v[196:199], v5 offset:62464
  v_and_b32 v230, 0x80000180, v11
  v_mfma_f32_16x16x32_bf16 v[20:23], v[176:179], v[132:135], v[20:23]
  buffer_load_dwordx4 v[168:171], v2, s[40:43], s77 offen sc1
  buffer_load_dwordx4 v[172:175], v2, s[40:43], s77 offen offset:1024 sc1
  s_waitcnt lgkmcnt(4)
  v_mfma_f32_16x16x32_bf16 v[24:27], v[180:183], v[128:131], v[24:27]
  ds_read_b128 v[176:179], v5 offset:63488
  v_add_u32 v230, s80, v230
  v_mfma_f32_16x16x32_bf16 v[28:31], v[180:183], v[132:135], v[28:31]
  buffer_load_dword v231, v230, s[36:39], 0 offen sc1
  s_waitcnt lgkmcnt(4)
  v_mfma_f32_16x16x32_bf16 v[32:35], v[184:187], v[128:131], v[32:35]
  ds_read_b128 v[180:183], v6 offset:0
  v_mfma_f32_16x16x32_bf16 v[36:39], v[184:187], v[132:135], v[36:39]
  s_waitcnt lgkmcnt(4)
  v_mfma_f32_16x16x32_bf16 v[40:43], v[188:191], v[128:131], v[40:43]
  ds_read_b128 v[184:187], v6 offset:1024
  v_mfma_f32_16x16x32_bf16 v[44:47], v[188:191], v[132:135], v[44:47]
  s_waitcnt lgkmcnt(4)
  v_mfma_f32_16x16x32_bf16 v[48:51], v[192:195], v[128:131], v[48:51]
  ds_read_b128 v[188:191], v6 offset:2048
  v_mfma_f32_16x16x32_bf16 v[52:55], v[192:195], v[132:135], v[52:55]
  s_waitcnt vmcnt(15)
  v_swap_b32 v138, v140
  v_swap_b32 v139, v141
  s_waitcnt lgkmcnt(4)
  v_mfma_f32_16x16x32_bf16 v[56:59], v[196:199], v[128:131], v[56:59]
  ds_read_b128 v[192:195], v6 offset:3072
  v_mfma_f32_16x16x32_bf16 v[60:63], v[196:199], v[132:135], v[60:63]
  s_waitcnt lgkmcnt(4)
  v_mfma_f32_16x16x32_bf16 v[64:67], v[176:179], v[128:131], v[64:67]
  ds_read_b128 v[196:199], v6 offset:4096
  v_mfma_f32_16x16x32_bf16 v[68:71], v[176:179], v[132:135], v[68:71]
  s_waitcnt lgkmcnt(4)
  v_mfma_f32_16x16x32_bf16 v[16:19], v[180:183], v[136:139], v[16:19]
  ds_read_b128 v[176:179], v6 offset:5120
  v_mfma_f32_16x16x32_bf16 v[20:23], v[180:183], v[140:143], v[20:23]
  buffer_load_dwordx4 v[128:131], v2, s[40:43], s78 offen sc1
  buffer_load_dwordx4 v[132:135], v2, s[40:43], s78 offen offset:1024 sc1
  s_waitcnt lgkmcnt(4)
  v_mfma_f32_16x16x32_bf16 v[24:27], v[184:187], v[136:139], v[24:27]
  ds_read_b128 v[180:183], v6 offset:6144
  v_mfma_f32_16x16x32_bf16 v[28:31], v[184:187], v[140:143], v[28:31]
  s_waitcnt lgkmcnt(4)
  v_mfma_f32_16x16x32_bf16 v[32:35], v[188:191], v[136:139], v[32:35]
  ds_read_b128 v[184:187], v6 offset:7168
  v_mfma_f32_16x16x32_bf16 v[36:39], v[188:191], v[140:143], v[36:39]
  s_waitcnt lgkmcnt(4)
  v_mfma_f32_16x16x32_bf16 v[40:43], v[192:195], v[136:139], v[40:43]
  ds_read_b128 v[188:191], v6 offset:8192
  v_mfma_f32_16x16x32_bf16 v[44:47], v[192:195], v[140:143], v[44:47]
  s_waitcnt lgkmcnt(4)
  v_mfma_f32_16x16x32_bf16 v[48:51], v[196:199], v[136:139], v[48:51]
  ds_read_b128 v[192:195], v6 offset:9216
  v_mfma_f32_16x16x32_bf16 v[52:55], v[196:199], v[140:143], v[52:55]
  s_waitcnt vmcnt(13)
  v_swap_b32 v146, v148
  v_swap_b32 v147, v149
  s_waitcnt lgkmcnt(4)
  v_mfma_f32_16x16x32_bf16 v[56:59], v[176:179], v[136:139], v[56:59]
  ds_read_b128 v[196:199], v6 offset:10240
  v_mfma_f32_16x16x32_bf16 v[60:63], v[176:179], v[140:143], v[60:63]
  s_waitcnt lgkmcnt(4)
  v_mfma_f32_16x16x32_bf16 v[64:67], v[180:183], v[136:139], v[64:67]
  ds_read_b128 v[176:179], v6 offset:11264
  v_mfma_f32_16x16x32_bf16 v[68:71], v[180:183], v[140:143], v[68:71]
  s_waitcnt lgkmcnt(4)
  v_mfma_f32_16x16x32_bf16 v[16:19], v[184:187], v[144:147], v[16:19]
  ds_read_b128 v[180:183], v6 offset:12288
  v_mfma_f32_16x16x32_bf16 v[20:23], v[184:187], v[148:151], v[20:23]
  buffer_load_dwordx4 v[136:139], v2, s[40:43], s79 offen sc1
  buffer_load_dwordx4 v[140:143], v2, s[40:43], s79 offen offset:1024 sc1
  s_waitcnt lgkmcnt(4)
  v_mfma_f32_16x16x32_bf16 v[24:27], v[188:191], v[144:147], v[24:27]
  ds_read_b128 v[184:187], v6 offset:13312
  v_mfma_f32_16x16x32_bf16 v[28:31], v[188:191], v[148:151], v[28:31]
  s_waitcnt lgkmcnt(4)
  v_mfma_f32_16x16x32_bf16 v[32:35], v[192:195], v[144:147], v[32:35]
  ds_read_b128 v[188:191], v6 offset:14336
  v_mfma_f32_16x16x32_bf16 v[36:39], v[192:195], v[148:151], v[36:39]
  s_waitcnt lgkmcnt(4)
  v_mfma_f32_16x16x32_bf16 v[40:43], v[196:199], v[144:147], v[40:43]
  ds_read_b128 v[192:195], v6 offset:15360
  v_mfma_f32_16x16x32_bf16 v[44:47], v[196:199], v[148:151], v[44:47]
  s_waitcnt lgkmcnt(4)
  v_mfma_f32_16x16x32_bf16 v[48:51], v[176:179], v[144:147], v[48:51]
  ds_read_b128 v[196:199], v6 offset:16384
  v_mfma_f32_16x16x32_bf16 v[52:55], v[176:179], v[148:151], v[52:55]
  s_waitcnt vmcnt(11)
  v_swap_b32 v154, v156
  v_swap_b32 v155, v157
  s_waitcnt lgkmcnt(4)
  v_mfma_f32_16x16x32_bf16 v[56:59], v[180:183], v[144:147], v[56:59]
  ds_read_b128 v[176:179], v6 offset:17408
  s_waitcnt vmcnt(4)
  v_cmp_gt_u32 vcc, 10, v231
  v_mfma_f32_16x16x32_bf16 v[60:63], v[180:183], v[148:151], v[60:63]
  s_and_b32 vcc_lo, vcc_lo, 0xf
  s_cbranch_scc1 L_cp_13
L_cpb_14:
  s_waitcnt lgkmcnt(4)
  v_mfma_f32_16x16x32_bf16 v[64:67], v[184:187], v[144:147], v[64:67]
  ds_read_b128 v[180:183], v6 offset:18432
  v_mfma_f32_16x16x32_bf16 v[68:71], v[184:187], v[148:151], v[68:71]
  s_waitcnt lgkmcnt(4)
  v_mfma_f32_16x16x32_bf16 v[16:19], v[188:191], v[152:155], v[16:19]
  ds_read_b128 v[184:187], v6 offset:19456
  v_mfma_f32_16x16x32_bf16 v[20:23], v[188:191], v[156:159], v[20:23]
  s_waitcnt lgkmcnt(4)
  v_mfma_f32_16x16x32_bf16 v[24:27], v[192:195], v[152:155], v[24:27]
  ds_read_b128 v[188:191], v6 offset:20480
  v_mfma_f32_16x16x32_bf16 v[28:31], v[192:195], v[156:159], v[28:31]
  s_waitcnt lgkmcnt(4)
  v_mfma_f32_16x16x32_bf16 v[32:35], v[196:199], v[152:155], v[32:35]
  s_barrier
  ds_read_b128 v[192:195], v6 offset:21504
  v_mfma_f32_16x16x32_bf16 v[36:39], v[196:199], v[156:159], v[36:39]
  s_add_u32 s40, s28, 0x1228000
  s_addc_u32 s41, s29, 0
  buffer_load_dwordx4 v[144:147], v2, s[40:43], s60 offen sc1
  buffer_load_dwordx4 v[148:151], v2, s[40:43], s60 offen offset:1024 sc1
  s_waitcnt lgkmcnt(4)
  v_mfma_f32_16x16x32_bf16 v[40:43], v[176:179], v[152:155], v[40:43]
  ds_read_b128 v[196:199], v6 offset:22528
  buffer_load_dwordx4 v[216:219], v12, s[36:39], 0 offen offset:0 sc1
  v_mfma_f32_16x16x32_bf16 v[44:47], v[176:179], v[156:159], v[44:47]
  buffer_load_dwordx4 v[220:223], v12, s[36:39], 0 offen offset:1024 sc1
  s_waitcnt lgkmcnt(4)
  v_mfma_f32_16x16x32_bf16 v[48:51], v[180:183], v[152:155], v[48:51]
  ds_read_b128 v[176:179], v6 offset:23552
  v_mfma_f32_16x16x32_bf16 v[52:55], v[180:183], v[156:159], v[52:55]
  v_swap_b32 v162, v164
  v_swap_b32 v163, v165
  s_waitcnt lgkmcnt(4)
  v_mfma_f32_16x16x32_bf16 v[56:59], v[184:187], v[152:155], v[56:59]
  ds_read_b128 v[180:183], v6 offset:24576
  v_mfma_f32_16x16x32_bf16 v[60:63], v[184:187], v[156:159], v[60:63]
  s_waitcnt lgkmcnt(4)
  v_mfma_f32_16x16x32_bf16 v[64:67], v[188:191], v[152:155], v[64:67]
  ds_read_b128 v[184:187], v6 offset:25600
  v_mfma_f32_16x16x32_bf16 v[68:71], v[188:191], v[156:159], v[68:71]
  s_waitcnt lgkmcnt(4)
  v_mfma_f32_16x16x32_bf16 v[16:19], v[192:195], v[160:163], v[16:19]
  ds_read_b128 v[188:191], v6 offset:26624
  v_mfma_f32_16x16x32_bf16 v[20:23], v[192:195], v[164:167], v[20:23]
  buffer_load_dwordx4 v[152:155], v2, s[40:43], s61 offen sc1
  buffer_load_dwordx4 v[156:159], v2, s[40:43], s61 offen offset:1024 sc1
  s_waitcnt lgkmcnt(4)
  v_mfma_f32_16x16x32_bf16 v[24:27], v[196:199], v[160:163], v[24:27]
  ds_read_b128 v[192:195], v6 offset:27648
  v_mfma_f32_16x16x32_bf16 v[28:31], v[196:199], v[164:167], v[28:31]
  s_waitcnt lgkmcnt(4)
  v_mfma_f32_16x16x32_bf16 v[32:35], v[176:179], v[160:163], v[32:35]
  ds_read_b128 v[196:199], v6 offset:28672
  v_mfma_f32_16x16x32_bf16 v[36:39], v[176:179], v[164:167], v[36:39]
  s_waitcnt lgkmcnt(4)
  v_mfma_f32_16x16x32_bf16 v[40:43], v[180:183], v[160:163], v[40:43]
  ds_read_b128 v[176:179], v6 offset:29696
  v_mfma_f32_16x16x32_bf16 v[44:47], v[180:183], v[164:167], v[44:47]
  s_waitcnt lgkmcnt(4)
  v_mfma_f32_16x16x32_bf16 v[48:51], v[184:187], v[160:163], v[48:51]
  ds_read_b128 v[180:183], v6 offset:30720
  v_mfma_f32_16x16x32_bf16 v[52:55], v[184:187], v[164:167], v[52:55]
  v_swap_b32 v170, v172
  v_swap_b32 v171, v173
  s_waitcnt lgkmcnt(4)
  v_mfma_f32_16x16x32_bf16 v[56:59], v[188:191], v[160:163], v[56:59]
  ds_read_b128 v[184:187], v6 offset:31744
  v_mfma_f32_16x16x32_bf16 v[60:63], v[188:191], v[164:167], v[60:63]
  s_waitcnt lgkmcnt(4)
  v_mfma_f32_16x16x32_bf16 v[64:67], v[192:195], v[160:163], v[64:67]
  ds_read_b128 v[188:191], v6 offset:32768
  v_mfma_f32_16x16x32_bf16 v[68:71], v[192:195], v[164:167], v[68:71]
  s_waitcnt lgkmcnt(4)
  v_mfma_f32_16x16x32_bf16 v[16:19], v[196:199], v[168:171], v[16:19]
  ds_read_b128 v[192:195], v6 offset:33792
  v_mfma_f32_16x16x32_bf16 v[20:23], v[196:199], v[172:175], v[20:23]
  buffer_load_dwordx4 v[160:163], v2, s[40:43], s62 offen sc1
  buffer_load_dwordx4 v[164:167], v2, s[40:43], s62 offen offset:1024 sc1
  s_waitcnt lgkmcnt(4)
  v_mfma_f32_16x16x32_bf16 v[24:27], v[176:179], v[168:171], v[24:27]
  ds_read_b128 v[196:199], v6 offset:34816
  v_mfma_f32_16x16x32_bf16 v[28:31], v[176:179], v[172:175], v[28:31]
  s_waitcnt lgkmcnt(4)
  v_mfma_f32_16x16x32_bf16 v[32:35], v[180:183], v[168:171], v[32:35]
  ds_read_b128 v[176:179], v6 offset:35840
  v_mfma_f32_16x16x32_bf16 v[36:39], v[180:183], v[172:175], v[36:39]
  s_waitcnt lgkmcnt(4)
  v_mfma_f32_16x16x32_bf16 v[40:43], v[184:187], v[168:171], v[40:43]
  ds_read_b128 v[180:183], v6 offset:36864
  v_mfma_f32_16x16x32_bf16 v[44:47], v[184:187], v[172:175], v[44:47]
  s_waitcnt lgkmcnt(4)
  v_mfma_f32_16x16x32_bf16 v[48:51], v[188:191], v[168:171], v[48:51]
  ds_read_b128 v[184:187], v6 offset:37888
  v_mfma_f32_16x16x32_bf16 v[52:55], v[188:191], v[172:175], v[52:55]
  s_waitcnt vmcnt(10)
  v_swap_b32 v130, v132
  v_swap_b32 v131, v133
  s_waitcnt lgkmcnt(4)
  v_mfma_f32_16x16x32_bf16 v[56:59], v[192:195], v[168:171], v[56:59]
  ds_read_b128 v[188:191], v6 offset:38912
  v_mfma_f32_16x16x32_bf16 v[60:63], v[192:195], v[172:175], v[60:63]
  s_waitcnt lgkmcnt(4)
  v_mfma_f32_16x16x32_bf16 v[64:67], v[196:199], v[168:171], v[64:67]
  ds_read_b128 v[192:195], v6 offset:39936
  s_waitcnt vmcnt(5)
  v_bitop3_b32 v224, v216, v217, v218 bitop3:0x80
  v_mfma_f32_16x16x32_bf16 v[68:71], v[196:199], v[172:175], v[68:71]
  s_waitcnt vmcnt(4)
  v_bitop3_b32 v225, v219, v220, v221 bitop3:0x80
  v_bitop3_b32 v224, v224, v222, v223 bitop3:0x80
  s_waitcnt lgkmcnt(4)
  v_mfma_f32_16x16x32_bf16 v[16:19], v[176:179], v[128:131], v[16:19]
  ds_read_b128 v[196:199], v6 offset:40960
  v_bitop3_b32 v224, v224, v225, 1 bitop3:0x80
  v_mfma_f32_16x16x32_bf16 v[20:23], v[176:179], v[132:135], v[20:23]
  buffer_load_dwordx4 v[168:171], v2, s[40:43], s63 offen sc1
  buffer_load_dwordx4 v[172:175], v2, s[40:43], s63 offen offset:1024 sc1
  s_waitcnt lgkmcnt(4)
  v_mfma_f32_16x16x32_bf16 v[24:27], v[180:183], v[128:131], v[24:27]
  ds_read_b128 v[176:179], v6 offset:41984
  v_cmp_eq_u32 vcc, 0, v224
  v_mfma_f32_16x16x32_bf16 v[28:31], v[180:183], v[132:135], v[28:31]
  s_cbranch_vccnz L_tp_15
L_tpb_16:
  v_add_f32 v216, v216, v220
  s_waitcnt lgkmcnt(4)
  v_mfma_f32_16x16x32_bf16 v[32:35], v[184:187], v[128:131], v[32:35]
  ds_read_b128 v[180:183], v6 offset:43008
  v_add_f32 v217, v217, v221
  v_mfma_f32_16x16x32_bf16 v[36:39], v[184:187], v[132:135], v[36:39]
  v_add_f32 v218, v218, v222
  v_add_f32 v219, v219, v223
  s_waitcnt lgkmcnt(4)
  v_mfma_f32_16x16x32_bf16 v[40:43], v[188:191], v[128:131], v[40:43]
  ds_read_b128 v[184:187], v6 offset:44032
  v_mul_f32 v216, 0x3acccccd, v216
  v_mfma_f32_16x16x32_bf16 v[44:47], v[188:191], v[132:135], v[44:47]
  v_mul_f32 v217, 0x3acccccd, v217
  v_mul_f32 v218, 0x3acccccd, v218
  s_waitcnt lgkmcnt(4)
  v_mfma_f32_16x16x32_bf16 v[48:51], v[192:195], v[128:131], v[48:51]
  ds_read_b128 v[188:191], v6 offset:45056
  v_mul_f32 v219, 0x3acccccd, v219
  v_mfma_f32_16x16x32_bf16 v[52:55], v[192:195], v[132:135], v[52:55]
  v_swap_b32 v138, v140
  v_swap_b32 v139, v141
  s_waitcnt lgkmcnt(4)
  v_mfma_f32_16x16x32_bf16 v[56:59], v[196:199], v[128:131], v[56:59]
  ds_read_b128 v[192:195], v6 offset:46080
  v_fma_f32 v217, -v216, v216, v217
  v_mfma_f32_16x16x32_bf16 v[60:63], v[196:199], v[132:135], v[60:63]
  v_fma_f32 v219, -v218, v218, v219
  v_max_f32 v217, 0, v217
  s_waitcnt lgkmcnt(4)
  v_mfma_f32_16x16x32_bf16 v[64:67], v[176:179], v[128:131], v[64:67]
  ds_read_b128 v[196:199], v6 offset:47104
  v_max_f32 v219, 0, v219
  v_mfma_f32_16x16x32_bf16 v[68:71], v[176:179], v[132:135], v[68:71]
  v_add_f32 v217, 0x3727c5ac, v217
  v_add_f32 v219, 0x3727c5ac, v219
  s_waitcnt lgkmcnt(4)
  v_mfma_f32_16x16x32_bf16 v[16:19], v[180:183], v[136:139], v[16:19]
  ds_read_b128 v[176:179], v6 offset:48128
  v_mfma_f32_16x16x32_bf16 v[20:23], v[180:183], v[140:143], v[20:23]
  buffer_load_dwordx4 v[128:131], v2, s[40:43], s64 offen sc1
  buffer_load_dwordx4 v[132:135], v2, s[40:43], s64 offen offset:1024 sc1
  s_waitcnt lgkmcnt(4)
  v_mfma_f32_16x16x32_bf16 v[24:27], v[184:187], v[136:139], v[24:27]
  ds_read_b128 v[180:183], v6 offset:49152
  v_mfma_f32_16x16x32_bf16 v[28:31], v[184:187], v[140:143], v[28:31]
  v_rsq_f32 v216, v217
  s_waitcnt lgkmcnt(4)
  v_mfma_f32_16x16x32_bf16 v[32:35], v[188:191], v[136:139], v[32:35]
  ds_read_b128 v[184:187], v6 offset:50176
  v_mfma_f32_16x16x32_bf16 v[36:39], v[188:191], v[140:143], v[36:39]
  v_rsq_f32 v218, v219
  s_waitcnt lgkmcnt(4)
  v_mfma_f32_16x16x32_bf16 v[40:43], v[192:195], v[136:139], v[40:43]
  ds_read_b128 v[188:191], v6 offset:51200
  v_mfma_f32_16x16x32_bf16 v[44:47], v[192:195], v[140:143], v[44:47]
  v_rcp_f32 v201, v217
  s_waitcnt lgkmcnt(4)
  v_mfma_f32_16x16x32_bf16 v[48:51], v[196:199], v[136:139], v[48:51]
  ds_read_b128 v[192:195], v6 offset:52224
  v_mfma_f32_16x16x32_bf16 v[52:55], v[196:199], v[140:143], v[52:55]
  v_swap_b32 v146, v148
  v_swap_b32 v147, v149
  s_waitcnt lgkmcnt(4)
  v_mfma_f32_16x16x32_bf16 v[56:59], v[176:179], v[136:139], v[56:59]
  ds_read_b128 v[196:199], v6 offset:53248
  v_mfma_f32_16x16x32_bf16 v[60:63], v[176:179], v[140:143], v[60:63]
  v_rcp_f32 v204, v219
  s_waitcnt lgkmcnt(4)
  v_mfma_f32_16x16x32_bf16 v[64:67], v[180:183], v[136:139], v[64:67]
  ds_read_b128 v[176:179], v6 offset:54272
  v_mul_f32 v200, 0xc0135761, v216
  v_mfma_f32_16x16x32_bf16 v[68:71], v[180:183], v[140:143], v[68:71]
  v_mov_b32 v202, v217
  v_mul_f32 v203, 0xc0135761, v218
  v_mov_b32 v205, v219
  v_mul_f32 v201, 0x3d372713, v201
  v_mul_f32 v204, 0x3d372713, v204
  v_mul_f32 v201, v201, v200
  v_mul_f32 v204, v204, v203
  s_waitcnt lgkmcnt(4)
  v_mfma_f32_16x16x32_bf16 v[72:75], v[184:187], v[144:147], 0
  ds_read_b128 v[180:183], v6 offset:55296
  s_lshr_b32 s80, s32, 1
  s_mul_i32 s81, s80, 81920
  v_mfma_f32_16x16x32_bf16 v[76:79], v[184:187], v[148:151], 0
  buffer_load_dwordx4 v[136:139], v2, s[40:43], s65 offen sc1
  buffer_load_dwordx4 v[140:143], v2, s[40:43], s65 offen offset:1024 sc1
  s_and_b32 s82, s32, 1
  s_waitcnt lgkmcnt(4)
  v_mfma_f32_16x16x32_bf16 v[80:83], v[188:191], v[144:147], 0
  ds_read_b128 v[184:187], v6 offset:56320
  s_lshl_b32 s82, s82, 4
  s_lshl_b32 s83, s91, 5
  v_mfma_f32_16x16x32_bf16 v[84:87], v[188:191], v[148:151], 0
  buffer_load_dwordx4 a[132:135], v254, s[36:39], s86 offen sc1
  s_add_u32 s82, s82, s83
  s_add_u32 s81, s81, s82
  s_waitcnt lgkmcnt(4)
  v_mfma_f32_16x16x32_bf16 v[88:91], v[192:195], v[144:147], 0
  ds_read_b128 v[188:191], v6 offset:57344
  s_mul_i32 s83, s90, 327680
  s_add_u32 s81, s81, s83
  v_mfma_f32_16x16x32_bf16 v[92:95], v[192:195], v[148:151], 0
  s_add_u32 s81, s81, 0x1228000
  v_lshl_add_u32 v224, v1, 10, s81
  v_lshl_add_u32 v225, v11, 3, s81
  s_waitcnt lgkmcnt(4)
  v_mfma_f32_16x16x32_bf16 v[96:99], v[196:199], v[144:147], 0
  ds_read_b128 v[192:195], v6 offset:58368
  v_and_b32 v226, 0x80000000, v11
  v_or_b32 v225, v226, v225
  v_mfma_f32_16x16x32_bf16 v[100:103], v[196:199], v[148:151], 0
  buffer_load_dwordx4 v[216:219], v224, s[36:39], 0 offen sc1
  buffer_load_dwordx4 v[220:223], v225, s[36:39], s68 offen sc1
  s_lshl_b32 s80, s80, 10
  s_waitcnt lgkmcnt(4)
  v_mfma_f32_16x16x32_bf16 v[104:107], v[176:179], v[144:147], 0
  ds_read_b128 v[196:199], v6 offset:59392
  s_add_u32 s80, s80, s82
  s_lshl_b32 s81, s90, 12
  v_mfma_f32_16x16x32_bf16 v[108:111], v[176:179], v[148:151], 0
  s_waitcnt vmcnt(11)
  v_swap_b32 v154, v156
  v_swap_b32 v155, v157
  s_add_u32 s80, s80, s81
  s_waitcnt lgkmcnt(4)
  v_mfma_f32_16x16x32_bf16 v[112:115], v[180:183], v[144:147], 0
  buffer_load_dwordx4 a[136:139], v255, s[36:39], s86 offen sc1
  ds_read_b128 v[176:179], v6 offset:60416
  s_add_u32 s85, s80, 0x2a00800
  v_mul_f32 v212, v64, v64
  v_mfma_f32_16x16x32_bf16 v[116:119], v[180:183], v[148:151], 0
  v_mul_f32 v213, v65, v65
  v_fma_f32 v212, v212, v201, v200
  v_fma_f32 v213, v213, v201, v200
  v_mul_f32 v212, v212, v64
  s_waitcnt lgkmcnt(4)
  v_mfma_f32_16x16x32_bf16 v[120:123], v[184:187], v[144:147], 0
  ds_read_b128 v[180:183], v6 offset:61440
  v_mul_f32 v213, v213, v65
  v_exp_f32 v212, v212
  v_mfma_f32_16x16x32_bf16 v[124:127], v[184:187], v[148:151], 0
  v_exp_f32 v213, v213
  v_mul_f32 v64, v64, v66
  v_mul_f32 v65, v65, v67
  s_waitcnt lgkmcnt(4)
  v_mfma_f32_16x16x32_bf16 v[72:75], v[188:191], v[152:155], v[72:75]
  ds_read_b128 v[184:187], v6 offset:62464
  v_fma_f32 v212, v212, v202, v202
  v_fma_f32 v213, v213, v202, v202
  v_mfma_f32_16x16x32_bf16 v[76:79], v[188:191], v[156:159], v[76:79]
  buffer_load_dwordx4 v[144:147], v2, s[40:43], s66 offen sc1
  buffer_load_dwordx4 v[148:151], v2, s[40:43], s66 offen offset:1024 sc1
  v_rcp_f32 v212, v212
  s_waitcnt lgkmcnt(4)
  v_mfma_f32_16x16x32_bf16 v[80:83], v[192:195], v[152:155], v[80:83]
  ds_read_b128 v[188:191], v6 offset:63488
  v_rcp_f32 v213, v213
  v_mul_f32 v64, v64, v212
  v_mfma_f32_16x16x32_bf16 v[84:87], v[192:195], v[156:159], v[84:87]
  s_mov_b32 s86, 35840
  buffer_load_dwordx4 a[140:143], v251, s[36:39], s86 offen sc1
  v_mul_f32 v65, v65, v213
  v_cvt_pk_bf16_f32 v208, v64, v65
  s_waitcnt lgkmcnt(4)
  v_mfma_f32_16x16x32_bf16 v[88:91], v[196:199], v[152:155], v[88:91]
  ds_read_b128 v[192:195], v7 offset:0
  v_mul_f32 v212, v68, v68
  v_mul_f32 v213, v69, v69
  v_fma_f32 v212, v212, v204, v203
  v_mfma_f32_16x16x32_bf16 v[92:95], v[196:199], v[156:159], v[92:95]
  v_fma_f32 v213, v213, v204, v203
  v_mul_f32 v212, v212, v68
  v_mul_f32 v213, v213, v69
  s_waitcnt lgkmcnt(4)
  v_mfma_f32_16x16x32_bf16 v[96:99], v[176:179], v[152:155], v[96:99]
  ds_read_b128 v[196:199], v7 offset:1024
  v_exp_f32 v212, v212
  v_mfma_f32_16x16x32_bf16 v[100:103], v[176:179], v[156:159], v[100:103]
  v_exp_f32 v213, v213
  v_mul_f32 v68, v68, v70
  v_mul_f32 v69, v69, v71
  s_waitcnt lgkmcnt(4)
  v_mfma_f32_16x16x32_bf16 v[104:107], v[180:183], v[152:155], v[104:107]
  ds_read_b128 v[176:179], v7 offset:2048
  v_fma_f32 v212, v212, v205, v205
  v_fma_f32 v213, v213, v205, v205
  v_mfma_f32_16x16x32_bf16 v[108:111], v[180:183], v[156:159], v[108:111]
  s_waitcnt vmcnt(13)
  v_swap_b32 v162, v164
  v_swap_b32 v163, v165
  v_rcp_f32 v212, v212
  s_waitcnt lgkmcnt(4)
  v_mfma_f32_16x16x32_bf16 v[112:115], v[184:187], v[152:155], v[112:115]
  buffer_load_dwordx4 a[144:147], v252, s[36:39], s86 offen sc1
  ds_read_b128 v[180:183], v7 offset:3072
  v_rcp_f32 v213, v213
  v_mfma_f32_16x16x32_bf16 v[116:119], v[184:187], v[156:159], v[116:119]
  v_mul_f32 v68, v68, v212
  v_mul_f32 v69, v69, v213
  v_cvt_pk_bf16_f32 v209, v68, v69
  s_nop 1
  v_permlane16_swap_b32 v208, v209
  s_waitcnt lgkmcnt(4)
  v_mfma_f32_16x16x32_bf16 v[120:123], v[188:191], v[152:155], v[120:123]
  ds_read_b128 v[184:187], v7 offset:4096
  s_mov_b32 s80, 0x1b00000
  buffer_store_dwordx2 v[208:209], v9, s[36:39], s80 offen sc1
  v_mul_f32 v212, v16, v16
  v_mfma_f32_16x16x32_bf16 v[124:127], v[188:191], v[156:159], v[124:127]
  v_mul_f32 v213, v17, v17
  v_mul_f32 v214, v18, v18
  v_mul_f32 v215, v19, v19
  v_fma_f32 v212, v212, v201, v200
  s_waitcnt lgkmcnt(4)
  v_mfma_f32_16x16x32_bf16 v[72:75], v[192:195], v[160:163], v[72:75]
  ds_read_b128 v[188:191], v7 offset:5120
  v_fma_f32 v213, v213, v201, v200
  v_fma_f32 v214, v214, v201, v200
  v_fma_f32 v215, v215, v201, v200
  v_mfma_f32_16x16x32_bf16 v[76:79], v[192:195], v[164:167], v[76:79]
  buffer_load_dwordx4 v[152:155], v2, s[40:43], s67 offen sc1
  buffer_load_dwordx4 v[156:159], v2, s[40:43], s67 offen offset:1024 sc1
  v_mul_f32 v212, v212, v16
  v_mul_f32 v213, v213, v17
  s_waitcnt lgkmcnt(4)
  v_mfma_f32_16x16x32_bf16 v[80:83], v[196:199], v[160:163], v[80:83]
  ds_read_b128 v[192:195], v7 offset:6144
  v_mul_f32 v214, v214, v18
  v_mul_f32 v215, v215, v19
  v_mfma_f32_16x16x32_bf16 v[84:87], v[196:199], v[164:167], v[84:87]
  buffer_load_dwordx4 a[148:151], v253, s[36:39], s86 offen sc1
  v_exp_f32 v212, v212
  s_waitcnt lgkmcnt(4)
  v_mfma_f32_16x16x32_bf16 v[88:91], v[176:179], v[160:163], v[88:91]
  ds_read_b128 v[196:199], v7 offset:7168
  v_exp_f32 v213, v213
  s_mov_b32 s81, 0x3f803f80
  v_mfma_f32_16x16x32_bf16 v[92:95], v[176:179], v[164:167], v[92:95]
  s_waitcnt vmcnt(10)
  v_dot2_f32_bf16 v224, v216, s81, 0
  v_dot2_f32_bf16 v225, v216, v216, 0
  v_dot2_f32_bf16 v226, v218, s81, 0
  v_dot2_f32_bf16 v227, v218, v218, 0
  s_waitcnt lgkmcnt(4)
  v_mfma_f32_16x16x32_bf16 v[96:99], v[180:183], v[160:163], v[96:99]
  ds_read_b128 v[176:179], v7 offset:8192
  v_dot2_f32_bf16 v224, v217, s81, v224
  v_dot2_f32_bf16 v225, v217, v217, v225
  v_dot2_f32_bf16 v226, v219, s81, v226
  v_mfma_f32_16x16x32_bf16 v[100:103], v[180:183], v[164:167], v[100:103]
  v_dot2_f32_bf16 v227, v219, v219, v227
  s_waitcnt vmcnt(9)
  v_dot2_f32_bf16 v224, v220, s81, v224
  v_dot2_f32_bf16 v225, v220, v220, v225
  v_dot2_f32_bf16 v226, v222, s81, v226
  s_waitcnt lgkmcnt(4)
  v_mfma_f32_16x16x32_bf16 v[104:107], v[184:187], v[160:163], v[104:107]
  ds_read_b128 v[180:183], v7 offset:9216
  v_dot2_f32_bf16 v227, v222, v222, v227
  v_dot2_f32_bf16 v224, v221, s81, v224
  v_dot2_f32_bf16 v225, v221, v221, v225
  v_mfma_f32_16x16x32_bf16 v[108:111], v[184:187], v[164:167], v[108:111]
  v_swap_b32 v170, v172
  v_swap_b32 v171, v173
  v_dot2_f32_bf16 v226, v223, s81, v226
  v_dot2_f32_bf16 v227, v223, v223, v227
  s_waitcnt lgkmcnt(4)
  v_mfma_f32_16x16x32_bf16 v[112:115], v[188:191], v[160:163], v[112:115]
  buffer_load_dwordx4 a[152:155], v254, s[36:39], s86 offen sc1
  ds_read_b128 v[184:187], v7 offset:10240
  v_lshrrev_b32 v216, 4, v1
  v_lshl_add_u32 v216, v216, 2, s85
  v_mfma_f32_16x16x32_bf16 v[116:119], v[188:191], v[164:167], v[116:119]
  v_and_b32 v217, 15, v1
  v_cmp_eq_u32 vcc, 0, v217
  v_mov_b32 v217, 0x80000000
  s_nop 0
  v_cndmask_b32 v216, v217, v216, vcc
  s_waitcnt lgkmcnt(4)
  v_mfma_f32_16x16x32_bf16 v[120:123], v[192:195], v[160:163], v[120:123]
  ds_read_b128 v[188:191], v7 offset:11264
  v_permlane32_swap_b32 v224, v226
  v_permlane32_swap_b32 v225, v227
  v_add_f32 v224, v224, v226
  v_mfma_f32_16x16x32_bf16 v[124:127], v[192:195], v[164:167], v[124:127]
  v_add_f32 v225, v225, v227
  s_nop 1
  v_permlane16_swap_b32 v224, v225
  v_add_f32 v224, v224, v225
  s_nop 1
  v_add_f32_dpp v224, v224, v224 row_ror:1 row_mask:0xf bank_mask:0xf
  s_waitcnt lgkmcnt(4)
  v_mfma_f32_16x16x32_bf16 v[72:75], v[196:199], v[168:171], v[72:75]
  ds_read_b128 v[192:195], v7 offset:12288
  v_add_f32_dpp v224, v224, v224 row_ror:2 row_mask:0xf bank_mask:0xf
  s_nop 1
  v_add_f32_dpp v224, v224, v224 row_ror:4 row_mask:0xf bank_mask:0xf
  s_nop 1
  v_add_f32_dpp v224, v224, v224 row_ror:8 row_mask:0xf bank_mask:0xf
  v_mfma_f32_16x16x32_bf16 v[76:79], v[196:199], v[172:175], v[76:79]
  buffer_load_dwordx4 v[160:163], v2, s[40:43], s68 offen sc1
  buffer_load_dwordx4 v[164:167], v2, s[40:43], s68 offen offset:1024 sc1
  v_or_b32 v224, 1, v224
  buffer_store_dword v224, v216, s[36:39], 0 offen sc1
  s_waitcnt lgkmcnt(4)
  v_mfma_f32_16x16x32_bf16 v[80:83], v[176:179], v[168:171], v[80:83]
  ds_read_b128 v[196:199], v7 offset:13312
  v_exp_f32 v214, v214
  v_mfma_f32_16x16x32_bf16 v[84:87], v[176:179], v[172:175], v[84:87]
  buffer_load_dwordx4 a[156:159], v255, s[36:39], s86 offen sc1
  v_exp_f32 v215, v215
  v_mul_f32 v16, v16, v24
  s_waitcnt lgkmcnt(4)
  v_mfma_f32_16x16x32_bf16 v[88:91], v[180:183], v[168:171], v[88:91]
  ds_read_b128 v[176:179], v5 offset:0
  v_mul_f32 v17, v17, v25
  v_mul_f32 v18, v18, v26
  v_mul_f32 v19, v19, v27
  v_mfma_f32_16x16x32_bf16 v[92:95], v[180:183], v[172:175], v[92:95]
  v_fma_f32 v212, v212, v202, v202
  v_fma_f32 v213, v213, v202, v202
  v_fma_f32 v214, v214, v202, v202
  v_fma_f32 v215, v215, v202, v202
  s_waitcnt lgkmcnt(4)
  v_mfma_f32_16x16x32_bf16 v[96:99], v[184:187], v[168:171], v[96:99]
  ds_read_b128 v[180:183], v5 offset:1024
  v_rcp_f32 v212, v212
  v_mfma_f32_16x16x32_bf16 v[100:103], v[184:187], v[172:175], v[100:103]
  v_rcp_f32 v213, v213
  v_rcp_f32 v214, v214
  s_waitcnt lgkmcnt(4)
  v_mfma_f32_16x16x32_bf16 v[104:107], v[188:191], v[168:171], v[104:107]
  ds_read_b128 v[184:187], v5 offset:2048
  v_rcp_f32 v215, v215
  v_mul_f32 v16, v16, v212
  v_mfma_f32_16x16x32_bf16 v[108:111], v[188:191], v[172:175], v[108:111]
  v_swap_b32 v130, v132
  v_swap_b32 v131, v133
  v_mul_f32 v17, v17, v213
  v_mul_f32 v18, v18, v214
  s_waitcnt lgkmcnt(4)
  v_mfma_f32_16x16x32_bf16 v[112:115], v[192:195], v[168:171], v[112:115]
  s_mov_b32 s86, 40960
  buffer_load_dwordx4 a[160:163], v251, s[36:39], s86 offen sc1
  ds_read_b128 v[188:191], v5 offset:3072
  v_mul_f32 v19, v19, v215
  v_mfma_f32_16x16x32_bf16 v[116:119], v[192:195], v[172:175], v[116:119]
  v_cvt_pk_bf16_f32 v208, v16, v17
  v_cvt_pk_bf16_f32 v209, v18, v19
  v_mul_f32 v212, v20, v20
  v_mul_f32 v213, v21, v21
  s_waitcnt lgkmcnt(4)
  v_mfma_f32_16x16x32_bf16 v[120:123], v[196:199], v[168:171], v[120:123]
  ds_read_b128 v[192:195], v5 offset:4096
  v_mul_f32 v214, v22, v22
  v_mul_f32 v215, v23, v23
  v_fma_f32 v212, v212, v204, v203
  v_mfma_f32_16x16x32_bf16 v[124:127], v[196:199], v[172:175], v[124:127]
  v_fma_f32 v213, v213, v204, v203
  v_fma_f32 v214, v214, v204, v203
  v_fma_f32 v215, v215, v204, v203
  v_mul_f32 v212, v212, v20
  s_waitcnt lgkmcnt(4)
  v_mfma_f32_16x16x32_bf16 v[72:75], v[176:179], v[128:131], v[72:75]
  ds_read_b128 v[196:199], v5 offset:5120
  v_mul_f32 v213, v213, v21
  v_mul_f32 v214, v214, v22
  v_mul_f32 v215, v215, v23
  v_mfma_f32_16x16x32_bf16 v[76:79], v[176:179], v[132:135], v[76:79]
  buffer_load_dwordx4 v[168:171], v2, s[40:43], s69 offen sc1
  buffer_load_dwordx4 v[172:175], v2, s[40:43], s69 offen offset:1024 sc1
  v_exp_f32 v212, v212
  s_waitcnt lgkmcnt(4)
  v_mfma_f32_16x16x32_bf16 v[80:83], v[180:183], v[128:131], v[80:83]
  ds_read_b128 v[176:179], v5 offset:6144
  v_exp_f32 v213, v213
  v_mfma_f32_16x16x32_bf16 v[84:87], v[180:183], v[132:135], v[84:87]
  buffer_load_dwordx4 a[164:167], v252, s[36:39], s86 offen sc1
  v_exp_f32 v214, v214
  s_waitcnt lgkmcnt(4)
  v_mfma_f32_16x16x32_bf16 v[88:91], v[184:187], v[128:131], v[88:91]
  ds_read_b128 v[180:183], v5 offset:7168
  v_exp_f32 v215, v215
  v_mul_f32 v20, v20, v28
  v_mfma_f32_16x16x32_bf16 v[92:95], v[184:187], v[132:135], v[92:95]
  v_mul_f32 v21, v21, v29
  v_mul_f32 v22, v22, v30
  v_mul_f32 v23, v23, v31
  v_fma_f32 v212, v212, v205, v205
  s_waitcnt lgkmcnt(4)
  v_mfma_f32_16x16x32_bf16 v[96:99], v[188:191], v[128:131], v[96:99]
  ds_read_b128 v[184:187], v5 offset:8192
  v_fma_f32 v213, v213, v205, v205
  v_fma_f32 v214, v214, v205, v205
  v_fma_f32 v215, v215, v205, v205
  v_mfma_f32_16x16x32_bf16 v[100:103], v[188:191], v[132:135], v[100:103]
  v_rcp_f32 v212, v212
  v_rcp_f32 v213, v213
  s_waitcnt lgkmcnt(4)
  v_mfma_f32_16x16x32_bf16 v[104:107], v[192:195], v[128:131], v[104:107]
  ds_read_b128 v[188:191], v5 offset:9216
  v_rcp_f32 v214, v214
  v_mfma_f32_16x16x32_bf16 v[108:111], v[192:195], v[132:135], v[108:111]
  v_swap_b32 v138, v140
  v_swap_b32 v139, v141
  v_rcp_f32 v215, v215
  s_waitcnt lgkmcnt(4)
  v_mfma_f32_16x16x32_bf16 v[112:115], v[196:199], v[128:131], v[112:115]
  buffer_load_dwordx4 a[168:171], v253, s[36:39], s86 offen sc1
  ds_read_b128 v[192:195], v5 offset:10240
  v_mul_f32 v20, v20, v212
  v_mul_f32 v21, v21, v213
  v_mfma_f32_16x16x32_bf16 v[116:119], v[196:199], v[132:135], v[116:119]
  v_mul_f32 v22, v22, v214
  v_mul_f32 v23, v23, v215
  v_cvt_pk_bf16_f32 v210, v20, v21
  v_cvt_pk_bf16_f32 v211, v22, v23
  s_waitcnt lgkmcnt(4)
  v_mfma_f32_16x16x32_bf16 v[120:123], v[176:179], v[128:131], v[120:123]
  ds_read_b128 v[196:199], v5 offset:11264
  s_mov_b32 s80, 0x1b00000
  buffer_store_dwordx4 v[208:211], v8, s[36:39], s80 offen sc1
  v_mul_f32 v212, v32, v32
  v_mfma_f32_16x16x32_bf16 v[124:127], v[176:179], v[132:135], v[124:127]
  v_mul_f32 v213, v33, v33
  v_mul_f32 v214, v34, v34
  v_mul_f32 v215, v35, v35
  v_fma_f32 v212, v212, v201, v200
  s_waitcnt lgkmcnt(4)
  v_mfma_f32_16x16x32_bf16 v[72:75], v[180:183], v[136:139], v[72:75]
  ds_read_b128 v[176:179], v5 offset:12288
  v_fma_f32 v213, v213, v201, v200
  v_fma_f32 v214, v214, v201, v200
  v_fma_f32 v215, v215, v201, v200
  v_mfma_f32_16x16x32_bf16 v[76:79], v[180:183], v[140:143], v[76:79]
  buffer_load_dwordx4 v[128:131], v2, s[40:43], s70 offen sc1
  buffer_load_dwordx4 v[132:135], v2, s[40:43], s70 offen offset:1024 sc1
  v_mul_f32 v212, v212, v32
  v_mul_f32 v213, v213, v33
  s_waitcnt lgkmcnt(4)
  v_mfma_f32_16x16x32_bf16 v[80:83], v[184:187], v[136:139], v[80:83]
  ds_read_b128 v[180:183], v5 offset:13312
  v_mul_f32 v214, v214, v34
  v_mul_f32 v215, v215, v35
  v_mfma_f32_16x16x32_bf16 v[84:87], v[184:187], v[140:143], v[84:87]
  buffer_load_dwordx4 a[172:175], v254, s[36:39], s86 offen sc1
  v_exp_f32 v212, v212
  s_waitcnt lgkmcnt(4)
  v_mfma_f32_16x16x32_bf16 v[88:91], v[188:191], v[136:139], v[88:91]
  ds_read_b128 v[184:187], v5 offset:14336
  v_exp_f32 v213, v213
  v_mfma_f32_16x16x32_bf16 v[92:95], v[188:191], v[140:143], v[92:95]
  v_exp_f32 v214, v214
  v_exp_f32 v215, v215
  s_waitcnt lgkmcnt(4)
  v_mfma_f32_16x16x32_bf16 v[96:99], v[192:195], v[136:139], v[96:99]
  ds_read_b128 v[188:191], v5 offset:15360
  v_mul_f32 v32, v32, v40
  v_mul_f32 v33, v33, v41
  v_mul_f32 v34, v34, v42
  v_mfma_f32_16x16x32_bf16 v[100:103], v[192:195], v[140:143], v[100:103]
  v_mul_f32 v35, v35, v43
  v_fma_f32 v212, v212, v202, v202
  v_fma_f32 v213, v213, v202, v202
  v_fma_f32 v214, v214, v202, v202
  s_waitcnt lgkmcnt(4)
  v_mfma_f32_16x16x32_bf16 v[104:107], v[196:199], v[136:139], v[104:107]
  ds_read_b128 v[192:195], v5 offset:16384
  v_fma_f32 v215, v215, v202, v202
  v_rcp_f32 v212, v212
  v_mfma_f32_16x16x32_bf16 v[108:111], v[196:199], v[140:143], v[108:111]
  s_waitcnt vmcnt(20)
  v_swap_b32 v146, v148
  v_swap_b32 v147, v149
  v_rcp_f32 v213, v213
  s_waitcnt lgkmcnt(4)
  v_mfma_f32_16x16x32_bf16 v[112:115], v[176:179], v[136:139], v[112:115]
  buffer_load_dwordx4 a[176:179], v255, s[36:39], s86 offen sc1
  ds_read_b128 v[196:199], v5 offset:17408
  v_rcp_f32 v214, v214
  v_mfma_f32_16x16x32_bf16 v[116:119], v[176:179], v[140:143], v[116:119]
  v_rcp_f32 v215, v215
  v_mul_f32 v32, v32, v212
  v_mul_f32 v33, v33, v213
  s_waitcnt lgkmcnt(4)
  v_mfma_f32_16x16x32_bf16 v[120:123], v[180:183], v[136:139], v[120:123]
  ds_read_b128 v[176:179], v5 offset:18432
  v_mul_f32 v34, v34, v214
  v_mul_f32 v35, v35, v215
  v_cvt_pk_bf16_f32 v208, v32, v33
  v_mfma_f32_16x16x32_bf16 v[124:127], v[180:183], v[140:143], v[124:127]
  v_cvt_pk_bf16_f32 v209, v34, v35
  v_mul_f32 v212, v36, v36
  v_mul_f32 v213, v37, v37
  v_mul_f32 v214, v38, v38
  s_waitcnt lgkmcnt(4)
  v_mfma_f32_16x16x32_bf16 v[72:75], v[184:187], v[144:147], v[72:75]
  ds_read_b128 v[180:183], v5 offset:19456
  v_mul_f32 v215, v39, v39
  v_fma_f32 v212, v212, v204, v203
  v_fma_f32 v213, v213, v204, v203
  v_mfma_f32_16x16x32_bf16 v[76:79], v[184:187], v[148:151], v[76:79]
  buffer_load_dwordx4 v[136:139], v2, s[40:43], s71 offen sc1
  buffer_load_dwordx4 v[140:143], v2, s[40:43], s71 offen offset:1024 sc1
  v_fma_f32 v214, v214, v204, v203
  v_fma_f32 v215, v215, v204, v203
  s_waitcnt lgkmcnt(4)
  v_mfma_f32_16x16x32_bf16 v[80:83], v[188:191], v[144:147], v[80:83]
  ds_read_b128 v[184:187], v5 offset:20480
  v_mul_f32 v212, v212, v36
  v_mul_f32 v213, v213, v37
  v_mul_f32 v214, v214, v38
  v_mfma_f32_16x16x32_bf16 v[84:87], v[188:191], v[148:151], v[84:87]
  s_mov_b32 s86, 46080
  buffer_load_dwordx4 a[180:183], v251, s[36:39], s86 offen sc1
  v_mul_f32 v215, v215, v39
  s_waitcnt lgkmcnt(4)
  v_mfma_f32_16x16x32_bf16 v[88:91], v[192:195], v[144:147], v[88:91]
  ds_read_b128 v[188:191], v5 offset:21504
  v_exp_f32 v212, v212
  v_mfma_f32_16x16x32_bf16 v[92:95], v[192:195], v[148:151], v[92:95]
  v_exp_f32 v213, v213
  v_exp_f32 v214, v214
  s_waitcnt lgkmcnt(4)
  v_mfma_f32_16x16x32_bf16 v[96:99], v[196:199], v[144:147], v[96:99]
  ds_read_b128 v[192:195], v5 offset:22528
  v_exp_f32 v215, v215
  v_mul_f32 v36, v36, v44
  v_mfma_f32_16x16x32_bf16 v[100:103], v[196:199], v[148:151], v[100:103]
  v_mul_f32 v37, v37, v45
  v_mul_f32 v38, v38, v46
  v_mul_f32 v39, v39, v47
  v_fma_f32 v212, v212, v205, v205
  s_waitcnt lgkmcnt(4)
  v_mfma_f32_16x16x32_bf16 v[104:107], v[176:179], v[144:147], v[104:107]
  ds_read_b128 v[196:199], v5 offset:23552
  v_fma_f32 v213, v213, v205, v205
  v_fma_f32 v214, v214, v205, v205
  v_fma_f32 v215, v215, v205, v205
  v_mfma_f32_16x16x32_bf16 v[108:111], v[176:179], v[148:151], v[108:111]
  s_waitcnt vmcnt(19)
  v_swap_b32 v154, v156
  v_swap_b32 v155, v157
  v_rcp_f32 v212, v212
  s_waitcnt lgkmcnt(4)
  v_mfma_f32_16x16x32_bf16 v[112:115], v[180:183], v[144:147], v[112:115]
  ds_read_b128 v[176:179], v5 offset:24576
  v_rcp_f32 v213, v213
  v_mfma_f32_16x16x32_bf16 v[116:119], v[180:183], v[148:151], v[116:119]
  buffer_load_dwordx4 a[184:187], v252, s[36:39], s86 offen sc1
  v_rcp_f32 v214, v214
  s_waitcnt lgkmcnt(4)
  v_mfma_f32_16x16x32_bf16 v[120:123], v[184:187], v[144:147], v[120:123]
  ds_read_b128 v[180:183], v5 offset:25600
  v_rcp_f32 v215, v215
  v_mul_f32 v36, v36, v212
  v_mfma_f32_16x16x32_bf16 v[124:127], v[184:187], v[148:151], v[124:127]
  v_mul_f32 v37, v37, v213
  v_mul_f32 v38, v38, v214
  v_mul_f32 v39, v39, v215
  v_cvt_pk_bf16_f32 v210, v36, v37
  s_waitcnt lgkmcnt(4)
  v_mfma_f32_16x16x32_bf16 v[72:75], v[188:191], v[152:155], v[72:75]
  ds_read_b128 v[184:187], v5 offset:26624
  v_cvt_pk_bf16_f32 v211, v38, v39
  s_mov_b32 s80, 0x1b01000
  buffer_store_dwordx4 v[208:211], v8, s[36:39], s80 offen sc1
  v_mfma_f32_16x16x32_bf16 v[76:79], v[188:191], v[156:159], v[76:79]
  buffer_load_dwordx4 v[144:147], v2, s[40:43], s72 offen sc1
  buffer_load_dwordx4 v[148:151], v2, s[40:43], s72 offen offset:1024 sc1
  v_mul_f32 v212, v48, v48
  v_mul_f32 v213, v49, v49
  s_waitcnt lgkmcnt(4)
  v_mfma_f32_16x16x32_bf16 v[80:83], v[192:195], v[152:155], v[80:83]
  ds_read_b128 v[188:191], v5 offset:27648
  v_mul_f32 v214, v50, v50
  v_mul_f32 v215, v51, v51
  v_fma_f32 v212, v212, v201, v200
  v_mfma_f32_16x16x32_bf16 v[84:87], v[192:195], v[156:159], v[84:87]
  v_fma_f32 v213, v213, v201, v200
  v_fma_f32 v214, v214, v201, v200
  v_fma_f32 v215, v215, v201, v200
  v_mul_f32 v212, v212, v48
  s_waitcnt lgkmcnt(4)
  v_mfma_f32_16x16x32_bf16 v[88:91], v[196:199], v[152:155], v[88:91]
  buffer_load_dwordx4 a[188:191], v253, s[36:39], s86 offen sc1
  ds_read_b128 v[192:195], v5 offset:28672
  v_mul_f32 v213, v213, v49
  v_mul_f32 v214, v214, v50
  v_mfma_f32_16x16x32_bf16 v[92:95], v[196:199], v[156:159], v[92:95]
  v_mul_f32 v215, v215, v51
  v_exp_f32 v212, v212
  s_waitcnt lgkmcnt(4)
  v_mfma_f32_16x16x32_bf16 v[96:99], v[176:179], v[152:155], v[96:99]
  ds_read_b128 v[196:199], v5 offset:29696
  v_exp_f32 v213, v213
  v_mfma_f32_16x16x32_bf16 v[100:103], v[176:179], v[156:159], v[100:103]
  v_exp_f32 v214, v214
  v_exp_f32 v215, v215
  s_waitcnt lgkmcnt(4)
  v_mfma_f32_16x16x32_bf16 v[104:107], v[180:183], v[152:155], v[104:107]
  ds_read_b128 v[176:179], v5 offset:30720
  v_mul_f32 v48, v48, v56
  v_mul_f32 v49, v49, v57
  v_mul_f32 v50, v50, v58
  v_mfma_f32_16x16x32_bf16 v[108:111], v[180:183], v[156:159], v[108:111]
  s_waitcnt vmcnt(20)
  v_swap_b32 v162, v164
  v_swap_b32 v163, v165
  v_mul_f32 v51, v51, v59
  v_fma_f32 v212, v212, v202, v202
  s_waitcnt lgkmcnt(4)
  v_mfma_f32_16x16x32_bf16 v[112:115], v[184:187], v[152:155], v[112:115]
  ds_read_b128 v[180:183], v5 offset:31744
  v_fma_f32 v213, v213, v202, v202
  v_fma_f32 v214, v214, v202, v202
  v_fma_f32 v215, v215, v202, v202
  v_mfma_f32_16x16x32_bf16 v[116:119], v[184:187], v[156:159], v[116:119]
  buffer_load_dwordx4 a[192:195], v254, s[36:39], s86 offen sc1
  v_rcp_f32 v212, v212
  s_waitcnt lgkmcnt(4)
  v_mfma_f32_16x16x32_bf16 v[120:123], v[188:191], v[152:155], v[120:123]
  ds_read_b128 v[184:187], v5 offset:32768
  v_rcp_f32 v213, v213
  v_mfma_f32_16x16x32_bf16 v[124:127], v[188:191], v[156:159], v[124:127]
  v_rcp_f32 v214, v214
  v_rcp_f32 v215, v215
  s_waitcnt lgkmcnt(4)
  v_mfma_f32_16x16x32_bf16 v[72:75], v[192:195], v[160:163], v[72:75]
  ds_read_b128 v[188:191], v5 offset:33792
  v_mul_f32 v48, v48, v212
  v_mul_f32 v49, v49, v213
  v_mul_f32 v50, v50, v214
  v_mfma_f32_16x16x32_bf16 v[76:79], v[192:195], v[164:167], v[76:79]
  buffer_load_dwordx4 v[152:155], v2, s[40:43], s73 offen sc1
  buffer_load_dwordx4 v[156:159], v2, s[40:43], s73 offen offset:1024 sc1
  v_mul_f32 v51, v51, v215
  v_cvt_pk_bf16_f32 v208, v48, v49
  s_waitcnt lgkmcnt(4)
  v_mfma_f32_16x16x32_bf16 v[80:83], v[196:199], v[160:163], v[80:83]
  ds_read_b128 v[192:195], v5 offset:34816
  v_cvt_pk_bf16_f32 v209, v50, v51
  v_mul_f32 v212, v52, v52
  v_mul_f32 v213, v53, v53
  v_mfma_f32_16x16x32_bf16 v[84:87], v[196:199], v[164:167], v[84:87]
  v_mul_f32 v214, v54, v54
  v_mul_f32 v215, v55, v55
  v_fma_f32 v212, v212, v204, v203
  v_fma_f32 v213, v213, v204, v203
  s_waitcnt lgkmcnt(4)
  v_mfma_f32_16x16x32_bf16 v[88:91], v[176:179], v[160:163], v[88:91]
  buffer_load_dwordx4 a[196:199], v255, s[36:39], s86 offen sc1
  ds_read_b128 v[196:199], v5 offset:35840
  v_fma_f32 v214, v214, v204, v203
  v_fma_f32 v215, v215, v204, v203
  v_mfma_f32_16x16x32_bf16 v[92:95], v[176:179], v[164:167], v[92:95]
  v_mul_f32 v212, v212, v52
  v_mul_f32 v213, v213, v53
  v_mul_f32 v214, v214, v54
  v_mul_f32 v215, v215, v55
  s_waitcnt lgkmcnt(4)
  v_mfma_f32_16x16x32_bf16 v[96:99], v[180:183], v[160:163], v[96:99]
  ds_read_b128 v[176:179], v5 offset:36864
  v_exp_f32 v212, v212
  v_mfma_f32_16x16x32_bf16 v[100:103], v[180:183], v[164:167], v[100:103]
  v_exp_f32 v213, v213
  v_exp_f32 v214, v214
  s_waitcnt lgkmcnt(4)
  v_mfma_f32_16x16x32_bf16 v[104:107], v[184:187], v[160:163], v[104:107]
  ds_read_b128 v[180:183], v5 offset:37888
  v_exp_f32 v215, v215
  v_mul_f32 v52, v52, v60
  v_mfma_f32_16x16x32_bf16 v[108:111], v[184:187], v[164:167], v[108:111]
  s_waitcnt vmcnt(19)
  v_swap_b32 v170, v172
  v_swap_b32 v171, v173
  v_mul_f32 v53, v53, v61
  v_mul_f32 v54, v54, v62
  s_waitcnt lgkmcnt(4)
  v_mfma_f32_16x16x32_bf16 v[112:115], v[188:191], v[160:163], v[112:115]
  ds_read_b128 v[184:187], v5 offset:38912
  v_mul_f32 v55, v55, v63
  v_fma_f32 v212, v212, v205, v205
  v_fma_f32 v213, v213, v205, v205
  v_mfma_f32_16x16x32_bf16 v[116:119], v[188:191], v[164:167], v[116:119]
  s_mov_b32 s86, 51200
  buffer_load_dwordx4 a[200:203], v251, s[36:39], s86 offen sc1
  v_fma_f32 v214, v214, v205, v205
  v_fma_f32 v215, v215, v205, v205
  s_waitcnt lgkmcnt(4)
  v_mfma_f32_16x16x32_bf16 v[120:123], v[192:195], v[160:163], v[120:123]
  ds_read_b128 v[188:191], v5 offset:39936
  v_rcp_f32 v212, v212
  v_mfma_f32_16x16x32_bf16 v[124:127], v[192:195], v[164:167], v[124:127]
  v_rcp_f32 v213, v213
  v_rcp_f32 v214, v214
  s_waitcnt lgkmcnt(4)
  v_mfma_f32_16x16x32_bf16 v[72:75], v[196:199], v[168:171], v[72:75]
  ds_read_b128 v[192:195], v5 offset:40960
  v_rcp_f32 v215, v215
  v_mul_f32 v52, v52, v212
  v_mfma_f32_16x16x32_bf16 v[76:79], v[196:199], v[172:175], v[76:79]
  buffer_load_dwordx4 v[160:163], v2, s[40:43], s74 offen sc1
  buffer_load_dwordx4 v[164:167], v2, s[40:43], s74 offen offset:1024 sc1
  v_mul_f32 v53, v53, v213
  v_mul_f32 v54, v54, v214
  s_waitcnt lgkmcnt(4)
  v_mfma_f32_16x16x32_bf16 v[80:83], v[176:179], v[168:171], v[80:83]
  ds_read_b128 v[196:199], v5 offset:41984
  v_mul_f32 v55, v55, v215
  v_cvt_pk_bf16_f32 v210, v52, v53
  v_cvt_pk_bf16_f32 v211, v54, v55
  v_mfma_f32_16x16x32_bf16 v[84:87], v[176:179], v[172:175], v[84:87]
  s_mov_b32 s80, 0x1b02000
  buffer_store_dwordx4 v[208:211], v8, s[36:39], s80 offen sc1
  s_waitcnt lgkmcnt(4)
  v_mfma_f32_16x16x32_bf16 v[88:91], v[180:183], v[168:171], v[88:91]
  buffer_load_dwordx4 a[204:207], v252, s[36:39], s86 offen sc1
  ds_read_b128 v[176:179], v5 offset:43008
  v_mfma_f32_16x16x32_bf16 v[92:95], v[180:183], v[172:175], v[92:95]
  s_waitcnt lgkmcnt(4)
  v_mfma_f32_16x16x32_bf16 v[96:99], v[184:187], v[168:171], v[96:99]
  ds_read_b128 v[180:183], v5 offset:44032
  v_mfma_f32_16x16x32_bf16 v[100:103], v[184:187], v[172:175], v[100:103]
  s_waitcnt lgkmcnt(4)
  v_mfma_f32_16x16x32_bf16 v[104:107], v[188:191], v[168:171], v[104:107]
  ds_read_b128 v[184:187], v5 offset:45056
  v_mfma_f32_16x16x32_bf16 v[108:111], v[188:191], v[172:175], v[108:111]
  s_waitcnt vmcnt(19)
  v_swap_b32 v130, v132
  v_swap_b32 v131, v133
  s_waitcnt lgkmcnt(4)
  v_mfma_f32_16x16x32_bf16 v[112:115], v[192:195], v[168:171], v[112:115]
  ds_read_b128 v[188:191], v5 offset:46080
  v_mfma_f32_16x16x32_bf16 v[116:119], v[192:195], v[172:175], v[116:119]
  buffer_load_dwordx4 a[208:211], v253, s[36:39], s86 offen sc1
  s_waitcnt lgkmcnt(4)
  v_mfma_f32_16x16x32_bf16 v[120:123], v[196:199], v[168:171], v[120:123]
  ds_read_b128 v[192:195], v5 offset:47104
  v_mfma_f32_16x16x32_bf16 v[124:127], v[196:199], v[172:175], v[124:127]
  s_waitcnt lgkmcnt(4)
  v_mfma_f32_16x16x32_bf16 v[72:75], v[176:179], v[128:131], v[72:75]
  ds_read_b128 v[196:199], v5 offset:48128
  v_mfma_f32_16x16x32_bf16 v[76:79], v[176:179], v[132:135], v[76:79]
  buffer_load_dwordx4 v[168:171], v2, s[40:43], s75 offen sc1
  buffer_load_dwordx4 v[172:175], v2, s[40:43], s75 offen offset:1024 sc1
  s_waitcnt lgkmcnt(4)
  v_mfma_f32_16x16x32_bf16 v[80:83], v[180:183], v[128:131], v[80:83]
  ds_read_b128 v[176:179], v5 offset:49152
  v_mfma_f32_16x16x32_bf16 v[84:87], v[180:183], v[132:135], v[84:87]
  s_waitcnt lgkmcnt(4)
  v_mfma_f32_16x16x32_bf16 v[88:91], v[184:187], v[128:131], v[88:91]
  buffer_load_dwordx4 a[212:215], v254, s[36:39], s86 offen sc1
  ds_read_b128 v[180:183], v5 offset:50176
  v_mfma_f32_16x16x32_bf16 v[92:95], v[184:187], v[132:135], v[92:95]
  s_waitcnt lgkmcnt(4)
  v_mfma_f32_16x16x32_bf16 v[96:99], v[188:191], v[128:131], v[96:99]
  ds_read_b128 v[184:187], v5 offset:51200
  v_mfma_f32_16x16x32_bf16 v[100:103], v[188:191], v[132:135], v[100:103]
  s_waitcnt lgkmcnt(4)
  v_mfma_f32_16x16x32_bf16 v[104:107], v[192:195], v[128:131], v[104:107]
  ds_read_b128 v[188:191], v5 offset:52224
  v_mfma_f32_16x16x32_bf16 v[108:111], v[192:195], v[132:135], v[108:111]
  s_waitcnt vmcnt(19)
  v_swap_b32 v138, v140
  v_swap_b32 v139, v141
  s_waitcnt lgkmcnt(4)
  v_mfma_f32_16x16x32_bf16 v[112:115], v[196:199], v[128:131], v[112:115]
  ds_read_b128 v[192:195], v5 offset:53248
  v_mfma_f32_16x16x32_bf16 v[116:119], v[196:199], v[132:135], v[116:119]
  buffer_load_dwordx4 a[216:219], v255, s[36:39], s86 offen sc1
  s_waitcnt lgkmcnt(4)
  v_mfma_f32_16x16x32_bf16 v[120:123], v[176:179], v[128:131], v[120:123]
  ds_read_b128 v[196:199], v5 offset:54272
  v_mfma_f32_16x16x32_bf16 v[124:127], v[176:179], v[132:135], v[124:127]
  s_waitcnt lgkmcnt(4)
  v_mfma_f32_16x16x32_bf16 v[72:75], v[180:183], v[136:139], v[72:75]
  ds_read_b128 v[176:179], v5 offset:55296
  v_mfma_f32_16x16x32_bf16 v[76:79], v[180:183], v[140:143], v[76:79]
  buffer_load_dwordx4 v[128:131], v2, s[40:43], s76 offen sc1
  buffer_load_dwordx4 v[132:135], v2, s[40:43], s76 offen offset:1024 sc1
  s_waitcnt lgkmcnt(4)
  v_mfma_f32_16x16x32_bf16 v[80:83], v[184:187], v[136:139], v[80:83]
  ds_read_b128 v[180:183], v5 offset:56320
  v_mfma_f32_16x16x32_bf16 v[84:87], v[184:187], v[140:143], v[84:87]
  s_waitcnt lgkmcnt(4)
  v_mfma_f32_16x16x32_bf16 v[88:91], v[188:191], v[136:139], v[88:91]
  s_mov_b32 s86, 56320
  buffer_load_dwordx4 a[220:223], v251, s[36:39], s86 offen sc1
  ds_read_b128 v[184:187], v5 offset:57344
  v_mfma_f32_16x16x32_bf16 v[92:95], v[188:191], v[140:143], v[92:95]
  s_waitcnt lgkmcnt(4)
  v_mfma_f32_16x16x32_bf16 v[96:99], v[192:195], v[136:139], v[96:99]
  ds_read_b128 v[188:191], v5 offset:58368
  v_mfma_f32_16x16x32_bf16 v[100:103], v[192:195], v[140:143], v[100:103]
  s_waitcnt lgkmcnt(4)
  v_mfma_f32_16x16x32_bf16 v[104:107], v[196:199], v[136:139], v[104:107]
  ds_read_b128 v[192:195], v5 offset:59392
  v_mfma_f32_16x16x32_bf16 v[108:111], v[196:199], v[140:143], v[108:111]
  s_waitcnt vmcnt(18)
  v_swap_b32 v146, v148
  v_swap_b32 v147, v149
  s_waitcnt lgkmcnt(4)
  v_mfma_f32_16x16x32_bf16 v[112:115], v[176:179], v[136:139], v[112:115]
  ds_read_b128 v[196:199], v5 offset:60416
  v_mfma_f32_16x16x32_bf16 v[116:119], v[176:179], v[140:143], v[116:119]
  buffer_load_dwordx4 a[224:227], v252, s[36:39], s86 offen sc1
  s_waitcnt lgkmcnt(4)
  v_mfma_f32_16x16x32_bf16 v[120:123], v[180:183], v[136:139], v[120:123]
  ds_read_b128 v[176:179], v5 offset:61440
  v_mfma_f32_16x16x32_bf16 v[124:127], v[180:183], v[140:143], v[124:127]
  s_waitcnt lgkmcnt(4)
  v_mfma_f32_16x16x32_bf16 v[72:75], v[184:187], v[144:147], v[72:75]
  ds_read_b128 v[180:183], v5 offset:62464
  v_mfma_f32_16x16x32_bf16 v[76:79], v[184:187], v[148:151], v[76:79]
  buffer_load_dwordx4 v[136:139], v2, s[40:43], s77 offen sc1
  buffer_load_dwordx4 v[140:143], v2, s[40:43], s77 offen offset:1024 sc1
  s_waitcnt lgkmcnt(4)
  v_mfma_f32_16x16x32_bf16 v[80:83], v[188:191], v[144:147], v[80:83]
  ds_read_b128 v[184:187], v5 offset:63488
  buffer_load_dwordx4 v[216:219], v12, s[36:39], 0 offen offset:2048 sc1
  v_mfma_f32_16x16x32_bf16 v[84:87], v[188:191], v[148:151], v[84:87]
  buffer_load_dwordx4 v[220:223], v12, s[36:39], 0 offen offset:3072 sc1
  s_waitcnt lgkmcnt(4)
  v_mfma_f32_16x16x32_bf16 v[88:91], v[192:195], v[144:147], v[88:91]
  buffer_load_dwordx4 a[228:231], v253, s[36:39], s86 offen sc1
  ds_read_b128 v[188:191], v6 offset:0
  v_mfma_f32_16x16x32_bf16 v[92:95], v[192:195], v[148:151], v[92:95]
  s_waitcnt lgkmcnt(4)
  v_mfma_f32_16x16x32_bf16 v[96:99], v[196:199], v[144:147], v[96:99]
  ds_read_b128 v[192:195], v6 offset:1024
  v_mfma_f32_16x16x32_bf16 v[100:103], v[196:199], v[148:151], v[100:103]
  s_waitcnt lgkmcnt(4)
  v_mfma_f32_16x16x32_bf16 v[104:107], v[176:179], v[144:147], v[104:107]
  ds_read_b128 v[196:199], v6 offset:2048
  v_mfma_f32_16x16x32_bf16 v[108:111], v[176:179], v[148:151], v[108:111]
  s_waitcnt vmcnt(20)
  v_swap_b32 v154, v156
  v_swap_b32 v155, v157
  s_waitcnt lgkmcnt(4)
  v_mfma_f32_16x16x32_bf16 v[112:115], v[180:183], v[144:147], v[112:115]
  ds_read_b128 v[176:179], v6 offset:3072
  v_mfma_f32_16x16x32_bf16 v[116:119], v[180:183], v[148:151], v[116:119]
  s_waitcnt lgkmcnt(4)
  v_mfma_f32_16x16x32_bf16 v[120:123], v[184:187], v[144:147], v[120:123]
  buffer_load_dwordx4 a[232:235], v254, s[36:39], s86 offen sc1
  ds_read_b128 v[180:183], v6 offset:4096
  v_mfma_f32_16x16x32_bf16 v[124:127], v[184:187], v[148:151], v[124:127]
  s_waitcnt lgkmcnt(4)
  v_mfma_f32_16x16x32_bf16 v[72:75], v[188:191], v[152:155], v[72:75]
  ds_read_b128 v[184:187], v6 offset:5120
  v_mfma_f32_16x16x32_bf16 v[76:79], v[188:191], v[156:159], v[76:79]
  buffer_load_dwordx4 v[144:147], v2, s[40:43], s78 offen sc1
  buffer_load_dwordx4 v[148:151], v2, s[40:43], s78 offen offset:1024 sc1
  s_waitcnt lgkmcnt(4)
  v_mfma_f32_16x16x32_bf16 v[80:83], v[192:195], v[152:155], v[80:83]
  ds_read_b128 v[188:191], v6 offset:6144
  v_mfma_f32_16x16x32_bf16 v[84:87], v[192:195], v[156:159], v[84:87]
  s_waitcnt lgkmcnt(4)
  v_mfma_f32_16x16x32_bf16 v[88:91], v[196:199], v[152:155], v[88:91]
  ds_read_b128 v[192:195], v6 offset:7168
  v_mfma_f32_16x16x32_bf16 v[92:95], v[196:199], v[156:159], v[92:95]
  buffer_load_dwordx4 a[236:239], v255, s[36:39], s86 offen sc1
  s_waitcnt lgkmcnt(4)
  v_mfma_f32_16x16x32_bf16 v[96:99], v[176:179], v[152:155], v[96:99]
  ds_read_b128 v[196:199], v6 offset:8192
  v_mfma_f32_16x16x32_bf16 v[100:103], v[176:179], v[156:159], v[100:103]
  s_waitcnt lgkmcnt(4)
  v_mfma_f32_16x16x32_bf16 v[104:107], v[180:183], v[152:155], v[104:107]
  ds_read_b128 v[176:179], v6 offset:9216
  v_mfma_f32_16x16x32_bf16 v[108:111], v[180:183], v[156:159], v[108:111]
  s_waitcnt vmcnt(20)
  v_swap_b32 v162, v164
  v_swap_b32 v163, v165
  s_waitcnt lgkmcnt(4)
  v_mfma_f32_16x16x32_bf16 v[112:115], v[184:187], v[152:155], v[112:115]
  ds_read_b128 v[180:183], v6 offset:10240
  v_mfma_f32_16x16x32_bf16 v[116:119], v[184:187], v[156:159], v[116:119]
  s_waitcnt lgkmcnt(4)
  v_mfma_f32_16x16x32_bf16 v[120:123], v[188:191], v[152:155], v[120:123]
  s_cmp_eq_u32 s32, 3
  s_cselect_b32 s87, 0x80000000, 0
  v_or_b32 v251, s87, v251
  s_mov_b32 s86, 61440
  buffer_load_dwordx4 a[240:243], v251, s[36:39], s86 offen sc1
  ds_read_b128 v[184:187], v6 offset:11264
  v_mfma_f32_16x16x32_bf16 v[124:127], v[188:191], v[156:159], v[124:127]
  s_waitcnt lgkmcnt(4)
  v_mfma_f32_16x16x32_bf16 v[72:75], v[192:195], v[160:163], v[72:75]
  ds_read_b128 v[188:191], v6 offset:12288
  v_mfma_f32_16x16x32_bf16 v[76:79], v[192:195], v[164:167], v[76:79]
  buffer_load_dwordx4 v[152:155], v2, s[40:43], s79 offen sc1
  buffer_load_dwordx4 v[156:159], v2, s[40:43], s79 offen offset:1024 sc1
  s_waitcnt lgkmcnt(4)
  v_mfma_f32_16x16x32_bf16 v[80:83], v[196:199], v[160:163], v[80:83]
  ds_read_b128 v[192:195], v6 offset:13312
  v_mfma_f32_16x16x32_bf16 v[84:87], v[196:199], v[164:167], v[84:87]
  s_waitcnt lgkmcnt(4)
  v_mfma_f32_16x16x32_bf16 v[88:91], v[176:179], v[160:163], v[88:91]
  ds_read_b128 v[196:199], v6 offset:14336
  v_mfma_f32_16x16x32_bf16 v[92:95], v[176:179], v[164:167], v[92:95]
  v_or_b32 v252, s87, v252
  buffer_load_dwordx4 a[244:247], v252, s[36:39], s86 offen sc1
  s_waitcnt lgkmcnt(4)
  v_mfma_f32_16x16x32_bf16 v[96:99], v[180:183], v[160:163], v[96:99]
  ds_read_b128 v[176:179], v6 offset:15360
  v_mfma_f32_16x16x32_bf16 v[100:103], v[180:183], v[164:167], v[100:103]
  s_waitcnt lgkmcnt(4)
  v_mfma_f32_16x16x32_bf16 v[104:107], v[184:187], v[160:163], v[104:107]
  ds_read_b128 v[180:183], v6 offset:16384
  v_mfma_f32_16x16x32_bf16 v[108:111], v[184:187], v[164:167], v[108:111]
  s_waitcnt vmcnt(19)
  v_swap_b32 v170, v172
  v_swap_b32 v171, v173
  s_waitcnt lgkmcnt(4)
  v_mfma_f32_16x16x32_bf16 v[112:115], v[188:191], v[160:163], v[112:115]
  ds_read_b128 v[184:187], v6 offset:17408
  s_lshr_b32 s81, s91, 3
  v_mfma_f32_16x16x32_bf16 v[116:119], v[188:191], v[164:167], v[116:119]
  s_lshl_b32 s80, s90, 3
  s_add_u32 s80, s80, s81
  s_waitcnt lgkmcnt(4)
  v_mfma_f32_16x16x32_bf16 v[120:123], v[192:195], v[160:163], v[120:123]
  v_or_b32 v253, s87, v253
  buffer_load_dwordx4 a[248:251], v253, s[36:39], s86 offen sc1
  ds_read_b128 v[188:191], v6 offset:18432
  v_mfma_f32_16x16x32_bf16 v[124:127], v[192:195], v[164:167], v[124:127]
  s_lshl_b32 s80, s80, 2
  s_add_u32 s80, s80, s32
  s_waitcnt lgkmcnt(4)
  v_mfma_f32_16x16x32_bf16 v[72:75], v[196:199], v[168:171], v[72:75]
  ds_read_b128 v[192:195], v6 offset:19456
  s_lshl_b32 s80, s80, 7
  v_mfma_f32_16x16x32_bf16 v[76:79], v[196:199], v[172:175], v[76:79]
  s_add_u32 s80, s80, 32768
  v_or_b32 v230, s80, v206
  s_waitcnt lgkmcnt(4)
  v_mfma_f32_16x16x32_bf16 v[80:83], v[176:179], v[168:171], v[80:83]
  ds_read_b128 v[196:199], v6 offset:20480
  v_mov_b32 v231, 1
  v_mfma_f32_16x16x32_bf16 v[84:87], v[176:179], v[172:175], v[84:87]
  buffer_atomic_add v231, v230, s[36:39], 0 offen sc1
  s_waitcnt vmcnt(12)
  v_bitop3_b32 v224, v216, v217, v218 bitop3:0x80
  s_waitcnt lgkmcnt(4)
  v_mfma_f32_16x16x32_bf16 v[88:91], v[180:183], v[168:171], v[88:91]
  ds_read_b128 v[176:179], v6 offset:21504
  s_waitcnt vmcnt(11)
  v_bitop3_b32 v225, v219, v220, v221 bitop3:0x80
  v_mfma_f32_16x16x32_bf16 v[92:95], v[180:183], v[172:175], v[92:95]
  v_or_b32 v254, s87, v254
  buffer_load_dwordx4 a[252:255], v254, s[36:39], s86 offen sc1
  s_waitcnt lgkmcnt(4)
  v_mfma_f32_16x16x32_bf16 v[96:99], v[184:187], v[168:171], v[96:99]
  ds_read_b128 v[180:183], v6 offset:22528
  v_bitop3_b32 v224, v224, v222, v223 bitop3:0x80
  v_mfma_f32_16x16x32_bf16 v[100:103], v[184:187], v[172:175], v[100:103]
  v_bitop3_b32 v224, v224, v225, 1 bitop3:0x80
  v_cmp_eq_u32 vcc, 0, v224
  s_waitcnt lgkmcnt(4)
  v_mfma_f32_16x16x32_bf16 v[104:107], v[188:191], v[168:171], v[104:107]
  ds_read_b128 v[184:187], v6 offset:23552
  s_cbranch_vccnz L_tp_17
L_tpb_18:
  v_mfma_f32_16x16x32_bf16 v[108:111], v[188:191], v[172:175], v[108:111]
  v_swap_b32 v130, v132
  v_swap_b32 v131, v133
  s_waitcnt lgkmcnt(4)
  v_mfma_f32_16x16x32_bf16 v[112:115], v[192:195], v[168:171], v[112:115]
  ds_read_b128 v[188:191], v6 offset:24576
  v_add_f32 v216, v216, v220
  v_mfma_f32_16x16x32_bf16 v[116:119], v[192:195], v[172:175], v[116:119]
  v_add_f32 v217, v217, v221
  v_add_f32 v218, v218, v222
  s_waitcnt lgkmcnt(4)
  v_mfma_f32_16x16x32_bf16 v[120:123], v[196:199], v[168:171], v[120:123]
  v_or_b32 v255, s87, v255
  buffer_load_dwordx4 v[232:235], v255, s[36:39], s86 offen sc1
  ds_read_b128 v[192:195], v6 offset:25600
  v_mfma_f32_16x16x32_bf16 v[124:127], v[196:199], v[172:175], v[124:127]
  v_add_f32 v219, v219, v223
  v_mul_f32 v216, 0x3acccccd, v216
  s_waitcnt lgkmcnt(4)
  v_mfma_f32_16x16x32_bf16 v[72:75], v[176:179], v[128:131], v[72:75]
  ds_read_b128 v[196:199], v6 offset:26624
  v_mul_f32 v217, 0x3acccccd, v217
  v_mfma_f32_16x16x32_bf16 v[76:79], v[176:179], v[132:135], v[76:79]
  v_mul_f32 v218, 0x3acccccd, v218
  v_mul_f32 v219, 0x3acccccd, v219
  s_waitcnt lgkmcnt(4)
  v_mfma_f32_16x16x32_bf16 v[80:83], v[180:183], v[128:131], v[80:83]
  ds_read_b128 v[176:179], v6 offset:27648
  v_fma_f32 v217, -v216, v216, v217
  v_mfma_f32_16x16x32_bf16 v[84:87], v[180:183], v[132:135], v[84:87]
  v_fma_f32 v219, -v218, v218, v219
  v_max_f32 v217, 0, v217
  s_waitcnt lgkmcnt(4)
  v_mfma_f32_16x16x32_bf16 v[88:91], v[184:187], v[128:131], v[88:91]
  ds_read_b128 v[180:183], v6 offset:28672
  v_max_f32 v219, 0, v219
  v_mfma_f32_16x16x32_bf16 v[92:95], v[184:187], v[132:135], v[92:95]
  s_mov_b32 s86, 66560
  buffer_load_dwordx4 v[236:239], v251, s[36:39], s86 offen sc1
  s_waitcnt lgkmcnt(4)
  v_mfma_f32_16x16x32_bf16 v[96:99], v[188:191], v[128:131], v[96:99]
  ds_read_b128 v[184:187], v6 offset:29696
  v_add_f32 v217, 0x3727c5ac, v217
  v_mfma_f32_16x16x32_bf16 v[100:103], v[188:191], v[132:135], v[100:103]
  v_add_f32 v219, 0x3727c5ac, v219
  s_waitcnt lgkmcnt(4)
  v_mfma_f32_16x16x32_bf16 v[104:107], v[192:195], v[128:131], v[104:107]
  ds_read_b128 v[188:191], v6 offset:30720
  v_mfma_f32_16x16x32_bf16 v[108:111], v[192:195], v[132:135], v[108:111]
  v_swap_b32 v138, v140
  v_swap_b32 v139, v141
  s_waitcnt lgkmcnt(4)
  v_mfma_f32_16x16x32_bf16 v[112:115], v[196:199], v[128:131], v[112:115]
  ds_read_b128 v[192:195], v6 offset:31744
  v_mfma_f32_16x16x32_bf16 v[116:119], v[196:199], v[132:135], v[116:119]
  v_rsq_f32 v216, v217
  s_waitcnt lgkmcnt(4)
  v_mfma_f32_16x16x32_bf16 v[120:123], v[176:179], v[128:131], v[120:123]
  buffer_load_dwordx4 v[240:243], v252, s[36:39], s86 offen sc1
  ds_read_b128 v[196:199], v6 offset:32768
  v_mfma_f32_16x16x32_bf16 v[124:127], v[176:179], v[132:135], v[124:127]
  v_rsq_f32 v218, v219
  s_waitcnt lgkmcnt(4)
  v_mfma_f32_16x16x32_bf16 v[72:75], v[180:183], v[136:139], v[72:75]
  ds_read_b128 v[176:179], v6 offset:33792
  v_mfma_f32_16x16x32_bf16 v[76:79], v[180:183], v[140:143], v[76:79]
  v_rcp_f32 v201, v217
  s_waitcnt lgkmcnt(4)
  v_mfma_f32_16x16x32_bf16 v[80:83], v[184:187], v[136:139], v[80:83]
  ds_read_b128 v[180:183], v6 offset:34816
  v_mfma_f32_16x16x32_bf16 v[84:87], v[184:187], v[140:143], v[84:87]
  v_rcp_f32 v204, v219
  s_waitcnt lgkmcnt(4)
  v_mfma_f32_16x16x32_bf16 v[88:91], v[188:191], v[136:139], v[88:91]
  ds_read_b128 v[184:187], v6 offset:35840
  v_mul_f32 v200, 0xc0135761, v216
  v_mfma_f32_16x16x32_bf16 v[92:95], v[188:191], v[140:143], v[92:95]
  buffer_load_dwordx4 v[244:247], v253, s[36:39], s86 offen sc1
  v_mov_b32 v202, v217
  s_waitcnt lgkmcnt(4)
  v_mfma_f32_16x16x32_bf16 v[96:99], v[192:195], v[136:139], v[96:99]
  ds_read_b128 v[188:191], v6 offset:36864
  v_mul_f32 v203, 0xc0135761, v218
  v_mfma_f32_16x16x32_bf16 v[100:103], v[192:195], v[140:143], v[100:103]
  v_mov_b32 v205, v219
  v_mul_f32 v201, 0x3d372713, v201
  s_waitcnt lgkmcnt(4)
  v_mfma_f32_16x16x32_bf16 v[104:107], v[196:199], v[136:139], v[104:107]
  ds_read_b128 v[192:195], v6 offset:37888
  v_mul_f32 v204, 0x3d372713, v204
  v_mfma_f32_16x16x32_bf16 v[108:111], v[196:199], v[140:143], v[108:111]
  s_waitcnt vmcnt(12)
  v_swap_b32 v146, v148
  v_swap_b32 v147, v149
  s_waitcnt lgkmcnt(4)
  v_mfma_f32_16x16x32_bf16 v[112:115], v[176:179], v[136:139], v[112:115]
  ds_read_b128 v[196:199], v6 offset:38912
  v_mul_f32 v201, v201, v200
  v_mfma_f32_16x16x32_bf16 v[116:119], v[176:179], v[140:143], v[116:119]
  v_mul_f32 v204, v204, v203
  s_waitcnt lgkmcnt(4)
  v_mfma_f32_16x16x32_bf16 v[120:123], v[180:183], v[136:139], v[120:123]
  buffer_load_dwordx4 v[248:251], v254, s[36:39], s86 offen sc1
  ds_read_b128 v[176:179], v6 offset:39936
  v_mfma_f32_16x16x32_bf16 v[124:127], v[180:183], v[140:143], v[124:127]
  s_waitcnt lgkmcnt(4)
  v_mfma_f32_16x16x32_bf16 v[72:75], v[184:187], v[144:147], v[72:75]
  ds_read_b128 v[180:183], v6 offset:40960
  v_mfma_f32_16x16x32_bf16 v[76:79], v[184:187], v[148:151], v[76:79]
  s_waitcnt lgkmcnt(4)
  v_mfma_f32_16x16x32_bf16 v[80:83], v[188:191], v[144:147], v[80:83]
  ds_read_b128 v[184:187], v6 offset:41984
  v_mfma_f32_16x16x32_bf16 v[84:87], v[188:191], v[148:151], v[84:87]
  s_waitcnt lgkmcnt(4)
  v_mfma_f32_16x16x32_bf16 v[88:91], v[192:195], v[144:147], v[88:91]
  ds_read_b128 v[188:191], v6 offset:43008
  v_mfma_f32_16x16x32_bf16 v[92:95], v[192:195], v[148:151], v[92:95]
  buffer_load_dwordx4 v[252:255], v255, s[36:39], s86 offen sc1
  s_waitcnt lgkmcnt(4)
  v_mfma_f32_16x16x32_bf16 v[96:99], v[196:199], v[144:147], v[96:99]
  ds_read_b128 v[192:195], v6 offset:44032
  v_mfma_f32_16x16x32_bf16 v[100:103], v[196:199], v[148:151], v[100:103]
  s_waitcnt lgkmcnt(4)
  v_mfma_f32_16x16x32_bf16 v[104:107], v[176:179], v[144:147], v[104:107]
  ds_read_b128 v[196:199], v6 offset:45056
  v_mfma_f32_16x16x32_bf16 v[108:111], v[176:179], v[148:151], v[108:111]
  s_waitcnt vmcnt(10)
  v_swap_b32 v154, v156
  v_swap_b32 v155, v157
  s_waitcnt lgkmcnt(4)
  v_mfma_f32_16x16x32_bf16 v[112:115], v[180:183], v[144:147], v[112:115]
  ds_read_b128 v[176:179], v6 offset:46080
  s_lshl_b32 s80, s30, 3
  v_mfma_f32_16x16x32_bf16 v[116:119], v[180:183], v[148:151], v[116:119]
  s_add_u32 s80, s80, s32
  s_lshl_b32 s80, s80, 2
  s_waitcnt lgkmcnt(4)
  v_mfma_f32_16x16x32_bf16 v[120:123], v[184:187], v[144:147], v[120:123]
  ds_read_b128 v[180:183], v6 offset:47104
  s_add_u32 s80, s80, s100
  v_mfma_f32_16x16x32_bf16 v[124:127], v[184:187], v[148:151], v[124:127]
  s_lshl_b32 s80, s80, 7
  s_add_u32 s80, s80, 32768
  s_waitcnt lgkmcnt(4)
  v_mfma_f32_16x16x32_bf16 v[72:75], v[188:191], v[152:155], v[72:75]
  ds_read_b128 v[184:187], v6 offset:48128
  v_add_u32 v230, s80, v206
  v_mfma_f32_16x16x32_bf16 v[76:79], v[188:191], v[156:159], v[76:79]
  buffer_load_dword v231, v230, s[36:39], 0 offen sc1
  s_waitcnt lgkmcnt(4)
  v_mfma_f32_16x16x32_bf16 v[80:83], v[192:195], v[152:155], v[80:83]
  ds_read_b128 v[188:191], v6 offset:49152
  v_mfma_f32_16x16x32_bf16 v[84:87], v[192:195], v[156:159], v[84:87]
  s_waitcnt lgkmcnt(4)
  v_mfma_f32_16x16x32_bf16 v[88:91], v[196:199], v[152:155], v[88:91]
  v_mfma_f32_16x16x32_bf16 v[92:95], v[196:199], v[156:159], v[92:95]
  s_waitcnt lgkmcnt(3)
  v_mfma_f32_16x16x32_bf16 v[96:99], v[176:179], v[152:155], v[96:99]
  v_mfma_f32_16x16x32_bf16 v[100:103], v[176:179], v[156:159], v[100:103]
  s_waitcnt lgkmcnt(2)
  v_mfma_f32_16x16x32_bf16 v[104:107], v[180:183], v[152:155], v[104:107]
  v_mfma_f32_16x16x32_bf16 v[108:111], v[180:183], v[156:159], v[108:111]
  s_waitcnt lgkmcnt(1)
  v_mfma_f32_16x16x32_bf16 v[112:115], v[184:187], v[152:155], v[112:115]
  v_mfma_f32_16x16x32_bf16 v[116:119], v[184:187], v[156:159], v[116:119]
  s_waitcnt lgkmcnt(0)
  v_mfma_f32_16x16x32_bf16 v[120:123], v[188:191], v[152:155], v[120:123]
  v_mfma_f32_16x16x32_bf16 v[124:127], v[188:191], v[156:159], v[124:127]
  s_nop 6
  v_mul_f32 v212, v120, v120
  v_mul_f32 v213, v121, v121
  v_fma_f32 v212, v212, v201, v200
  v_fma_f32 v213, v213, v201, v200
  v_mul_f32 v212, v212, v120
  v_mul_f32 v213, v213, v121
  v_exp_f32 v212, v212
  v_exp_f32 v213, v213
  s_waitcnt vmcnt(0)
  v_cmp_gt_u32 vcc, 8, v231
  s_nop 0
  s_and_b32 vcc_lo, vcc_lo, 0x1
  s_cbranch_scc1 L_cp_19
L_cpb_20:
  s_add_u32 s44, s28, 0x1b00000
  s_addc_u32 s45, s29, 0
  buffer_load_dwordx4 v[160:163], v3, s[44:47], s60 offen sc1
  v_mul_f32 v120, v120, v122
  v_mul_f32 v121, v121, v123
  v_fma_f32 v212, v212, v202, v202
  v_fma_f32 v213, v213, v202, v202
  v_rcp_f32 v212, v212
  v_rcp_f32 v213, v213
  buffer_load_dwordx4 v[164:167], v3, s[44:47], s60 offen offset:1024 sc1
  v_mul_f32 v120, v120, v212
  v_mul_f32 v121, v121, v213
  v_cvt_pk_bf16_f32 v208, v120, v121
  v_mul_f32 v212, v124, v124
  v_mul_f32 v213, v125, v125
  v_fma_f32 v212, v212, v204, v203
  v_fma_f32 v213, v213, v204, v203
  v_mul_f32 v212, v212, v124
  buffer_load_dwordx4 v[168:171], v3, s[44:47], s61 offen sc1
  v_mul_f32 v213, v213, v125
  v_exp_f32 v212, v212
  v_exp_f32 v213, v213
  v_mul_f32 v124, v124, v126
  v_mul_f32 v125, v125, v127
  v_fma_f32 v212, v212, v205, v205
  buffer_load_dwordx4 v[172:175], v3, s[44:47], s61 offen offset:1024 sc1
  v_fma_f32 v213, v213, v205, v205
  v_rcp_f32 v212, v212
  v_rcp_f32 v213, v213
  v_mul_f32 v124, v124, v212
  v_mul_f32 v125, v125, v213
  v_cvt_pk_bf16_f32 v209, v124, v125
  buffer_load_dwordx4 v[128:131], v3, s[44:47], s62 offen sc1
  s_nop 0
  v_permlane16_swap_b32 v208, v209
  s_mov_b32 s80, 0x1b70000
  buffer_store_dwordx2 v[208:209], v9, s[36:39], s80 offen sc1
  v_mul_f32 v212, v72, v72
  v_mul_f32 v213, v73, v73
  v_mul_f32 v214, v74, v74
  v_mul_f32 v215, v75, v75
  v_fma_f32 v212, v212, v201, v200
  buffer_load_dwordx4 v[132:135], v3, s[44:47], s62 offen offset:1024 sc1
  v_fma_f32 v213, v213, v201, v200
  v_fma_f32 v214, v214, v201, v200
  v_fma_f32 v215, v215, v201, v200
  v_mul_f32 v212, v212, v72
  v_mul_f32 v213, v213, v73
  v_mul_f32 v214, v214, v74
  v_mul_f32 v215, v215, v75
  v_exp_f32 v212, v212
  buffer_load_dwordx4 v[136:139], v3, s[44:47], s63 offen sc1
  v_exp_f32 v213, v213
  v_exp_f32 v214, v214
  v_exp_f32 v215, v215
  v_mul_f32 v72, v72, v80
  buffer_load_dwordx4 v[140:143], v3, s[44:47], s63 offen offset:1024 sc1
  v_mul_f32 v73, v73, v81
  v_mul_f32 v74, v74, v82
  v_mul_f32 v75, v75, v83
  v_fma_f32 v212, v212, v202, v202
  v_fma_f32 v213, v213, v202, v202
  v_fma_f32 v214, v214, v202, v202
  v_fma_f32 v215, v215, v202, v202
  v_rcp_f32 v212, v212
  buffer_load_dwordx4 v[144:147], v3, s[44:47], s64 offen sc1
  v_rcp_f32 v213, v213
  v_rcp_f32 v214, v214
  v_rcp_f32 v215, v215
  v_mul_f32 v72, v72, v212
  buffer_load_dwordx4 v[148:151], v3, s[44:47], s64 offen offset:1024 sc1
  v_mul_f32 v73, v73, v213
  v_mul_f32 v74, v74, v214
  v_mul_f32 v75, v75, v215
  v_cvt_pk_bf16_f32 v208, v72, v73
  v_cvt_pk_bf16_f32 v209, v74, v75
  v_mul_f32 v212, v76, v76
  v_mul_f32 v213, v77, v77
  v_mul_f32 v214, v78, v78
  buffer_load_dwordx4 v[152:155], v3, s[44:47], s65 offen sc1
  v_mul_f32 v215, v79, v79
  v_fma_f32 v212, v212, v204, v203
  v_fma_f32 v213, v213, v204, v203
  v_fma_f32 v214, v214, v204, v203
  v_fma_f32 v215, v215, v204, v203
  v_mul_f32 v212, v212, v76
  v_mul_f32 v213, v213, v77
  v_mul_f32 v214, v214, v78
  buffer_load_dwordx4 v[156:159], v3, s[44:47], s65 offen offset:1024 sc1
  v_mul_f32 v215, v215, v79
  v_exp_f32 v212, v212
  v_exp_f32 v213, v213
  v_exp_f32 v214, v214
  v_exp_f32 v215, v215
  v_mul_f32 v76, v76, v84
  v_mul_f32 v77, v77, v85
  v_mul_f32 v78, v78, v86
  s_waitcnt vmcnt(11)
  v_swap_b32 v162, v164
  v_swap_b32 v163, v165
  s_nop 1
  v_mfma_f32_16x16x32_bf16 v[16:19], a[0:3], v[160:163], 0
  v_mul_f32 v79, v79, v87
  v_fma_f32 v212, v212, v205, v205
  v_fma_f32 v213, v213, v205, v205
  v_fma_f32 v214, v214, v205, v205
  v_mfma_f32_16x16x32_bf16 v[20:23], a[0:3], v[164:167], 0
  buffer_load_dwordx4 v[176:179], v3, s[44:47], s66 offen sc1
  buffer_load_dwordx4 v[180:183], v3, s[44:47], s66 offen offset:1024 sc1
  v_fma_f32 v215, v215, v205, v205
  v_mfma_f32_16x16x32_bf16 v[24:27], a[4:7], v[160:163], 0
  v_rcp_f32 v212, v212
  v_rcp_f32 v213, v213
  v_mfma_f32_16x16x32_bf16 v[28:31], a[4:7], v[164:167], 0
  v_rcp_f32 v214, v214
  v_rcp_f32 v215, v215
  v_mfma_f32_16x16x32_bf16 v[32:35], a[8:11], v[160:163], 0
  v_mul_f32 v76, v76, v212
  v_mul_f32 v77, v77, v213
  v_mul_f32 v78, v78, v214
  v_mul_f32 v79, v79, v215
  v_mfma_f32_16x16x32_bf16 v[36:39], a[8:11], v[164:167], 0
  v_cvt_pk_bf16_f32 v210, v76, v77
  v_cvt_pk_bf16_f32 v211, v78, v79
  s_mov_b32 s80, 0x1b70000
  buffer_store_dwordx4 v[208:211], v8, s[36:39], s80 offen sc1
  v_mfma_f32_16x16x32_bf16 v[40:43], a[12:15], v[160:163], 0
  v_mul_f32 v212, v88, v88
  v_mul_f32 v213, v89, v89
  v_mul_f32 v214, v90, v90
  v_mul_f32 v215, v91, v91
  v_mfma_f32_16x16x32_bf16 v[44:47], a[12:15], v[164:167], 0
  s_waitcnt vmcnt(12)
  v_swap_b32 v170, v172
  v_swap_b32 v171, v173
  v_fma_f32 v212, v212, v201, v200
  v_fma_f32 v213, v213, v201, v200
  v_mfma_f32_16x16x32_bf16 v[48:51], a[16:19], v[160:163], 0
  v_fma_f32 v214, v214, v201, v200
  v_fma_f32 v215, v215, v201, v200
  v_mul_f32 v212, v212, v88
  v_mul_f32 v213, v213, v89
  v_mfma_f32_16x16x32_bf16 v[52:55], a[16:19], v[164:167], 0
  v_mul_f32 v214, v214, v90
  v_mul_f32 v215, v215, v91
  v_exp_f32 v212, v212
  v_mfma_f32_16x16x32_bf16 v[16:19], a[20:23], v[168:171], v[16:19]
  v_exp_f32 v213, v213
  v_exp_f32 v214, v214
  v_mfma_f32_16x16x32_bf16 v[20:23], a[20:23], v[172:175], v[20:23]
  buffer_load_dwordx4 v[184:187], v3, s[44:47], s67 offen sc1
  buffer_load_dwordx4 v[188:191], v3, s[44:47], s67 offen offset:1024 sc1
  v_exp_f32 v215, v215
  v_mfma_f32_16x16x32_bf16 v[24:27], a[24:27], v[168:171], v[24:27]
  v_mul_f32 v88, v88, v96
  v_mul_f32 v89, v89, v97
  v_mul_f32 v90, v90, v98
  v_mul_f32 v91, v91, v99
  v_mfma_f32_16x16x32_bf16 v[28:31], a[24:27], v[172:175], v[28:31]
  v_fma_f32 v212, v212, v202, v202
  v_fma_f32 v213, v213, v202, v202
  v_fma_f32 v214, v214, v202, v202
  v_fma_f32 v215, v215, v202, v202
  v_mfma_f32_16x16x32_bf16 v[32:35], a[28:31], v[168:171], v[32:35]
  v_rcp_f32 v212, v212
  v_rcp_f32 v213, v213
  v_mfma_f32_16x16x32_bf16 v[36:39], a[28:31], v[172:175], v[36:39]
  v_rcp_f32 v214, v214
  v_rcp_f32 v215, v215
  v_mfma_f32_16x16x32_bf16 v[40:43], a[32:35], v[168:171], v[40:43]
  v_mul_f32 v88, v88, v212
  v_mul_f32 v89, v89, v213
  v_mul_f32 v90, v90, v214
  v_mul_f32 v91, v91, v215
  v_mfma_f32_16x16x32_bf16 v[44:47], a[32:35], v[172:175], v[44:47]
  s_waitcnt vmcnt(11)
  v_swap_b32 v130, v132
  v_swap_b32 v131, v133
  v_cvt_pk_bf16_f32 v208, v88, v89
  v_cvt_pk_bf16_f32 v209, v90, v91
  v_mfma_f32_16x16x32_bf16 v[48:51], a[36:39], v[168:171], v[48:51]
  v_mul_f32 v212, v92, v92
  v_mul_f32 v213, v93, v93
  v_mul_f32 v214, v94, v94
  v_mul_f32 v215, v95, v95
  v_mfma_f32_16x16x32_bf16 v[52:55], a[36:39], v[172:175], v[52:55]
  v_fma_f32 v212, v212, v204, v203
  v_fma_f32 v213, v213, v204, v203
  v_fma_f32 v214, v214, v204, v203
  v_fma_f32 v215, v215, v204, v203
  v_mfma_f32_16x16x32_bf16 v[16:19], a[40:43], v[128:131], v[16:19]
  v_mul_f32 v212, v212, v92
  v_mul_f32 v213, v213, v93
  v_mul_f32 v214, v214, v94
  v_mul_f32 v215, v215, v95
  v_mfma_f32_16x16x32_bf16 v[20:23], a[40:43], v[132:135], v[20:23]
  buffer_load_dwordx4 v[192:195], v3, s[44:47], s68 offen sc1
  buffer_load_dwordx4 v[196:199], v3, s[44:47], s68 offen offset:1024 sc1
  v_exp_f32 v212, v212
  v_mfma_f32_16x16x32_bf16 v[24:27], a[44:47], v[128:131], v[24:27]
  v_exp_f32 v213, v213
  v_exp_f32 v214, v214
  v_mfma_f32_16x16x32_bf16 v[28:31], a[44:47], v[132:135], v[28:31]
  v_exp_f32 v215, v215
  v_mul_f32 v92, v92, v100
  v_mul_f32 v93, v93, v101
  v_mfma_f32_16x16x32_bf16 v[32:35], a[48:51], v[128:131], v[32:35]
  v_mul_f32 v94, v94, v102
  v_mul_f32 v95, v95, v103
  v_fma_f32 v212, v212, v205, v205
  v_fma_f32 v213, v213, v205, v205
  v_mfma_f32_16x16x32_bf16 v[36:39], a[48:51], v[132:135], v[36:39]
  v_fma_f32 v214, v214, v205, v205
  v_fma_f32 v215, v215, v205, v205
  v_rcp_f32 v212, v212
  v_mfma_f32_16x16x32_bf16 v[40:43], a[52:55], v[128:131], v[40:43]
  v_rcp_f32 v213, v213
  v_rcp_f32 v214, v214
  v_mfma_f32_16x16x32_bf16 v[44:47], a[52:55], v[132:135], v[44:47]
  s_waitcnt vmcnt(11)
  v_swap_b32 v138, v140
  v_swap_b32 v139, v141
  v_rcp_f32 v215, v215
  v_mfma_f32_16x16x32_bf16 v[48:51], a[56:59], v[128:131], v[48:51]
  v_mul_f32 v92, v92, v212
  v_mul_f32 v93, v93, v213
  v_mul_f32 v94, v94, v214
  v_mul_f32 v95, v95, v215
  v_mfma_f32_16x16x32_bf16 v[52:55], a[56:59], v[132:135], v[52:55]
  v_cvt_pk_bf16_f32 v210, v92, v93
  v_cvt_pk_bf16_f32 v211, v94, v95
  s_mov_b32 s80, 0x1b71000
  buffer_store_dwordx4 v[208:211], v8, s[36:39], s80 offen sc1
  v_mfma_f32_16x16x32_bf16 v[16:19], a[60:63], v[136:139], v[16:19]
  v_mul_f32 v212, v104, v104
  v_mul_f32 v213, v105, v105
  v_mul_f32 v214, v106, v106
  v_mul_f32 v215, v107, v107
  v_mfma_f32_16x16x32_bf16 v[20:23], a[60:63], v[140:143], v[20:23]
  buffer_load_dwordx4 v[160:163], v3, s[44:47], s69 offen sc1
  buffer_load_dwordx4 v[164:167], v3, s[44:47], s69 offen offset:1024 sc1
  v_fma_f32 v212, v212, v201, v200
  v_fma_f32 v213, v213, v201, v200
  v_mfma_f32_16x16x32_bf16 v[24:27], a[64:67], v[136:139], v[24:27]
  v_fma_f32 v214, v214, v201, v200
  v_fma_f32 v215, v215, v201, v200
  v_mul_f32 v212, v212, v104
  v_mul_f32 v213, v213, v105
  v_mfma_f32_16x16x32_bf16 v[28:31], a[64:67], v[140:143], v[28:31]
  v_mul_f32 v214, v214, v106
  v_mul_f32 v215, v215, v107
  v_exp_f32 v212, v212
  v_mfma_f32_16x16x32_bf16 v[32:35], a[68:71], v[136:139], v[32:35]
  v_exp_f32 v213, v213
  v_exp_f32 v214, v214
  v_mfma_f32_16x16x32_bf16 v[36:39], a[68:71], v[140:143], v[36:39]
  v_exp_f32 v215, v215
  v_mul_f32 v104, v104, v112
  v_mul_f32 v105, v105, v113
  v_mfma_f32_16x16x32_bf16 v[40:43], a[72:75], v[136:139], v[40:43]
  v_mul_f32 v106, v106, v114
  v_mul_f32 v107, v107, v115
  v_fma_f32 v212, v212, v202, v202
  v_fma_f32 v213, v213, v202, v202
  v_mfma_f32_16x16x32_bf16 v[44:47], a[72:75], v[140:143], v[44:47]
  s_waitcnt vmcnt(12)
  v_swap_b32 v146, v148
  v_swap_b32 v147, v149
  v_fma_f32 v214, v214, v202, v202
  v_fma_f32 v215, v215, v202, v202
  v_mfma_f32_16x16x32_bf16 v[48:51], a[76:79], v[136:139], v[48:51]
  v_rcp_f32 v212, v212
  v_rcp_f32 v213, v213
  v_mfma_f32_16x16x32_bf16 v[52:55], a[76:79], v[140:143], v[52:55]
  v_rcp_f32 v214, v214
  v_rcp_f32 v215, v215
  v_mfma_f32_16x16x32_bf16 v[16:19], a[80:83], v[144:147], v[16:19]
  v_mul_f32 v104, v104, v212
  v_mul_f32 v105, v105, v213
  v_mul_f32 v106, v106, v214
  v_mul_f32 v107, v107, v215
  v_mfma_f32_16x16x32_bf16 v[20:23], a[80:83], v[148:151], v[20:23]
  buffer_load_dwordx4 v[168:171], v3, s[44:47], s70 offen sc1
  buffer_load_dwordx4 v[172:175], v3, s[44:47], s70 offen offset:1024 sc1
  v_cvt_pk_bf16_f32 v208, v104, v105
  v_cvt_pk_bf16_f32 v209, v106, v107
  v_mfma_f32_16x16x32_bf16 v[24:27], a[84:87], v[144:147], v[24:27]
  v_mul_f32 v212, v108, v108
  v_mul_f32 v213, v109, v109
  v_mul_f32 v214, v110, v110
  v_mul_f32 v215, v111, v111
  v_mfma_f32_16x16x32_bf16 v[28:31], a[84:87], v[148:151], v[28:31]
  v_fma_f32 v212, v212, v204, v203
  v_fma_f32 v213, v213, v204, v203
  v_fma_f32 v214, v214, v204, v203
  v_fma_f32 v215, v215, v204, v203
  v_mfma_f32_16x16x32_bf16 v[32:35], a[88:91], v[144:147], v[32:35]
  v_mul_f32 v212, v212, v108
  v_mul_f32 v213, v213, v109
  v_mul_f32 v214, v214, v110
  v_mul_f32 v215, v215, v111
  v_mfma_f32_16x16x32_bf16 v[36:39], a[88:91], v[148:151], v[36:39]
  v_exp_f32 v212, v212
  v_exp_f32 v213, v213
  v_mfma_f32_16x16x32_bf16 v[40:43], a[92:95], v[144:147], v[40:43]
  v_exp_f32 v214, v214
  v_exp_f32 v215, v215
  v_mfma_f32_16x16x32_bf16 v[44:47], a[92:95], v[148:151], v[44:47]
  s_waitcnt vmcnt(12)
  v_swap_b32 v154, v156
  v_swap_b32 v155, v157
  v_mul_f32 v108, v108, v116
  v_mul_f32 v109, v109, v117
  v_mfma_f32_16x16x32_bf16 v[48:51], a[96:99], v[144:147], v[48:51]
  v_mul_f32 v110, v110, v118
  v_mul_f32 v111, v111, v119
  v_fma_f32 v212, v212, v205, v205
  v_fma_f32 v213, v213, v205, v205
  v_mfma_f32_16x16x32_bf16 v[52:55], a[96:99], v[148:151], v[52:55]
  v_fma_f32 v214, v214, v205, v205
  v_fma_f32 v215, v215, v205, v205
  v_rcp_f32 v212, v212
  v_mfma_f32_16x16x32_bf16 v[16:19], a[100:103], v[152:155], v[16:19]
  v_rcp_f32 v213, v213
  v_rcp_f32 v214, v214
  v_mfma_f32_16x16x32_bf16 v[20:23], a[100:103], v[156:159], v[20:23]
  buffer_load_dwordx4 v[128:131], v3, s[44:47], s71 offen sc1
  buffer_load_dwordx4 v[132:135], v3, s[44:47], s71 offen offset:1024 sc1
  v_rcp_f32 v215, v215
  v_mfma_f32_16x16x32_bf16 v[24:27], a[104:107], v[152:155], v[24:27]
  v_mul_f32 v108, v108, v212
  v_mul_f32 v109, v109, v213
  v_mul_f32 v110, v110, v214
  v_mul_f32 v111, v111, v215
  v_mfma_f32_16x16x32_bf16 v[28:31], a[104:107], v[156:159], v[28:31]
  v_cvt_pk_bf16_f32 v210, v108, v109
  v_cvt_pk_bf16_f32 v211, v110, v111
  s_mov_b32 s80, 0x1b72000
  buffer_store_dwordx4 v[208:211], v8, s[36:39], s80 offen sc1
  v_mfma_f32_16x16x32_bf16 v[32:35], a[108:111], v[152:155], v[32:35]
  v_mfma_f32_16x16x32_bf16 v[36:39], a[108:111], v[156:159], v[36:39]
  v_mfma_f32_16x16x32_bf16 v[40:43], a[112:115], v[152:155], v[40:43]
  v_mfma_f32_16x16x32_bf16 v[44:47], a[112:115], v[156:159], v[44:47]
  s_waitcnt vmcnt(13)
  v_swap_b32 v178, v180
  v_swap_b32 v179, v181
  v_mfma_f32_16x16x32_bf16 v[48:51], a[116:119], v[152:155], v[48:51]
  v_mfma_f32_16x16x32_bf16 v[52:55], a[116:119], v[156:159], v[52:55]
  v_mfma_f32_16x16x32_bf16 v[16:19], a[120:123], v[176:179], v[16:19]
  s_mov_b32 s83, 0x1200000
  buffer_load_dwordx4 v[56:59], v10, s[36:39], s83 offen sc1
  buffer_load_dword v60, v4, s[36:39], s83 offen sc1
  s_mov_b32 s83, 0x1500000
  buffer_load_dwordx4 v[64:67], v10, s[36:39], s83 offen sc1
  buffer_load_dword v68, v4, s[36:39], s83 offen sc1
  v_mfma_f32_16x16x32_bf16 v[20:23], a[120:123], v[180:183], v[20:23]
  buffer_load_dwordx4 v[136:139], v15, s[44:47], s72 offen sc1
  buffer_load_dwordx4 v[140:143], v15, s[44:47], s72 offen offset:1024 sc1
  v_mfma_f32_16x16x32_bf16 v[24:27], a[124:127], v[176:179], v[24:27]
  v_mfma_f32_16x16x32_bf16 v[28:31], a[124:127], v[180:183], v[28:31]
  v_mfma_f32_16x16x32_bf16 v[32:35], a[128:131], v[176:179], v[32:35]
  v_mfma_f32_16x16x32_bf16 v[36:39], a[128:131], v[180:183], v[36:39]
  v_mfma_f32_16x16x32_bf16 v[40:43], a[132:135], v[176:179], v[40:43]
  v_mfma_f32_16x16x32_bf16 v[44:47], a[132:135], v[180:183], v[44:47]
  s_waitcnt vmcnt(16)
  v_swap_b32 v186, v188
  v_swap_b32 v187, v189
  v_mfma_f32_16x16x32_bf16 v[48:51], a[136:139], v[176:179], v[48:51]
  v_mfma_f32_16x16x32_bf16 v[52:55], a[136:139], v[180:183], v[52:55]
  v_mfma_f32_16x16x32_bf16 v[16:19], a[140:143], v[184:187], v[16:19]
  v_mfma_f32_16x16x32_bf16 v[20:23], a[140:143], v[188:191], v[20:23]
  buffer_load_dwordx4 v[144:147], v15, s[44:47], s73 offen sc1
  buffer_load_dwordx4 v[148:151], v15, s[44:47], s73 offen offset:1024 sc1
  v_mfma_f32_16x16x32_bf16 v[24:27], a[144:147], v[184:187], v[24:27]
  v_mfma_f32_16x16x32_bf16 v[28:31], a[144:147], v[188:191], v[28:31]
  v_mfma_f32_16x16x32_bf16 v[32:35], a[148:151], v[184:187], v[32:35]
  v_mfma_f32_16x16x32_bf16 v[36:39], a[148:151], v[188:191], v[36:39]
  v_mfma_f32_16x16x32_bf16 v[40:43], a[152:155], v[184:187], v[40:43]
  v_mfma_f32_16x16x32_bf16 v[44:47], a[152:155], v[188:191], v[44:47]
  s_waitcnt vmcnt(16)
  v_swap_b32 v194, v196
  v_swap_b32 v195, v197
  v_mfma_f32_16x16x32_bf16 v[48:51], a[156:159], v[184:187], v[48:51]
  v_mfma_f32_16x16x32_bf16 v[52:55], a[156:159], v[188:191], v[52:55]
  v_mfma_f32_16x16x32_bf16 v[16:19], a[160:163], v[192:195], v[16:19]
  v_mfma_f32_16x16x32_bf16 v[20:23], a[160:163], v[196:199], v[20:23]
  v_mfma_f32_16x16x32_bf16 v[24:27], a[164:167], v[192:195], v[24:27]
  v_mfma_f32_16x16x32_bf16 v[28:31], a[164:167], v[196:199], v[28:31]
  v_mfma_f32_16x16x32_bf16 v[32:35], a[168:171], v[192:195], v[32:35]
  v_mfma_f32_16x16x32_bf16 v[36:39], a[168:171], v[196:199], v[36:39]
  v_mfma_f32_16x16x32_bf16 v[40:43], a[172:175], v[192:195], v[40:43]
  v_mfma_f32_16x16x32_bf16 v[44:47], a[172:175], v[196:199], v[44:47]
  s_waitcnt vmcnt(13)
  v_swap_b32 v162, v164
  v_swap_b32 v163, v165
  v_mfma_f32_16x16x32_bf16 v[48:51], a[176:179], v[192:195], v[48:51]
  v_mfma_f32_16x16x32_bf16 v[52:55], a[176:179], v[196:199], v[52:55]
  v_mfma_f32_16x16x32_bf16 v[16:19], a[180:183], v[160:163], v[16:19]
  v_mfma_f32_16x16x32_bf16 v[20:23], a[180:183], v[164:167], v[20:23]
  v_mfma_f32_16x16x32_bf16 v[24:27], a[184:187], v[160:163], v[24:27]
  v_mfma_f32_16x16x32_bf16 v[28:31], a[184:187], v[164:167], v[28:31]
  v_mfma_f32_16x16x32_bf16 v[32:35], a[188:191], v[160:163], v[32:35]
  v_mfma_f32_16x16x32_bf16 v[36:39], a[188:191], v[164:167], v[36:39]
  s_lshr_b32 s81, s91, 3
  s_lshl_b32 s80, s90, 3
  v_mfma_f32_16x16x32_bf16 v[40:43], a[192:195], v[160:163], v[40:43]
  s_add_u32 s80, s80, s81
  s_lshl_b32 s80, s80, 2
  v_mfma_f32_16x16x32_bf16 v[44:47], a[192:195], v[164:167], v[44:47]
  s_waitcnt vmcnt(11)
  v_swap_b32 v170, v172
  v_swap_b32 v171, v173
  v_mfma_f32_16x16x32_bf16 v[48:51], a[196:199], v[160:163], v[48:51]
  s_add_u32 s80, s80, s32
  s_lshl_b32 s80, s80, 7
  v_mfma_f32_16x16x32_bf16 v[52:55], a[196:199], v[164:167], v[52:55]
  s_add_u32 s80, s80, 34816
  s_waitcnt vmcnt(8)
  v_or_b32 v230, s80, v206
  v_mfma_f32_16x16x32_bf16 v[16:19], a[200:203], v[168:171], v[16:19]
  v_mov_b32 v231, 1
  buffer_atomic_add v231, v230, s[36:39], 0 offen sc1
  v_mfma_f32_16x16x32_bf16 v[20:23], a[200:203], v[172:175], v[20:23]
  v_mfma_f32_16x16x32_bf16 v[24:27], a[204:207], v[168:171], v[24:27]
  v_mfma_f32_16x16x32_bf16 v[28:31], a[204:207], v[172:175], v[28:31]
  v_mfma_f32_16x16x32_bf16 v[32:35], a[208:211], v[168:171], v[32:35]
  v_mfma_f32_16x16x32_bf16 v[36:39], a[208:211], v[172:175], v[36:39]
  v_mfma_f32_16x16x32_bf16 v[40:43], a[212:215], v[168:171], v[40:43]
  v_mfma_f32_16x16x32_bf16 v[44:47], a[212:215], v[172:175], v[44:47]
  v_swap_b32 v130, v132
  v_swap_b32 v131, v133
  v_mfma_f32_16x16x32_bf16 v[48:51], a[216:219], v[168:171], v[48:51]
  v_mfma_f32_16x16x32_bf16 v[52:55], a[216:219], v[172:175], v[52:55]
  v_mfma_f32_16x16x32_bf16 v[16:19], a[220:223], v[128:131], v[16:19]
  v_mfma_f32_16x16x32_bf16 v[20:23], a[220:223], v[132:135], v[20:23]
  v_mfma_f32_16x16x32_bf16 v[24:27], a[224:227], v[128:131], v[24:27]
  v_mfma_f32_16x16x32_bf16 v[28:31], a[224:227], v[132:135], v[28:31]
  v_mfma_f32_16x16x32_bf16 v[32:35], a[228:231], v[128:131], v[32:35]
  v_mfma_f32_16x16x32_bf16 v[36:39], a[228:231], v[132:135], v[36:39]
  v_mfma_f32_16x16x32_bf16 v[40:43], a[232:235], v[128:131], v[40:43]
  v_mfma_f32_16x16x32_bf16 v[44:47], a[232:235], v[132:135], v[44:47]
  s_waitcnt vmcnt(3)
  v_swap_b32 v138, v140
  v_swap_b32 v139, v141
  v_mfma_f32_16x16x32_bf16 v[48:51], a[236:239], v[128:131], v[48:51]
  v_mfma_f32_16x16x32_bf16 v[52:55], a[236:239], v[132:135], v[52:55]
  v_mfma_f32_16x16x32_bf16 v[16:19], a[240:243], v[136:139], v[16:19]
  v_mfma_f32_16x16x32_bf16 v[20:23], a[240:243], v[140:143], v[20:23]
  v_mfma_f32_16x16x32_bf16 v[24:27], a[244:247], v[136:139], v[24:27]
  v_mfma_f32_16x16x32_bf16 v[28:31], a[244:247], v[140:143], v[28:31]
  v_mfma_f32_16x16x32_bf16 v[32:35], a[248:251], v[136:139], v[32:35]
  v_mfma_f32_16x16x32_bf16 v[36:39], a[248:251], v[140:143], v[36:39]
  v_mfma_f32_16x16x32_bf16 v[40:43], a[252:255], v[136:139], v[40:43]
  v_mfma_f32_16x16x32_bf16 v[44:47], a[252:255], v[140:143], v[44:47]
  s_waitcnt vmcnt(1)
  v_swap_b32 v146, v148
  v_swap_b32 v147, v149
  v_mfma_f32_16x16x32_bf16 v[48:51], v[232:235], v[136:139], v[48:51]
  v_mfma_f32_16x16x32_bf16 v[52:55], v[232:235], v[140:143], v[52:55]
  v_mfma_f32_16x16x32_bf16 v[16:19], v[236:239], v[144:147], v[16:19]
  v_mfma_f32_16x16x32_bf16 v[20:23], v[236:239], v[148:151], v[20:23]
  v_mfma_f32_16x16x32_bf16 v[24:27], v[240:243], v[144:147], v[24:27]
  v_mfma_f32_16x16x32_bf16 v[28:31], v[240:243], v[148:151], v[28:31]
  v_mfma_f32_16x16x32_bf16 v[32:35], v[244:247], v[144:147], v[32:35]
  v_mfma_f32_16x16x32_bf16 v[36:39], v[244:247], v[148:151], v[36:39]
  v_mfma_f32_16x16x32_bf16 v[40:43], v[248:251], v[144:147], v[40:43]
  v_mfma_f32_16x16x32_bf16 v[44:47], v[248:251], v[148:151], v[44:47]
  v_mfma_f32_16x16x32_bf16 v[48:51], v[252:255], v[144:147], v[48:51]
  v_mfma_f32_16x16x32_bf16 v[52:55], v[252:255], v[148:151], v[52:55]
  s_lshl_b32 s80, s32, 12
  v_add_u32 v216, s80, v14
  v_xor_b32 v217, 0x2000, v216
  ds_write_b128 v216, v[32:35] offset:0
  ds_write_b128 v216, v[36:39] offset:1024
  ds_write_b128 v216, v[40:43] offset:2048
  ds_write_b128 v216, v[44:47] offset:3072
  v_xor_b32 v218, 0x3000, v216
  v_lshrrev_b32 v219, 4, v1
  v_xor_b32 v219, 2, v219
  v_and_b32 v220, 0xf0, v14
  v_lshl_add_u32 v219, v219, 12, v220
  s_lshl_b32 s80, s32, 8
  v_add_u32 v219, s80, v219
  s_waitcnt lgkmcnt(0)
  s_barrier
  ds_read_b128 v[96:99], v217 offset:2048
  ds_read_b128 v[100:103], v217 offset:3072
  ds_read_b128 v[88:91], v217 offset:0
  ds_read_b128 v[92:95], v217 offset:1024
  s_waitcnt lgkmcnt(3)
  v_pk_add_f32 v[24:25], v[24:25], v[96:97]
  v_pk_add_f32 v[26:27], v[26:27], v[98:99]
  s_waitcnt lgkmcnt(2)
  v_pk_add_f32 v[28:29], v[28:29], v[100:101]
  v_pk_add_f32 v[30:31], v[30:31], v[102:103]
  s_waitcnt lgkmcnt(0)
  ds_write_b128 v217, v[24:27] offset:0
  ds_write_b128 v217, v[28:31] offset:1024
  ds_write_b128 v217, v[48:51] offset:2048
  ds_write_b128 v217, v[52:55] offset:3072
  v_pk_add_f32 v[16:17], v[16:17], v[88:89]
  v_pk_add_f32 v[18:19], v[18:19], v[90:91]
  v_pk_add_f32 v[20:21], v[20:21], v[92:93]
  v_pk_add_f32 v[22:23], v[22:23], v[94:95]
  v_lshlrev_b32 v212, 16, v56
  v_and_b32 v213, 0xffff0000, v56
  v_pk_add_f32 v[16:17], v[16:17], v[212:213]
  v_lshlrev_b32 v214, 16, v57
  v_and_b32 v215, 0xffff0000, v57
  v_pk_add_f32 v[18:19], v[18:19], v[214:215]
  v_lshlrev_b32 v212, 16, v58
  v_and_b32 v213, 0xffff0000, v58
  v_pk_add_f32 v[20:21], v[20:21], v[212:213]
  v_lshlrev_b32 v214, 16, v59
  v_and_b32 v215, 0xffff0000, v59
  v_pk_add_f32 v[22:23], v[22:23], v[214:215]
  s_lshl_b32 s80, s30, 3
  s_add_u32 s80, s80, s32
  s_lshl_b32 s80, s80, 2
  s_add_u32 s80, s80, s100
  s_lshl_b32 s80, s80, 7
  s_add_u32 s80, s80, 34816
  v_add_u32 v230, s80, v206
  buffer_load_dword v231, v230, s[36:39], 0 offen sc1
  s_waitcnt lgkmcnt(0)
  s_barrier
  ds_read_b128 v[96:99], v219 offset:2048
  ds_read_b128 v[100:103], v219 offset:3072
  ds_read_b128 v[88:91], v218 offset:0
  ds_read_b128 v[92:95], v218 offset:1024
  v_lshlrev_b32 v24, 16, v60
  v_and_b32 v25, 0xffff0000, v60
  s_waitcnt lgkmcnt(2)
  v_permlane32_swap_b32 v96, v100
  v_permlane32_swap_b32 v97, v101
  v_permlane32_swap_b32 v98, v102
  v_permlane32_swap_b32 v99, v103
  v_pk_add_f32 v[96:97], v[96:97], v[100:101]
  v_pk_add_f32 v[98:99], v[98:99], v[102:103]
  s_waitcnt lgkmcnt(1)
  v_pk_add_f32 v[16:17], v[16:17], v[88:89]
  v_pk_add_f32 v[18:19], v[18:19], v[90:91]
  s_waitcnt lgkmcnt(0)
  v_pk_add_f32 v[20:21], v[20:21], v[92:93]
  v_pk_add_f32 v[22:23], v[22:23], v[94:95]
  v_permlane16_swap_b32 v96, v98
  v_permlane16_swap_b32 v97, v99
  v_pk_add_f32 v[24:25], v[24:25], v[96:97]
  v_pk_add_f32 v[24:25], v[24:25], v[98:99]
  s_waitcnt vmcnt(0)
  v_cmp_gt_u32 vcc, 8, v231
  s_nop 0
  s_and_b32 vcc_lo, vcc_lo, 0x1
  s_cbranch_scc1 L_cp_21
L_cpb_22:
  s_add_u32 s44, s28, 0x1b70000
  s_addc_u32 s45, s29, 0
  buffer_load_dwordx4 v[152:155], v3, s[44:47], s60 offen sc1
  v_add_f32 v216, v16, v17
  v_mul_f32 v217, v16, v16
  v_add_f32 v218, v20, v21
  v_mul_f32 v219, v20, v20
  v_fmac_f32 v217, v17, v17
  buffer_load_dwordx4 v[156:159], v3, s[44:47], s60 offen offset:1024 sc1
  v_fmac_f32 v219, v21, v21
  v_add_f32 v216, v216, v18
  v_fmac_f32 v217, v18, v18
  v_add_f32 v218, v218, v22
  v_fmac_f32 v219, v22, v22
  buffer_load_dwordx4 v[176:179], v3, s[44:47], s61 offen sc1
  v_add_f32 v216, v216, v19
  v_fmac_f32 v217, v19, v19
  v_add_f32 v218, v218, v23
  v_fmac_f32 v219, v23, v23
  v_and_b32 v220, 0xf0, v14
  buffer_load_dwordx4 v[180:183], v3, s[44:47], s61 offen offset:1024 sc1
  v_lshrrev_b32 v221, 4, v1
  v_permlane32_swap_b32 v216, v218
  v_permlane32_swap_b32 v217, v219
  v_add_f32 v216, v216, v218
  v_add_f32 v217, v217, v219
  buffer_load_dwordx4 v[184:187], v3, s[44:47], s62 offen sc1
  v_add_f32 v216, v216, v24
  v_fmac_f32 v217, v24, v24
  v_add_f32 v216, v216, v25
  v_fmac_f32 v217, v25, v25
  v_lshl_add_u32 v220, v221, 2, v220
  buffer_load_dwordx4 v[188:191], v3, s[44:47], s62 offen offset:1024 sc1
  s_lshl_b32 s80, s32, 8
  v_add_u32 v220, s80, v220
  v_permlane16_swap_b32 v216, v217
  v_add_f32 v216, v216, v217
  ds_write_b32 v220, v216 offset:16384
  buffer_load_dwordx4 v[192:195], v3, s[44:47], s63 offen sc1
  v_lshlrev_b32 v220, 2, v1
  s_lshl_b32 s80, s30, 14
  s_lshl_b32 s81, s31, 8
  s_add_u32 s80, s80, s81
  s_add_u32 s80, s80, 0x2a80000
  buffer_load_dwordx4 v[196:199], v3, s[44:47], s63 offen offset:1024 sc1
  s_cmp_eq_u32 s32, 0
  s_cselect_b32 s80, s80, 0x80000000
  v_add_u32 v221, s80, v220
  s_waitcnt lgkmcnt(0)
  s_barrier
  ds_read_b32 v216, v220 offset:16384
  buffer_load_dwordx4 v[160:163], v3, s[44:47], s64 offen sc1
  ds_read_b32 v217, v220 offset:16640
  ds_read_b32 v218, v220 offset:16896
  ds_read_b32 v219, v220 offset:17152
  s_waitcnt lgkmcnt(2)
  v_add_f32 v216, v216, v217
  s_waitcnt lgkmcnt(0)
  v_add_f32 v218, v218, v219
  buffer_load_dwordx4 v[164:167], v3, s[44:47], s64 offen offset:1024 sc1
  v_add_f32 v216, v216, v218
  v_or_b32 v216, 1, v216
  buffer_store_dword v216, v221, s[36:39], 0 offen sc1
  buffer_load_dwordx4 v[168:171], v3, s[44:47], s65 offen sc1
  buffer_load_dwordx4 v[172:175], v3, s[44:47], s65 offen offset:1024 sc1
  s_waitcnt vmcnt(11)
  v_swap_b32 v154, v156
  v_swap_b32 v155, v157
  s_nop 1
  v_mfma_f32_16x16x32_bf16 v[72:75], a[0:3], v[152:155], 0
  v_mfma_f32_16x16x32_bf16 v[76:79], a[0:3], v[156:159], 0
  buffer_load_dwordx4 v[128:131], v3, s[44:47], s66 offen sc1
  buffer_load_dwordx4 v[132:135], v3, s[44:47], s66 offen offset:1024 sc1
  v_mfma_f32_16x16x32_bf16 v[80:83], a[4:7], v[152:155], 0
  v_mfma_f32_16x16x32_bf16 v[84:87], a[4:7], v[156:159], 0
  v_mfma_f32_16x16x32_bf16 v[88:91], a[8:11], v[152:155], 0
  v_mfma_f32_16x16x32_bf16 v[92:95], a[8:11], v[156:159], 0
  v_mfma_f32_16x16x32_bf16 v[96:99], a[12:15], v[152:155], 0
  v_mfma_f32_16x16x32_bf16 v[100:103], a[12:15], v[156:159], 0
  s_waitcnt vmcnt(11)
  v_swap_b32 v178, v180
  v_swap_b32 v179, v181
  v_mfma_f32_16x16x32_bf16 v[104:107], a[16:19], v[152:155], 0
  v_mfma_f32_16x16x32_bf16 v[108:111], a[16:19], v[156:159], 0
  v_mfma_f32_16x16x32_bf16 v[72:75], a[20:23], v[176:179], v[72:75]
  v_mfma_f32_16x16x32_bf16 v[76:79], a[20:23], v[180:183], v[76:79]
  buffer_load_dwordx4 v[136:139], v3, s[44:47], s67 offen sc1
  buffer_load_dwordx4 v[140:143], v3, s[44:47], s67 offen offset:1024 sc1
  v_mfma_f32_16x16x32_bf16 v[80:83], a[24:27], v[176:179], v[80:83]
  v_mfma_f32_16x16x32_bf16 v[84:87], a[24:27], v[180:183], v[84:87]
  v_mfma_f32_16x16x32_bf16 v[88:91], a[28:31], v[176:179], v[88:91]
  v_mfma_f32_16x16x32_bf16 v[92:95], a[28:31], v[180:183], v[92:95]
  buffer_load_dwordx4 v[216:219], v13, s[36:39], 0 offen offset:0 sc1
  buffer_load_dwordx4 v[220:223], v13, s[36:39], 0 offen offset:256 sc1
  v_mfma_f32_16x16x32_bf16 v[96:99], a[32:35], v[176:179], v[96:99]
  v_mfma_f32_16x16x32_bf16 v[100:103], a[32:35], v[180:183], v[100:103]
  s_waitcnt vmcnt(13)
  v_swap_b32 v186, v188
  v_swap_b32 v187, v189
  v_mfma_f32_16x16x32_bf16 v[104:107], a[36:39], v[176:179], v[104:107]
  v_mfma_f32_16x16x32_bf16 v[108:111], a[36:39], v[180:183], v[108:111]
  v_mfma_f32_16x16x32_bf16 v[72:75], a[40:43], v[184:187], v[72:75]
  v_mfma_f32_16x16x32_bf16 v[76:79], a[40:43], v[188:191], v[76:79]
  buffer_load_dwordx4 v[144:147], v3, s[44:47], s68 offen sc1
  buffer_load_dwordx4 v[148:151], v3, s[44:47], s68 offen offset:1024 sc1
  v_mfma_f32_16x16x32_bf16 v[80:83], a[44:47], v[184:187], v[80:83]
  v_mfma_f32_16x16x32_bf16 v[84:87], a[44:47], v[188:191], v[84:87]
  v_mfma_f32_16x16x32_bf16 v[88:91], a[48:51], v[184:187], v[88:91]
  v_mfma_f32_16x16x32_bf16 v[92:95], a[48:51], v[188:191], v[92:95]
  v_mfma_f32_16x16x32_bf16 v[96:99], a[52:55], v[184:187], v[96:99]
  v_mfma_f32_16x16x32_bf16 v[100:103], a[52:55], v[188:191], v[100:103]
  s_waitcnt vmcnt(13)
  v_swap_b32 v194, v196
  v_swap_b32 v195, v197
  v_mfma_f32_16x16x32_bf16 v[104:107], a[56:59], v[184:187], v[104:107]
  v_mfma_f32_16x16x32_bf16 v[108:111], a[56:59], v[188:191], v[108:111]
  v_mfma_f32_16x16x32_bf16 v[72:75], a[60:63], v[192:195], v[72:75]
  v_mfma_f32_16x16x32_bf16 v[76:79], a[60:63], v[196:199], v[76:79]
  buffer_load_dwordx4 v[152:155], v3, s[44:47], s69 offen sc1
  buffer_load_dwordx4 v[156:159], v3, s[44:47], s69 offen offset:1024 sc1
  v_mfma_f32_16x16x32_bf16 v[80:83], a[64:67], v[192:195], v[80:83]
  v_mfma_f32_16x16x32_bf16 v[84:87], a[64:67], v[196:199], v[84:87]
  v_mfma_f32_16x16x32_bf16 v[88:91], a[68:71], v[192:195], v[88:91]
  v_mfma_f32_16x16x32_bf16 v[92:95], a[68:71], v[196:199], v[92:95]
  v_mfma_f32_16x16x32_bf16 v[96:99], a[72:75], v[192:195], v[96:99]
  v_mfma_f32_16x16x32_bf16 v[100:103], a[72:75], v[196:199], v[100:103]
  s_waitcnt vmcnt(13)
  v_swap_b32 v162, v164
  v_swap_b32 v163, v165
  v_mfma_f32_16x16x32_bf16 v[104:107], a[76:79], v[192:195], v[104:107]
  v_mfma_f32_16x16x32_bf16 v[108:111], a[76:79], v[196:199], v[108:111]
  v_mfma_f32_16x16x32_bf16 v[72:75], a[80:83], v[160:163], v[72:75]
  v_mfma_f32_16x16x32_bf16 v[76:79], a[80:83], v[164:167], v[76:79]
  buffer_load_dwordx4 v[176:179], v3, s[44:47], s70 offen sc1
  buffer_load_dwordx4 v[180:183], v3, s[44:47], s70 offen offset:1024 sc1
  v_mfma_f32_16x16x32_bf16 v[80:83], a[84:87], v[160:163], v[80:83]
  v_mfma_f32_16x16x32_bf16 v[84:87], a[84:87], v[164:167], v[84:87]
  v_mfma_f32_16x16x32_bf16 v[88:91], a[88:91], v[160:163], v[88:91]
  v_mfma_f32_16x16x32_bf16 v[92:95], a[88:91], v[164:167], v[92:95]
  s_waitcnt vmcnt(7)
  v_bitop3_b32 v224, v216, v217, v218 bitop3:0x80
  s_waitcnt vmcnt(6)
  v_bitop3_b32 v225, v219, v220, v221 bitop3:0x80
  v_bitop3_b32 v224, v224, v222, v223 bitop3:0x80
  v_bitop3_b32 v224, v224, v225, 1 bitop3:0x80
  v_mfma_f32_16x16x32_bf16 v[96:99], a[92:95], v[160:163], v[96:99]
  v_cmp_eq_u32 vcc, 0, v224
  s_nop 0
  s_cbranch_vccnz L_tp_23
L_tpb_24:
  v_add_f32 v216, v216, v220
  v_add_f32 v217, v217, v221
  v_mfma_f32_16x16x32_bf16 v[100:103], a[92:95], v[164:167], v[100:103]
  v_swap_b32 v170, v172
  v_swap_b32 v171, v173
  v_add_f32 v218, v218, v222
  v_add_f32 v219, v219, v223
  v_mfma_f32_16x16x32_bf16 v[104:107], a[96:99], v[160:163], v[104:107]
  v_permlane32_swap_b32 v216, v218
  v_permlane32_swap_b32 v217, v219
  v_add_f32 v216, v216, v218
  v_add_f32 v217, v217, v219
  v_mfma_f32_16x16x32_bf16 v[108:111], a[96:99], v[164:167], v[108:111]
  s_nop 0
  v_permlane16_swap_b32 v216, v217
  v_add_f32 v216, v216, v217
  v_mov_b32 v217, v216
  s_nop 1
  v_permlane16_swap_b32 v216, v217
  v_mfma_f32_16x16x32_bf16 v[72:75], a[100:103], v[168:171], v[72:75]
  v_mov_b32 v218, v216
  v_mov_b32 v219, v217
  s_nop 0
  v_permlane32_swap_b32 v216, v218
  v_permlane32_swap_b32 v217, v219
  v_mfma_f32_16x16x32_bf16 v[76:79], a[100:103], v[172:175], v[76:79]
  buffer_load_dwordx4 v[184:187], v3, s[44:47], s71 offen sc1
  buffer_load_dwordx4 v[188:191], v3, s[44:47], s71 offen offset:1024 sc1
  v_mul_f32 v216, 0x3acccccd, v216
  v_mul_f32 v217, 0x3acccccd, v217
  v_mfma_f32_16x16x32_bf16 v[80:83], a[104:107], v[168:171], v[80:83]
  v_mul_f32 v218, 0x3acccccd, v218
  v_mul_f32 v219, 0x3acccccd, v219
  v_fma_f32 v217, -v216, v216, v217
  v_fma_f32 v219, -v218, v218, v219
  v_mfma_f32_16x16x32_bf16 v[84:87], a[104:107], v[172:175], v[84:87]
  v_max_f32 v217, 0, v217
  v_max_f32 v219, 0, v219
  v_add_f32 v217, 0x3727c5ac, v217
  v_add_f32 v219, 0x3727c5ac, v219
  v_mfma_f32_16x16x32_bf16 v[88:91], a[108:111], v[168:171], v[88:91]
  v_rsq_f32 v217, v217
  v_rsq_f32 v219, v219
  v_mfma_f32_16x16x32_bf16 v[92:95], a[108:111], v[172:175], v[92:95]
  s_mov_b32 vcc_lo, 0
  s_mov_b32 vcc_hi, -1
  v_mul_f32 v216, v216, v217
  v_mul_f32 v218, v218, v219
  v_mfma_f32_16x16x32_bf16 v[96:99], a[112:115], v[168:171], v[96:99]
  v_cndmask_b32 v221, v217, v219, vcc
  v_cndmask_b32 v220, v216, v218, vcc
  v_lshlrev_b32 v222, 16, v64
  v_and_b32 v223, 0xffff0000, v64
  v_mfma_f32_16x16x32_bf16 v[100:103], a[112:115], v[172:175], v[100:103]
  v_swap_b32 v130, v132
  v_swap_b32 v131, v133
  v_fma_f32 v224, v16, v217, -v216
  v_fma_f32 v225, v17, v217, -v216
  v_mfma_f32_16x16x32_bf16 v[104:107], a[116:119], v[168:171], v[104:107]
  v_fmac_f32 v16, v224, v222
  v_fmac_f32 v17, v225, v223
  v_cvt_pk_bf16_f32 v64, v16, v17
  v_lshlrev_b32 v222, 16, v65
  v_mfma_f32_16x16x32_bf16 v[108:111], a[116:119], v[172:175], v[108:111]
  v_and_b32 v223, 0xffff0000, v65
  v_fma_f32 v224, v18, v217, -v216
  v_fma_f32 v225, v19, v217, -v216
  v_fmac_f32 v18, v224, v222
  v_mfma_f32_16x16x32_bf16 v[72:75], a[120:123], v[128:131], v[72:75]
  s_mov_b32 s83, 0x1228000
  buffer_load_dwordx4 v[112:115], v10, s[36:39], s83 offen sc1
  buffer_load_dword v116, v4, s[36:39], s83 offen sc1
  s_mov_b32 s83, 0x1528000
  buffer_load_dwordx4 v[120:123], v10, s[36:39], s83 offen sc1
  buffer_load_dword v124, v4, s[36:39], s83 offen sc1
  v_mfma_f32_16x16x32_bf16 v[76:79], a[120:123], v[132:135], v[76:79]
  buffer_load_dwordx4 v[192:195], v15, s[44:47], s72 offen sc1
  buffer_load_dwordx4 v[196:199], v15, s[44:47], s72 offen offset:1024 sc1
  v_fmac_f32 v19, v225, v223
  v_cvt_pk_bf16_f32 v65, v18, v19
  v_mfma_f32_16x16x32_bf16 v[80:83], a[124:127], v[128:131], v[80:83]
  v_lshlrev_b32 v222, 16, v66
  v_and_b32 v223, 0xffff0000, v66
  v_fma_f32 v224, v20, v219, -v218
  v_fma_f32 v225, v21, v219, -v218
  v_mfma_f32_16x16x32_bf16 v[84:87], a[124:127], v[132:135], v[84:87]
  v_fmac_f32 v20, v224, v222
  v_fmac_f32 v21, v225, v223
  v_cvt_pk_bf16_f32 v66, v20, v21
  v_lshlrev_b32 v222, 16, v67
  v_mfma_f32_16x16x32_bf16 v[88:91], a[128:131], v[128:131], v[88:91]
  v_and_b32 v223, 0xffff0000, v67
  v_fma_f32 v224, v22, v219, -v218
  v_fma_f32 v225, v23, v219, -v218
  v_fmac_f32 v22, v224, v222
  v_mfma_f32_16x16x32_bf16 v[92:95], a[128:131], v[132:135], v[92:95]
  v_fmac_f32 v23, v225, v223
  v_cvt_pk_bf16_f32 v67, v22, v23
  v_lshlrev_b32 v222, 16, v68
  v_and_b32 v223, 0xffff0000, v68
  v_mfma_f32_16x16x32_bf16 v[96:99], a[132:135], v[128:131], v[96:99]
  v_fma_f32 v224, v24, v221, -v220
  v_fma_f32 v225, v25, v221, -v220
  v_fmac_f32 v24, v224, v222
  v_fmac_f32 v25, v225, v223
  v_mfma_f32_16x16x32_bf16 v[100:103], a[132:135], v[132:135], v[100:103]
  v_swap_b32 v138, v140
  v_swap_b32 v139, v141
  v_cvt_pk_bf16_f32 v68, v24, v25
  s_mov_b32 s80, 0x1800000
  v_mfma_f32_16x16x32_bf16 v[104:107], a[136:139], v[128:131], v[104:107]
  buffer_store_dwordx4 v[64:67], v10, s[36:39], s80 offen sc1
  buffer_store_dword v68, v4, s[36:39], s80 offen sc1
  v_add_f32 v216, v16, v17
  v_mul_f32 v217, v16, v16
  v_mfma_f32_16x16x32_bf16 v[108:111], a[136:139], v[132:135], v[108:111]
  v_add_f32 v218, v20, v21
  v_mul_f32 v219, v20, v20
  v_fmac_f32 v217, v17, v17
  v_fmac_f32 v219, v21, v21
  v_mfma_f32_16x16x32_bf16 v[72:75], a[140:143], v[136:139], v[72:75]
  v_add_f32 v216, v216, v18
  v_fmac_f32 v217, v18, v18
  v_add_f32 v218, v218, v22
  v_fmac_f32 v219, v22, v22
  v_mfma_f32_16x16x32_bf16 v[76:79], a[140:143], v[140:143], v[76:79]
  buffer_load_dwordx4 v[160:163], v15, s[44:47], s73 offen sc1
  buffer_load_dwordx4 v[164:167], v15, s[44:47], s73 offen offset:1024 sc1
  v_add_f32 v216, v216, v19
  v_fmac_f32 v217, v19, v19
  v_mfma_f32_16x16x32_bf16 v[80:83], a[144:147], v[136:139], v[80:83]
  v_add_f32 v218, v218, v23
  v_fmac_f32 v219, v23, v23
  v_and_b32 v220, 0xf0, v14
  v_lshrrev_b32 v221, 4, v1
  v_mfma_f32_16x16x32_bf16 v[84:87], a[144:147], v[140:143], v[84:87]
  v_permlane32_swap_b32 v216, v218
  v_permlane32_swap_b32 v217, v219
  v_add_f32 v216, v216, v218
  v_add_f32 v217, v217, v219
  v_mfma_f32_16x16x32_bf16 v[88:91], a[148:151], v[136:139], v[88:91]
  v_add_f32 v216, v216, v24
  v_fmac_f32 v217, v24, v24
  v_add_f32 v216, v216, v25
  v_fmac_f32 v217, v25, v25
  v_mfma_f32_16x16x32_bf16 v[92:95], a[148:151], v[140:143], v[92:95]
  v_lshl_add_u32 v220, v221, 2, v220
  s_lshl_b32 s80, s32, 8
  v_add_u32 v220, s80, v220
  v_permlane16_swap_b32 v216, v217
  v_mfma_f32_16x16x32_bf16 v[96:99], a[152:155], v[136:139], v[96:99]
  v_add_f32 v216, v216, v217
  ds_write_b32 v220, v216 offset:17408
  v_lshlrev_b32 v220, 2, v1
  s_lshl_b32 s80, s30, 14
  v_mfma_f32_16x16x32_bf16 v[100:103], a[152:155], v[140:143], v[100:103]
  s_waitcnt vmcnt(16)
  v_swap_b32 v146, v148
  v_swap_b32 v147, v149
  s_lshl_b32 s81, s31, 8
  s_add_u32 s80, s80, s81
  v_mfma_f32_16x16x32_bf16 v[104:107], a[156:159], v[136:139], v[104:107]
  s_add_u32 s80, s80, 0x2b00000
  s_cmp_eq_u32 s32, 0
  s_cselect_b32 s80, s80, 0x80000000
  v_add_u32 v221, s80, v220
  s_waitcnt lgkmcnt(0)
  v_mfma_f32_16x16x32_bf16 v[108:111], a[156:159], v[140:143], v[108:111]
  s_barrier
  ds_read_b32 v216, v220 offset:17408
  ds_read_b32 v217, v220 offset:17664
  ds_read_b32 v218, v220 offset:17920
  v_mfma_f32_16x16x32_bf16 v[72:75], a[160:163], v[144:147], v[72:75]
  ds_read_b32 v219, v220 offset:18176
  s_waitcnt lgkmcnt(2)
  v_add_f32 v216, v216, v217
  s_waitcnt lgkmcnt(0)
  v_add_f32 v218, v218, v219
  v_add_f32 v216, v216, v218
  v_mfma_f32_16x16x32_bf16 v[76:79], a[160:163], v[148:151], v[76:79]
  v_or_b32 v216, 1, v216
  buffer_store_dword v216, v221, s[36:39], 0 offen sc1
  v_mfma_f32_16x16x32_bf16 v[80:83], a[164:167], v[144:147], v[80:83]
  v_mfma_f32_16x16x32_bf16 v[84:87], a[164:167], v[148:151], v[84:87]
  v_mfma_f32_16x16x32_bf16 v[88:91], a[168:171], v[144:147], v[88:91]
  v_mfma_f32_16x16x32_bf16 v[92:95], a[168:171], v[148:151], v[92:95]
  v_mfma_f32_16x16x32_bf16 v[96:99], a[172:175], v[144:147], v[96:99]
  v_mfma_f32_16x16x32_bf16 v[100:103], a[172:175], v[148:151], v[100:103]
  s_waitcnt vmcnt(15)
  v_swap_b32 v154, v156
  v_swap_b32 v155, v157
  v_mfma_f32_16x16x32_bf16 v[104:107], a[176:179], v[144:147], v[104:107]
  v_mfma_f32_16x16x32_bf16 v[108:111], a[176:179], v[148:151], v[108:111]
  v_mfma_f32_16x16x32_bf16 v[72:75], a[180:183], v[152:155], v[72:75]
  v_mfma_f32_16x16x32_bf16 v[76:79], a[180:183], v[156:159], v[76:79]
  v_mfma_f32_16x16x32_bf16 v[80:83], a[184:187], v[152:155], v[80:83]
  v_mfma_f32_16x16x32_bf16 v[84:87], a[184:187], v[156:159], v[84:87]
  v_mfma_f32_16x16x32_bf16 v[88:91], a[188:191], v[152:155], v[88:91]
  v_mfma_f32_16x16x32_bf16 v[92:95], a[188:191], v[156:159], v[92:95]
  v_mfma_f32_16x16x32_bf16 v[96:99], a[192:195], v[152:155], v[96:99]
  v_mfma_f32_16x16x32_bf16 v[100:103], a[192:195], v[156:159], v[100:103]
  s_waitcnt vmcnt(13)
  v_swap_b32 v178, v180
  v_swap_b32 v179, v181
  v_mfma_f32_16x16x32_bf16 v[104:107], a[196:199], v[152:155], v[104:107]
  v_mfma_f32_16x16x32_bf16 v[108:111], a[196:199], v[156:159], v[108:111]
  v_mfma_f32_16x16x32_bf16 v[72:75], a[200:203], v[176:179], v[72:75]
  s_lshl_b32 s80, s30, 3
  s_add_u32 s80, s80, s100
  v_mfma_f32_16x16x32_bf16 v[76:79], a[200:203], v[180:183], v[76:79]
  s_lshl_b32 s80, s80, 2
  s_add_u32 s80, s80, s32
  v_mfma_f32_16x16x32_bf16 v[80:83], a[204:207], v[176:179], v[80:83]
  s_lshl_b32 s80, s80, 7
  s_add_u32 s80, s80, 98304
  s_waitcnt vmcnt(0)
  v_mfma_f32_16x16x32_bf16 v[84:87], a[204:207], v[180:183], v[84:87]
  v_or_b32 v230, s80, v206
  v_mov_b32 v231, 1
  v_mfma_f32_16x16x32_bf16 v[88:91], a[208:211], v[176:179], v[88:91]
  buffer_atomic_add v231, v230, s[36:39], 0 offen sc1
  v_mfma_f32_16x16x32_bf16 v[92:95], a[208:211], v[180:183], v[92:95]
  v_mfma_f32_16x16x32_bf16 v[96:99], a[212:215], v[176:179], v[96:99]
  v_mfma_f32_16x16x32_bf16 v[100:103], a[212:215], v[180:183], v[100:103]
  v_swap_b32 v186, v188
  v_swap_b32 v187, v189
  v_mfma_f32_16x16x32_bf16 v[104:107], a[216:219], v[176:179], v[104:107]
  v_mfma_f32_16x16x32_bf16 v[108:111], a[216:219], v[180:183], v[108:111]
  v_mfma_f32_16x16x32_bf16 v[72:75], a[220:223], v[184:187], v[72:75]
  v_mfma_f32_16x16x32_bf16 v[76:79], a[220:223], v[188:191], v[76:79]
  v_mfma_f32_16x16x32_bf16 v[80:83], a[224:227], v[184:187], v[80:83]
  v_mfma_f32_16x16x32_bf16 v[84:87], a[224:227], v[188:191], v[84:87]
  v_mfma_f32_16x16x32_bf16 v[88:91], a[228:231], v[184:187], v[88:91]
  v_mfma_f32_16x16x32_bf16 v[92:95], a[228:231], v[188:191], v[92:95]
  v_mfma_f32_16x16x32_bf16 v[96:99], a[232:235], v[184:187], v[96:99]
  v_mfma_f32_16x16x32_bf16 v[100:103], a[232:235], v[188:191], v[100:103]
  v_swap_b32 v194, v196
  v_swap_b32 v195, v197
  v_mfma_f32_16x16x32_bf16 v[104:107], a[236:239], v[184:187], v[104:107]
  v_mfma_f32_16x16x32_bf16 v[108:111], a[236:239], v[188:191], v[108:111]
  v_mfma_f32_16x16x32_bf16 v[72:75], a[240:243], v[192:195], v[72:75]
  v_mfma_f32_16x16x32_bf16 v[76:79], a[240:243], v[196:199], v[76:79]
  v_mfma_f32_16x16x32_bf16 v[80:83], a[244:247], v[192:195], v[80:83]
  v_mfma_f32_16x16x32_bf16 v[84:87], a[244:247], v[196:199], v[84:87]
  v_mfma_f32_16x16x32_bf16 v[88:91], a[248:251], v[192:195], v[88:91]
  v_mfma_f32_16x16x32_bf16 v[92:95], a[248:251], v[196:199], v[92:95]
  v_mfma_f32_16x16x32_bf16 v[96:99], a[252:255], v[192:195], v[96:99]
  v_mfma_f32_16x16x32_bf16 v[100:103], a[252:255], v[196:199], v[100:103]
  v_swap_b32 v162, v164
  v_swap_b32 v163, v165
  v_mfma_f32_16x16x32_bf16 v[104:107], v[232:235], v[192:195], v[104:107]
  v_mfma_f32_16x16x32_bf16 v[108:111], v[232:235], v[196:199], v[108:111]
  v_mfma_f32_16x16x32_bf16 v[72:75], v[236:239], v[160:163], v[72:75]
  v_mfma_f32_16x16x32_bf16 v[76:79], v[236:239], v[164:167], v[76:79]
  v_mfma_f32_16x16x32_bf16 v[80:83], v[240:243], v[160:163], v[80:83]
  v_mfma_f32_16x16x32_bf16 v[84:87], v[240:243], v[164:167], v[84:87]
  v_mfma_f32_16x16x32_bf16 v[88:91], v[244:247], v[160:163], v[88:91]
  v_mfma_f32_16x16x32_bf16 v[92:95], v[244:247], v[164:167], v[92:95]
  v_mfma_f32_16x16x32_bf16 v[96:99], v[248:251], v[160:163], v[96:99]
  v_mfma_f32_16x16x32_bf16 v[100:103], v[248:251], v[164:167], v[100:103]
  v_mfma_f32_16x16x32_bf16 v[104:107], v[252:255], v[160:163], v[104:107]
  v_mfma_f32_16x16x32_bf16 v[108:111], v[252:255], v[164:167], v[108:111]
  s_lshl_b32 s80, s32, 12
  v_add_u32 v216, s80, v14
  v_xor_b32 v217, 0x2000, v216
  ds_write_b128 v216, v[88:91] offset:0
  ds_write_b128 v216, v[92:95] offset:1024
  ds_write_b128 v216, v[96:99] offset:2048
  ds_write_b128 v216, v[100:103] offset:3072
  v_xor_b32 v218, 0x3000, v216
  v_lshrrev_b32 v219, 4, v1
  v_xor_b32 v219, 2, v219
  v_and_b32 v220, 0xf0, v14
  v_lshl_add_u32 v219, v219, 12, v220
  s_lshl_b32 s80, s32, 8
  v_add_u32 v219, s80, v219
  s_waitcnt lgkmcnt(0)
  s_barrier
  ds_read_b128 v[40:43], v217 offset:2048
  ds_read_b128 v[44:47], v217 offset:3072
  ds_read_b128 v[32:35], v217 offset:0
  ds_read_b128 v[36:39], v217 offset:1024
  s_waitcnt lgkmcnt(3)
  v_pk_add_f32 v[80:81], v[80:81], v[40:41]
  v_pk_add_f32 v[82:83], v[82:83], v[42:43]
  s_waitcnt lgkmcnt(2)
  v_pk_add_f32 v[84:85], v[84:85], v[44:45]
  v_pk_add_f32 v[86:87], v[86:87], v[46:47]
  s_waitcnt lgkmcnt(0)
  ds_write_b128 v217, v[80:83] offset:0
  ds_write_b128 v217, v[84:87] offset:1024
  ds_write_b128 v217, v[104:107] offset:2048
  ds_write_b128 v217, v[108:111] offset:3072
  v_pk_add_f32 v[72:73], v[72:73], v[32:33]
  v_pk_add_f32 v[74:75], v[74:75], v[34:35]
  v_pk_add_f32 v[76:77], v[76:77], v[36:37]
  v_pk_add_f32 v[78:79], v[78:79], v[38:39]
  v_lshlrev_b32 v212, 16, v112
  v_and_b32 v213, 0xffff0000, v112
  v_pk_add_f32 v[72:73], v[72:73], v[212:213]
  v_lshlrev_b32 v214, 16, v113
  v_and_b32 v215, 0xffff0000, v113
  v_pk_add_f32 v[74:75], v[74:75], v[214:215]
  v_lshlrev_b32 v212, 16, v114
  v_and_b32 v213, 0xffff0000, v114
  v_pk_add_f32 v[76:77], v[76:77], v[212:213]
  v_lshlrev_b32 v214, 16, v115
  v_and_b32 v215, 0xffff0000, v115
  v_pk_add_f32 v[78:79], v[78:79], v[214:215]
  s_waitcnt lgkmcnt(0)
  s_barrier
  ds_read_b128 v[40:43], v219 offset:2048
  ds_read_b128 v[44:47], v219 offset:3072
  ds_read_b128 v[32:35], v218 offset:0
  ds_read_b128 v[36:39], v218 offset:1024
  v_lshlrev_b32 v80, 16, v116
  v_and_b32 v81, 0xffff0000, v116
  s_waitcnt lgkmcnt(2)
  v_permlane32_swap_b32 v40, v44
  v_permlane32_swap_b32 v41, v45
  v_permlane32_swap_b32 v42, v46
  v_permlane32_swap_b32 v43, v47
  v_pk_add_f32 v[40:41], v[40:41], v[44:45]
  v_pk_add_f32 v[42:43], v[42:43], v[46:47]
  s_waitcnt lgkmcnt(1)
  v_pk_add_f32 v[72:73], v[72:73], v[32:33]
  v_pk_add_f32 v[74:75], v[74:75], v[34:35]
  s_waitcnt lgkmcnt(0)
  v_pk_add_f32 v[76:77], v[76:77], v[36:37]
  v_pk_add_f32 v[78:79], v[78:79], v[38:39]
  v_permlane16_swap_b32 v40, v42
  v_permlane16_swap_b32 v41, v43
  v_pk_add_f32 v[80:81], v[80:81], v[40:41]
  v_pk_add_f32 v[80:81], v[80:81], v[42:43]
  s_lshl_b32 s80, s90, 3
  s_add_u32 s80, s80, s32
  s_lshl_b32 s80, s80, 9
  s_add_u32 s80, s80, 98304
  v_and_b32 v230, 0x80000180, v11
  v_add_u32 v230, s80, v230
  buffer_load_dword v231, v230, s[36:39], 0 offen sc1
  v_add_f32 v216, v72, v73
  v_mul_f32 v217, v72, v72
  v_add_f32 v218, v76, v77
  v_mul_f32 v219, v76, v76
  v_fmac_f32 v217, v73, v73
  v_fmac_f32 v219, v77, v77
  v_add_f32 v216, v216, v74
  v_fmac_f32 v217, v74, v74
  v_add_f32 v218, v218, v78
  v_fmac_f32 v219, v78, v78
  v_add_f32 v216, v216, v75
  v_fmac_f32 v217, v75, v75
  v_add_f32 v218, v218, v79
  v_fmac_f32 v219, v79, v79
  v_and_b32 v220, 0xf0, v14
  v_lshrrev_b32 v221, 4, v1
  v_permlane32_swap_b32 v216, v218
  v_permlane32_swap_b32 v217, v219
  v_add_f32 v216, v216, v218
  v_add_f32 v217, v217, v219
  v_add_f32 v216, v216, v80
  v_fmac_f32 v217, v80, v80
  v_add_f32 v216, v216, v81
  v_fmac_f32 v217, v81, v81
  v_lshl_add_u32 v220, v221, 2, v220
  s_lshl_b32 s80, s32, 8
  v_add_u32 v220, s80, v220
  v_permlane16_swap_b32 v216, v217
  v_add_f32 v216, v216, v217
  ds_write_b32 v220, v216 offset:16384
  v_lshlrev_b32 v220, 2, v1
  s_lshl_b32 s80, s30, 14
  s_lshl_b32 s81, s31, 8
  s_add_u32 s80, s80, s81
  s_add_u32 s80, s80, 0x2a82000
  s_cmp_eq_u32 s32, 0
  s_cselect_b32 s80, s80, 0x80000000
  v_add_u32 v221, s80, v220
  s_waitcnt lgkmcnt(0)
  s_barrier
  ds_read_b32 v216, v220 offset:16384
  ds_read_b32 v217, v220 offset:16640
  ds_read_b32 v218, v220 offset:16896
  ds_read_b32 v219, v220 offset:17152
  s_waitcnt lgkmcnt(2)
  v_add_f32 v216, v216, v217
  s_waitcnt lgkmcnt(0)
  v_add_f32 v218, v218, v219
  v_add_f32 v216, v216, v218
  v_or_b32 v216, 1, v216
  buffer_store_dword v216, v221, s[36:39], 0 offen sc1
  s_add_u32 s40, s28, 0x1800000
  s_addc_u32 s41, s29, 0
  s_waitcnt vmcnt(1)
  v_cmp_gt_u32 vcc, 8, v231
  s_nop 0
  s_and_b32 vcc_lo, vcc_lo, 0xf
  s_cbranch_scc1 L_cp_25
L_cpb_26:
  buffer_load_dwordx4 v[168:171], v2, s[40:43], s60 offen sc1
  buffer_load_dwordx4 v[172:175], v2, s[40:43], s60 offen offset:1024 sc1
  buffer_load_dwordx4 v[128:131], v2, s[40:43], s61 offen sc1
  buffer_load_dwordx4 v[132:135], v2, s[40:43], s61 offen offset:1024 sc1
  buffer_load_dwordx4 v[136:139], v2, s[40:43], s62 offen sc1
  buffer_load_dwordx4 v[140:143], v2, s[40:43], s62 offen offset:1024 sc1
  buffer_load_dwordx4 v[144:147], v2, s[40:43], s63 offen sc1
  buffer_load_dwordx4 v[148:151], v2, s[40:43], s63 offen offset:1024 sc1
  buffer_load_dwordx4 v[152:155], v2, s[40:43], s64 offen sc1
  buffer_load_dwordx4 v[156:159], v2, s[40:43], s64 offen offset:1024 sc1
  ds_read_b128 v[176:179], v6 offset:50176
  ds_read_b128 v[180:183], v6 offset:51200
  ds_read_b128 v[184:187], v6 offset:52224
  ds_read_b128 v[188:191], v6 offset:53248
  ds_read_b128 v[192:195], v6 offset:54272
  s_waitcnt vmcnt(8)
  v_swap_b32 v170, v172
  v_swap_b32 v171, v173
  s_waitcnt lgkmcnt(4)
  s_nop 0
  v_mfma_f32_16x16x32_bf16 v[16:19], v[176:179], v[168:171], 0
  ds_read_b128 v[196:199], v6 offset:55296
  buffer_load_dwordx4 v[216:219], v13, s[36:39], s61 offen offset:0 sc1
  v_mfma_f32_16x16x32_bf16 v[20:23], v[176:179], v[172:175], 0
  buffer_load_dwordx4 v[160:163], v2, s[40:43], s65 offen sc1
  buffer_load_dwordx4 v[164:167], v2, s[40:43], s65 offen offset:1024 sc1
  s_waitcnt lgkmcnt(4)
  v_mfma_f32_16x16x32_bf16 v[24:27], v[180:183], v[168:171], 0
  ds_read_b128 v[176:179], v6 offset:56320
  buffer_load_dwordx4 v[220:223], v13, s[36:39], s61 offen offset:256 sc1
  v_mfma_f32_16x16x32_bf16 v[28:31], v[180:183], v[172:175], 0
  s_waitcnt lgkmcnt(4)
  v_mfma_f32_16x16x32_bf16 v[32:35], v[184:187], v[168:171], 0
  ds_read_b128 v[180:183], v6 offset:57344
  v_mfma_f32_16x16x32_bf16 v[36:39], v[184:187], v[172:175], 0
  s_waitcnt lgkmcnt(4)
  v_mfma_f32_16x16x32_bf16 v[40:43], v[188:191], v[168:171], 0
  ds_read_b128 v[184:187], v6 offset:58368
  v_mfma_f32_16x16x32_bf16 v[44:47], v[188:191], v[172:175], 0
  s_waitcnt lgkmcnt(4)
  v_mfma_f32_16x16x32_bf16 v[48:51], v[192:195], v[168:171], 0
  ds_read_b128 v[188:191], v6 offset:59392
  v_mfma_f32_16x16x32_bf16 v[52:55], v[192:195], v[172:175], 0
  s_waitcnt vmcnt(10)
  v_swap_b32 v130, v132
  v_swap_b32 v131, v133
  s_waitcnt lgkmcnt(4)
  v_mfma_f32_16x16x32_bf16 v[56:59], v[196:199], v[168:171], 0
  ds_read_b128 v[192:195], v6 offset:60416
  v_mfma_f32_16x16x32_bf16 v[60:63], v[196:199], v[172:175], 0
  s_waitcnt lgkmcnt(4)
  v_mfma_f32_16x16x32_bf16 v[64:67], v[176:179], v[168:171], 0
  ds_read_b128 v[196:199], v6 offset:61440
  v_mfma_f32_16x16x32_bf16 v[68:71], v[176:179], v[172:175], 0
  s_waitcnt lgkmcnt(4)
  v_mfma_f32_16x16x32_bf16 v[16:19], v[180:183], v[128:131], v[16:19]
  ds_read_b128 v[176:179], v6 offset:62464
  v_mfma_f32_16x16x32_bf16 v[20:23], v[180:183], v[132:135], v[20:23]
  buffer_load_dwordx4 v[168:171], v2, s[40:43], s66 offen sc1
  buffer_load_dwordx4 v[172:175], v2, s[40:43], s66 offen offset:1024 sc1
  s_waitcnt lgkmcnt(4)
  v_mfma_f32_16x16x32_bf16 v[24:27], v[184:187], v[128:131], v[24:27]
  ds_read_b128 v[180:183], v6 offset:63488
  v_mfma_f32_16x16x32_bf16 v[28:31], v[184:187], v[132:135], v[28:31]
  s_waitcnt lgkmcnt(4)
  v_mfma_f32_16x16x32_bf16 v[32:35], v[188:191], v[128:131], v[32:35]
  ds_read_b128 v[184:187], v7 offset:0
  v_mfma_f32_16x16x32_bf16 v[36:39], v[188:191], v[132:135], v[36:39]
  s_waitcnt lgkmcnt(4)
  v_mfma_f32_16x16x32_bf16 v[40:43], v[192:195], v[128:131], v[40:43]
  ds_read_b128 v[188:191], v7 offset:1024
  v_mfma_f32_16x16x32_bf16 v[44:47], v[192:195], v[132:135], v[44:47]
  s_waitcnt lgkmcnt(4)
  v_mfma_f32_16x16x32_bf16 v[48:51], v[196:199], v[128:131], v[48:51]
  ds_read_b128 v[192:195], v7 offset:2048
  v_mfma_f32_16x16x32_bf16 v[52:55], v[196:199], v[132:135], v[52:55]
  s_waitcnt vmcnt(10)
  v_swap_b32 v138, v140
  v_swap_b32 v139, v141
  s_waitcnt lgkmcnt(4)
  v_mfma_f32_16x16x32_bf16 v[56:59], v[176:179], v[128:131], v[56:59]
  ds_read_b128 v[196:199], v7 offset:3072
  v_mfma_f32_16x16x32_bf16 v[60:63], v[176:179], v[132:135], v[60:63]
  s_waitcnt vmcnt(5)
  v_bitop3_b32 v224, v216, v217, v218 bitop3:0x80
  s_waitcnt vmcnt(2)
  v_bitop3_b32 v225, v219, v220, v221 bitop3:0x80
  v_bitop3_b32 v224, v224, v222, v223 bitop3:0x80
  s_waitcnt lgkmcnt(4)
  v_mfma_f32_16x16x32_bf16 v[64:67], v[180:183], v[128:131], v[64:67]
  ds_read_b128 v[176:179], v7 offset:4096
  v_bitop3_b32 v224, v224, v225, 1 bitop3:0x80
  v_cmp_eq_u32 vcc, 0, v224
  v_mfma_f32_16x16x32_bf16 v[68:71], v[180:183], v[132:135], v[68:71]
  s_cbranch_vccnz L_tp_27
L_tpb_28:
  v_add_f32 v216, v216, v220
  v_add_f32 v217, v217, v221
  s_waitcnt lgkmcnt(4)
  v_mfma_f32_16x16x32_bf16 v[16:19], v[184:187], v[136:139], v[16:19]
  ds_read_b128 v[180:183], v7 offset:5120
  v_add_f32 v218, v218, v222
  v_add_f32 v219, v219, v223
  v_mfma_f32_16x16x32_bf16 v[20:23], v[184:187], v[140:143], v[20:23]
  buffer_load_dwordx4 v[128:131], v2, s[40:43], s67 offen sc1
  buffer_load_dwordx4 v[132:135], v2, s[40:43], s67 offen offset:1024 sc1
  v_permlane32_swap_b32 v216, v218
  s_waitcnt lgkmcnt(4)
  v_mfma_f32_16x16x32_bf16 v[24:27], v[188:191], v[136:139], v[24:27]
  ds_read_b128 v[184:187], v7 offset:6144
  v_permlane32_swap_b32 v217, v219
  v_add_f32 v216, v216, v218
  v_mfma_f32_16x16x32_bf16 v[28:31], v[188:191], v[140:143], v[28:31]
  v_add_f32 v217, v217, v219
  s_nop 1
  v_permlane16_swap_b32 v216, v217
  v_add_f32 v216, v216, v217
  s_waitcnt lgkmcnt(4)
  v_mfma_f32_16x16x32_bf16 v[32:35], v[192:195], v[136:139], v[32:35]
  ds_read_b128 v[188:191], v7 offset:7168
  v_mov_b32 v217, v216
  s_nop 1
  v_permlane16_swap_b32 v216, v217
  v_mfma_f32_16x16x32_bf16 v[36:39], v[192:195], v[140:143], v[36:39]
  v_mov_b32 v218, v216
  v_mov_b32 v219, v217
  s_nop 0
  v_permlane32_swap_b32 v216, v218
  s_waitcnt lgkmcnt(4)
  v_mfma_f32_16x16x32_bf16 v[40:43], v[196:199], v[136:139], v[40:43]
  ds_read_b128 v[192:195], v7 offset:8192
  v_permlane32_swap_b32 v217, v219
  v_mul_f32 v216, 0x3acccccd, v216
  v_mfma_f32_16x16x32_bf16 v[44:47], v[196:199], v[140:143], v[44:47]
  v_mul_f32 v217, 0x3acccccd, v217
  v_mul_f32 v218, 0x3acccccd, v218
  v_mul_f32 v219, 0x3acccccd, v219
  s_waitcnt lgkmcnt(4)
  v_mfma_f32_16x16x32_bf16 v[48:51], v[176:179], v[136:139], v[48:51]
  ds_read_b128 v[196:199], v7 offset:9216
  v_fma_f32 v217, -v216, v216, v217
  v_fma_f32 v219, -v218, v218, v219
  v_mfma_f32_16x16x32_bf16 v[52:55], v[176:179], v[140:143], v[52:55]
  v_swap_b32 v146, v148
  v_swap_b32 v147, v149
  v_max_f32 v217, 0, v217
  s_waitcnt lgkmcnt(4)
  v_mfma_f32_16x16x32_bf16 v[56:59], v[180:183], v[136:139], v[56:59]
  ds_read_b128 v[176:179], v7 offset:10240
  v_max_f32 v219, 0, v219
  v_add_f32 v217, 0x3727c5ac, v217
  v_mfma_f32_16x16x32_bf16 v[60:63], v[180:183], v[140:143], v[60:63]
  v_add_f32 v219, 0x3727c5ac, v219
  v_rsq_f32 v217, v217
  s_waitcnt lgkmcnt(4)
  v_mfma_f32_16x16x32_bf16 v[64:67], v[184:187], v[136:139], v[64:67]
  ds_read_b128 v[180:183], v7 offset:11264
  v_rsq_f32 v219, v219
  v_mfma_f32_16x16x32_bf16 v[68:71], v[184:187], v[140:143], v[68:71]
  s_mov_b32 vcc_lo, 0
  s_mov_b32 vcc_hi, -1
  v_mul_f32 v216, v216, v217
  s_waitcnt lgkmcnt(4)
  v_mfma_f32_16x16x32_bf16 v[16:19], v[188:191], v[144:147], v[16:19]
  ds_read_b128 v[184:187], v7 offset:12288
  v_mul_f32 v218, v218, v219
  v_cndmask_b32 v221, v217, v219, vcc
  v_mfma_f32_16x16x32_bf16 v[20:23], v[188:191], v[148:151], v[20:23]
  buffer_load_dwordx4 v[136:139], v2, s[40:43], s68 offen sc1
  buffer_load_dwordx4 v[140:143], v2, s[40:43], s68 offen offset:1024 sc1
  v_cndmask_b32 v220, v216, v218, vcc
  s_waitcnt lgkmcnt(4)
  v_mfma_f32_16x16x32_bf16 v[24:27], v[192:195], v[144:147], v[24:27]
  ds_read_b128 v[188:191], v7 offset:13312
  v_lshlrev_b32 v222, 16, v120
  v_and_b32 v223, 0xffff0000, v120
  v_mfma_f32_16x16x32_bf16 v[28:31], v[192:195], v[148:151], v[28:31]
  v_fma_f32 v224, v72, v217, -v216
  v_fma_f32 v225, v73, v217, -v216
  v_fmac_f32 v72, v224, v222
  s_waitcnt lgkmcnt(4)
  v_mfma_f32_16x16x32_bf16 v[32:35], v[196:199], v[144:147], v[32:35]
  ds_read_b128 v[192:195], v5 offset:0
  v_fmac_f32 v73, v225, v223
  v_cvt_pk_bf16_f32 v120, v72, v73
  v_mfma_f32_16x16x32_bf16 v[36:39], v[196:199], v[148:151], v[36:39]
  v_lshlrev_b32 v222, 16, v121
  v_and_b32 v223, 0xffff0000, v121
  v_fma_f32 v224, v74, v217, -v216
  s_waitcnt lgkmcnt(4)
  v_mfma_f32_16x16x32_bf16 v[40:43], v[176:179], v[144:147], v[40:43]
  ds_read_b128 v[196:199], v5 offset:1024
  v_fma_f32 v225, v75, v217, -v216
  v_fmac_f32 v74, v224, v222
  v_mfma_f32_16x16x32_bf16 v[44:47], v[176:179], v[148:151], v[44:47]
  v_fmac_f32 v75, v225, v223
  v_cvt_pk_bf16_f32 v121, v74, v75
  v_lshlrev_b32 v222, 16, v122
  s_waitcnt lgkmcnt(4)
  v_mfma_f32_16x16x32_bf16 v[48:51], v[180:183], v[144:147], v[48:51]
  ds_read_b128 v[176:179], v5 offset:2048
  v_and_b32 v223, 0xffff0000, v122
  v_fma_f32 v224, v76, v219, -v218
  v_mfma_f32_16x16x32_bf16 v[52:55], v[180:183], v[148:151], v[52:55]
  v_swap_b32 v154, v156
  v_swap_b32 v155, v157
  v_fma_f32 v225, v77, v219, -v218
  s_waitcnt lgkmcnt(4)
  v_mfma_f32_16x16x32_bf16 v[56:59], v[184:187], v[144:147], v[56:59]
  ds_read_b128 v[180:183], v5 offset:3072
  v_fmac_f32 v76, v224, v222
  v_fmac_f32 v77, v225, v223
  v_mfma_f32_16x16x32_bf16 v[60:63], v[184:187], v[148:151], v[60:63]
  v_cvt_pk_bf16_f32 v122, v76, v77
  v_lshlrev_b32 v222, 16, v123
  v_and_b32 v223, 0xffff0000, v123
  s_waitcnt lgkmcnt(4)
  v_mfma_f32_16x16x32_bf16 v[64:67], v[188:191], v[144:147], v[64:67]
  ds_read_b128 v[184:187], v5 offset:4096
  v_fma_f32 v224, v78, v219, -v218
  v_fma_f32 v225, v79, v219, -v218
  v_mfma_f32_16x16x32_bf16 v[68:71], v[188:191], v[148:151], v[68:71]
  v_fmac_f32 v78, v224, v222
  v_fmac_f32 v79, v225, v223
  v_cvt_pk_bf16_f32 v123, v78, v79
  s_waitcnt lgkmcnt(4)
  v_mfma_f32_16x16x32_bf16 v[16:19], v[192:195], v[152:155], v[16:19]
  ds_read_b128 v[188:191], v5 offset:5120
  v_lshlrev_b32 v222, 16, v124
  v_and_b32 v223, 0xffff0000, v124
  v_mfma_f32_16x16x32_bf16 v[20:23], v[192:195], v[156:159], v[20:23]
  buffer_load_dwordx4 v[144:147], v2, s[40:43], s69 offen sc1
  buffer_load_dwordx4 v[148:151], v2, s[40:43], s69 offen offset:1024 sc1
  v_fma_f32 v224, v80, v221, -v220
  s_waitcnt lgkmcnt(4)
  v_mfma_f32_16x16x32_bf16 v[24:27], v[196:199], v[152:155], v[24:27]
  ds_read_b128 v[192:195], v5 offset:6144
  v_fma_f32 v225, v81, v221, -v220
  v_fmac_f32 v80, v224, v222
  v_mfma_f32_16x16x32_bf16 v[28:31], v[196:199], v[156:159], v[28:31]
  v_fmac_f32 v81, v225, v223
  v_cvt_pk_bf16_f32 v124, v80, v81
  s_mov_b32 s80, 0x1828000
  s_waitcnt lgkmcnt(4)
  v_mfma_f32_16x16x32_bf16 v[32:35], v[176:179], v[152:155], v[32:35]
  ds_read_b128 v[196:199], v5 offset:7168
  buffer_store_dwordx4 v[120:123], v10, s[36:39], s80 offen sc1
  buffer_store_dword v124, v4, s[36:39], s80 offen sc1
  v_mfma_f32_16x16x32_bf16 v[36:39], v[176:179], v[156:159], v[36:39]
  v_add_f32 v216, v72, v73
  v_mul_f32 v217, v72, v72
  v_add_f32 v218, v76, v77
  s_waitcnt lgkmcnt(4)
  v_mfma_f32_16x16x32_bf16 v[40:43], v[180:183], v[152:155], v[40:43]
  ds_read_b128 v[176:179], v5 offset:8192
  v_mul_f32 v219, v76, v76
  v_fmac_f32 v217, v73, v73
  v_mfma_f32_16x16x32_bf16 v[44:47], v[180:183], v[156:159], v[44:47]
  v_fmac_f32 v219, v77, v77
  v_add_f32 v216, v216, v74
  v_fmac_f32 v217, v74, v74
  s_waitcnt lgkmcnt(4)
  v_mfma_f32_16x16x32_bf16 v[48:51], v[184:187], v[152:155], v[48:51]
  ds_read_b128 v[180:183], v5 offset:9216
  v_add_f32 v218, v218, v78
  v_fmac_f32 v219, v78, v78
  v_mfma_f32_16x16x32_bf16 v[52:55], v[184:187], v[156:159], v[52:55]
  v_swap_b32 v162, v164
  v_swap_b32 v163, v165
  v_add_f32 v216, v216, v75
  s_waitcnt lgkmcnt(4)
  v_mfma_f32_16x16x32_bf16 v[56:59], v[188:191], v[152:155], v[56:59]
  ds_read_b128 v[184:187], v5 offset:10240
  v_fmac_f32 v217, v75, v75
  v_add_f32 v218, v218, v79
  v_mfma_f32_16x16x32_bf16 v[60:63], v[188:191], v[156:159], v[60:63]
  v_fmac_f32 v219, v79, v79
  v_and_b32 v220, 0xf0, v14
  v_lshrrev_b32 v221, 4, v1
  s_waitcnt lgkmcnt(4)
  v_mfma_f32_16x16x32_bf16 v[64:67], v[192:195], v[152:155], v[64:67]
  ds_read_b128 v[188:191], v5 offset:11264
  v_permlane32_swap_b32 v216, v218
  v_permlane32_swap_b32 v217, v219
  v_mfma_f32_16x16x32_bf16 v[68:71], v[192:195], v[156:159], v[68:71]
  v_add_f32 v216, v216, v218
  v_add_f32 v217, v217, v219
  v_add_f32 v216, v216, v80
  s_waitcnt lgkmcnt(4)
  v_mfma_f32_16x16x32_bf16 v[16:19], v[196:199], v[160:163], v[16:19]
  ds_read_b128 v[192:195], v5 offset:12288
  v_fmac_f32 v217, v80, v80
  v_add_f32 v216, v216, v81
  v_mfma_f32_16x16x32_bf16 v[20:23], v[196:199], v[164:167], v[20:23]
  buffer_load_dwordx4 v[152:155], v2, s[40:43], s70 offen sc1
  buffer_load_dwordx4 v[156:159], v2, s[40:43], s70 offen offset:1024 sc1
  v_fmac_f32 v217, v81, v81
  s_waitcnt lgkmcnt(4)
  v_mfma_f32_16x16x32_bf16 v[24:27], v[176:179], v[160:163], v[24:27]
  ds_read_b128 v[196:199], v5 offset:13312
  v_lshl_add_u32 v220, v221, 2, v220
  s_lshl_b32 s80, s32, 8
  v_mfma_f32_16x16x32_bf16 v[28:31], v[176:179], v[164:167], v[28:31]
  v_add_u32 v220, s80, v220
  v_permlane16_swap_b32 v216, v217
  v_add_f32 v216, v216, v217
  s_waitcnt lgkmcnt(4)
  v_mfma_f32_16x16x32_bf16 v[32:35], v[180:183], v[160:163], v[32:35]
  ds_read_b128 v[176:179], v5 offset:14336
  ds_write_b32 v220, v216 offset:17408
  v_lshlrev_b32 v220, 2, v1
  v_mfma_f32_16x16x32_bf16 v[36:39], v[180:183], v[164:167], v[36:39]
  s_lshl_b32 s80, s30, 14
  s_lshl_b32 s81, s31, 8
  s_add_u32 s80, s80, s81
  s_waitcnt lgkmcnt(5)
  v_mfma_f32_16x16x32_bf16 v[40:43], v[184:187], v[160:163], v[40:43]
  ds_read_b128 v[180:183], v5 offset:15360
  s_add_u32 s80, s80, 0x2b02000
  s_cmp_eq_u32 s32, 0
  v_mfma_f32_16x16x32_bf16 v[44:47], v[184:187], v[164:167], v[44:47]
  s_cselect_b32 s80, s80, 0x80000000
  v_add_u32 v221, s80, v220
  s_waitcnt lgkmcnt(0)
  s_barrier
  v_mfma_f32_16x16x32_bf16 v[48:51], v[188:191], v[160:163], v[48:51]
  ds_read_b128 v[184:187], v5 offset:16384
  ds_read_b32 v216, v220 offset:17408
  ds_read_b32 v217, v220 offset:17664
  v_mfma_f32_16x16x32_bf16 v[52:55], v[188:191], v[164:167], v[52:55]
  s_waitcnt vmcnt(10)
  v_swap_b32 v170, v172
  v_swap_b32 v171, v173
  ds_read_b32 v218, v220 offset:17920
  v_mfma_f32_16x16x32_bf16 v[56:59], v[192:195], v[160:163], v[56:59]
  ds_read_b128 v[188:191], v5 offset:17408
  ds_read_b32 v219, v220 offset:18176
  s_waitcnt lgkmcnt(3)
  v_add_f32 v216, v216, v217
  v_mfma_f32_16x16x32_bf16 v[60:63], v[192:195], v[164:167], v[60:63]
  s_waitcnt lgkmcnt(0)
  v_add_f32 v218, v218, v219
  v_add_f32 v216, v216, v218
  v_or_b32 v216, 1, v216
  v_mfma_f32_16x16x32_bf16 v[64:67], v[196:199], v[160:163], v[64:67]
  ds_read_b128 v[192:195], v5 offset:18432
  buffer_store_dword v216, v221, s[36:39], 0 offen sc1
  v_mfma_f32_16x16x32_bf16 v[68:71], v[196:199], v[164:167], v[68:71]
  v_mfma_f32_16x16x32_bf16 v[16:19], v[176:179], v[168:171], v[16:19]
  ds_read_b128 v[196:199], v5 offset:19456
  v_mfma_f32_16x16x32_bf16 v[20:23], v[176:179], v[172:175], v[20:23]
  buffer_load_dwordx4 v[160:163], v2, s[40:43], s71 offen sc1
  buffer_load_dwordx4 v[164:167], v2, s[40:43], s71 offen offset:1024 sc1
  v_mfma_f32_16x16x32_bf16 v[24:27], v[180:183], v[168:171], v[24:27]
  ds_read_b128 v[176:179], v5 offset:20480
  v_mfma_f32_16x16x32_bf16 v[28:31], v[180:183], v[172:175], v[28:31]
  v_mfma_f32_16x16x32_bf16 v[32:35], v[184:187], v[168:171], v[32:35]
  ds_read_b128 v[180:183], v5 offset:21504
  v_mfma_f32_16x16x32_bf16 v[36:39], v[184:187], v[172:175], v[36:39]
  v_mfma_f32_16x16x32_bf16 v[40:43], v[188:191], v[168:171], v[40:43]
  ds_read_b128 v[184:187], v5 offset:22528
  v_mfma_f32_16x16x32_bf16 v[44:47], v[188:191], v[172:175], v[44:47]
  s_waitcnt lgkmcnt(4)
  v_mfma_f32_16x16x32_bf16 v[48:51], v[192:195], v[168:171], v[48:51]
  ds_read_b128 v[188:191], v5 offset:23552
  v_mfma_f32_16x16x32_bf16 v[52:55], v[192:195], v[172:175], v[52:55]
  s_waitcnt vmcnt(11)
  v_swap_b32 v130, v132
  v_swap_b32 v131, v133
  s_waitcnt lgkmcnt(4)
  v_mfma_f32_16x16x32_bf16 v[56:59], v[196:199], v[168:171], v[56:59]
  ds_read_b128 v[192:195], v5 offset:24576
  v_mfma_f32_16x16x32_bf16 v[60:63], v[196:199], v[172:175], v[60:63]
  s_lshl_b32 s80, s30, 3
  s_add_u32 s80, s80, s100
  s_waitcnt lgkmcnt(4)
  v_mfma_f32_16x16x32_bf16 v[64:67], v[176:179], v[168:171], v[64:67]
  ds_read_b128 v[196:199], v5 offset:25600
  s_lshl_b32 s80, s80, 2
  v_mfma_f32_16x16x32_bf16 v[68:71], v[176:179], v[172:175], v[68:71]
  s_add_u32 s80, s80, s32
  s_lshl_b32 s80, s80, 7
  s_waitcnt lgkmcnt(4)
  v_mfma_f32_16x16x32_bf16 v[16:19], v[180:183], v[128:131], v[16:19]
  ds_read_b128 v[176:179], v5 offset:26624
  s_add_u32 s80, s80, 100352
  s_waitcnt vmcnt(2)
  v_mfma_f32_16x16x32_bf16 v[20:23], v[180:183], v[132:135], v[20:23]
  buffer_load_dwordx4 v[168:171], v2, s[40:43], s72 offen sc1
  buffer_load_dwordx4 v[172:175], v2, s[40:43], s72 offen offset:1024 sc1
  s_waitcnt lgkmcnt(4)
  v_mfma_f32_16x16x32_bf16 v[24:27], v[184:187], v[128:131], v[24:27]
  ds_read_b128 v[180:183], v5 offset:27648
  v_or_b32 v230, s80, v206
  v_mfma_f32_16x16x32_bf16 v[28:31], v[184:187], v[132:135], v[28:31]
  v_mov_b32 v231, 1
  buffer_atomic_add v231, v230, s[36:39], 0 offen sc1
  s_waitcnt lgkmcnt(4)
  v_mfma_f32_16x16x32_bf16 v[32:35], v[188:191], v[128:131], v[32:35]
  ds_read_b128 v[184:187], v5 offset:28672
  v_mfma_f32_16x16x32_bf16 v[36:39], v[188:191], v[132:135], v[36:39]
  s_waitcnt lgkmcnt(4)
  v_mfma_f32_16x16x32_bf16 v[40:43], v[192:195], v[128:131], v[40:43]
  ds_read_b128 v[188:191], v5 offset:29696
  v_mfma_f32_16x16x32_bf16 v[44:47], v[192:195], v[132:135], v[44:47]
  s_waitcnt lgkmcnt(4)
  v_mfma_f32_16x16x32_bf16 v[48:51], v[196:199], v[128:131], v[48:51]
  ds_read_b128 v[192:195], v5 offset:30720
  v_mfma_f32_16x16x32_bf16 v[52:55], v[196:199], v[132:135], v[52:55]
  v_swap_b32 v138, v140
  v_swap_b32 v139, v141
  s_waitcnt lgkmcnt(4)
  v_mfma_f32_16x16x32_bf16 v[56:59], v[176:179], v[128:131], v[56:59]
  ds_read_b128 v[196:199], v5 offset:31744
  v_mfma_f32_16x16x32_bf16 v[60:63], v[176:179], v[132:135], v[60:63]
  s_waitcnt lgkmcnt(4)
  v_mfma_f32_16x16x32_bf16 v[64:67], v[180:183], v[128:131], v[64:67]
  ds_read_b128 v[176:179], v5 offset:32768
  v_mfma_f32_16x16x32_bf16 v[68:71], v[180:183], v[132:135], v[68:71]
  s_waitcnt lgkmcnt(4)
  v_mfma_f32_16x16x32_bf16 v[16:19], v[184:187], v[136:139], v[16:19]
  ds_read_b128 v[180:183], v5 offset:33792
  v_mfma_f32_16x16x32_bf16 v[20:23], v[184:187], v[140:143], v[20:23]
  buffer_load_dwordx4 v[128:131], v2, s[40:43], s73 offen sc1
  buffer_load_dwordx4 v[132:135], v2, s[40:43], s73 offen offset:1024 sc1
  s_waitcnt lgkmcnt(4)
  v_mfma_f32_16x16x32_bf16 v[24:27], v[188:191], v[136:139], v[24:27]
  ds_read_b128 v[184:187], v5 offset:34816
  v_mfma_f32_16x16x32_bf16 v[28:31], v[188:191], v[140:143], v[28:31]
  s_waitcnt lgkmcnt(4)
  v_mfma_f32_16x16x32_bf16 v[32:35], v[192:195], v[136:139], v[32:35]
  ds_read_b128 v[188:191], v5 offset:35840
  v_mfma_f32_16x16x32_bf16 v[36:39], v[192:195], v[140:143], v[36:39]
  s_waitcnt lgkmcnt(4)
  v_mfma_f32_16x16x32_bf16 v[40:43], v[196:199], v[136:139], v[40:43]
  ds_read_b128 v[192:195], v5 offset:36864
  v_mfma_f32_16x16x32_bf16 v[44:47], v[196:199], v[140:143], v[44:47]
  s_waitcnt lgkmcnt(4)
  v_mfma_f32_16x16x32_bf16 v[48:51], v[176:179], v[136:139], v[48:51]
  ds_read_b128 v[196:199], v5 offset:37888
  v_mfma_f32_16x16x32_bf16 v[52:55], v[176:179], v[140:143], v[52:55]
  v_swap_b32 v146, v148
  v_swap_b32 v147, v149
  s_waitcnt lgkmcnt(4)
  v_mfma_f32_16x16x32_bf16 v[56:59], v[180:183], v[136:139], v[56:59]
  ds_read_b128 v[176:179], v5 offset:38912
  v_mfma_f32_16x16x32_bf16 v[60:63], v[180:183], v[140:143], v[60:63]
  s_waitcnt lgkmcnt(4)
  v_mfma_f32_16x16x32_bf16 v[64:67], v[184:187], v[136:139], v[64:67]
  ds_read_b128 v[180:183], v5 offset:39936
  v_mfma_f32_16x16x32_bf16 v[68:71], v[184:187], v[140:143], v[68:71]
  s_waitcnt lgkmcnt(4)
  v_mfma_f32_16x16x32_bf16 v[16:19], v[188:191], v[144:147], v[16:19]
  ds_read_b128 v[184:187], v5 offset:40960
  v_mfma_f32_16x16x32_bf16 v[20:23], v[188:191], v[148:151], v[20:23]
  buffer_load_dwordx4 v[136:139], v2, s[40:43], s74 offen sc1
  buffer_load_dwordx4 v[140:143], v2, s[40:43], s74 offen offset:1024 sc1
  s_waitcnt lgkmcnt(4)
  v_mfma_f32_16x16x32_bf16 v[24:27], v[192:195], v[144:147], v[24:27]
  ds_read_b128 v[188:191], v5 offset:41984
  v_mfma_f32_16x16x32_bf16 v[28:31], v[192:195], v[148:151], v[28:31]
  s_waitcnt lgkmcnt(4)
  v_mfma_f32_16x16x32_bf16 v[32:35], v[196:199], v[144:147], v[32:35]
  ds_read_b128 v[192:195], v5 offset:43008
  v_mfma_f32_16x16x32_bf16 v[36:39], v[196:199], v[148:151], v[36:39]
  s_waitcnt lgkmcnt(4)
  v_mfma_f32_16x16x32_bf16 v[40:43], v[176:179], v[144:147], v[40:43]
  ds_read_b128 v[196:199], v5 offset:44032
  v_mfma_f32_16x16x32_bf16 v[44:47], v[176:179], v[148:151], v[44:47]
  s_waitcnt lgkmcnt(4)
  v_mfma_f32_16x16x32_bf16 v[48:51], v[180:183], v[144:147], v[48:51]
  ds_read_b128 v[176:179], v5 offset:45056
  v_mfma_f32_16x16x32_bf16 v[52:55], v[180:183], v[148:151], v[52:55]
  v_swap_b32 v154, v156
  v_swap_b32 v155, v157
  s_waitcnt lgkmcnt(4)
  v_mfma_f32_16x16x32_bf16 v[56:59], v[184:187], v[144:147], v[56:59]
  ds_read_b128 v[180:183], v5 offset:46080
  v_mfma_f32_16x16x32_bf16 v[60:63], v[184:187], v[148:151], v[60:63]
  s_waitcnt lgkmcnt(4)
  v_mfma_f32_16x16x32_bf16 v[64:67], v[188:191], v[144:147], v[64:67]
  ds_read_b128 v[184:187], v5 offset:47104
  v_mfma_f32_16x16x32_bf16 v[68:71], v[188:191], v[148:151], v[68:71]
  s_waitcnt lgkmcnt(4)
  v_mfma_f32_16x16x32_bf16 v[16:19], v[192:195], v[152:155], v[16:19]
  ds_read_b128 v[188:191], v5 offset:48128
  v_mfma_f32_16x16x32_bf16 v[20:23], v[192:195], v[156:159], v[20:23]
  buffer_load_dwordx4 v[144:147], v2, s[40:43], s75 offen sc1
  buffer_load_dwordx4 v[148:151], v2, s[40:43], s75 offen offset:1024 sc1
  s_waitcnt lgkmcnt(4)
  v_mfma_f32_16x16x32_bf16 v[24:27], v[196:199], v[152:155], v[24:27]
  ds_read_b128 v[192:195], v5 offset:49152
  v_mfma_f32_16x16x32_bf16 v[28:31], v[196:199], v[156:159], v[28:31]
  s_waitcnt lgkmcnt(4)
  v_mfma_f32_16x16x32_bf16 v[32:35], v[176:179], v[152:155], v[32:35]
  ds_read_b128 v[196:199], v5 offset:50176
  v_mfma_f32_16x16x32_bf16 v[36:39], v[176:179], v[156:159], v[36:39]
  s_waitcnt lgkmcnt(4)
  v_mfma_f32_16x16x32_bf16 v[40:43], v[180:183], v[152:155], v[40:43]
  ds_read_b128 v[176:179], v5 offset:51200
  v_mfma_f32_16x16x32_bf16 v[44:47], v[180:183], v[156:159], v[44:47]
  s_waitcnt lgkmcnt(4)
  v_mfma_f32_16x16x32_bf16 v[48:51], v[184:187], v[152:155], v[48:51]
  ds_read_b128 v[180:183], v5 offset:52224
  v_mfma_f32_16x16x32_bf16 v[52:55], v[184:187], v[156:159], v[52:55]
  s_waitcnt vmcnt(9)
  v_swap_b32 v162, v164
  v_swap_b32 v163, v165
  s_waitcnt lgkmcnt(4)
  v_mfma_f32_16x16x32_bf16 v[56:59], v[188:191], v[152:155], v[56:59]
  ds_read_b128 v[184:187], v5 offset:53248
  v_mfma_f32_16x16x32_bf16 v[60:63], v[188:191], v[156:159], v[60:63]
  s_waitcnt lgkmcnt(4)
  v_mfma_f32_16x16x32_bf16 v[64:67], v[192:195], v[152:155], v[64:67]
  ds_read_b128 v[188:191], v5 offset:54272
  v_mfma_f32_16x16x32_bf16 v[68:71], v[192:195], v[156:159], v[68:71]
  s_waitcnt lgkmcnt(4)
  v_mfma_f32_16x16x32_bf16 v[16:19], v[196:199], v[160:163], v[16:19]
  ds_read_b128 v[192:195], v5 offset:55296
  v_mfma_f32_16x16x32_bf16 v[20:23], v[196:199], v[164:167], v[20:23]
  buffer_load_dwordx4 v[152:155], v2, s[40:43], s76 offen sc1
  buffer_load_dwordx4 v[156:159], v2, s[40:43], s76 offen offset:1024 sc1
  s_waitcnt lgkmcnt(4)
  v_mfma_f32_16x16x32_bf16 v[24:27], v[176:179], v[160:163], v[24:27]
  ds_read_b128 v[196:199], v5 offset:56320
  v_mfma_f32_16x16x32_bf16 v[28:31], v[176:179], v[164:167], v[28:31]
  s_waitcnt lgkmcnt(4)
  v_mfma_f32_16x16x32_bf16 v[32:35], v[180:183], v[160:163], v[32:35]
  ds_read_b128 v[176:179], v5 offset:57344
  v_mfma_f32_16x16x32_bf16 v[36:39], v[180:183], v[164:167], v[36:39]
  s_waitcnt lgkmcnt(4)
  v_mfma_f32_16x16x32_bf16 v[40:43], v[184:187], v[160:163], v[40:43]
  ds_read_b128 v[180:183], v5 offset:58368
  s_lshl_b32 s80, s90, 3
  v_mfma_f32_16x16x32_bf16 v[44:47], v[184:187], v[164:167], v[44:47]
  s_add_u32 s80, s80, s32
  s_lshl_b32 s80, s80, 9
  s_waitcnt lgkmcnt(4)
  v_mfma_f32_16x16x32_bf16 v[48:51], v[188:191], v[160:163], v[48:51]
  ds_read_b128 v[184:187], v5 offset:59392
  s_add_u32 s80, s80, 100352
  v_mfma_f32_16x16x32_bf16 v[52:55], v[188:191], v[164:167], v[52:55]
  s_waitcnt vmcnt(9)
  v_swap_b32 v170, v172
  v_swap_b32 v171, v173
  s_waitcnt lgkmcnt(4)
  v_mfma_f32_16x16x32_bf16 v[56:59], v[192:195], v[160:163], v[56:59]
  ds_read_b128 v[188:191], v5 offset:60416
  v_and_b32 v230, 0x80000180, v11
  v_mfma_f32_16x16x32_bf16 v[60:63], v[192:195], v[164:167], v[60:63]
  v_add_u32 v230, s80, v230
  buffer_load_dword v231, v230, s[36:39], 0 offen sc1
  s_waitcnt lgkmcnt(4)
  v_mfma_f32_16x16x32_bf16 v[64:67], v[196:199], v[160:163], v[64:67]
  ds_read_b128 v[192:195], v5 offset:61440
  v_mfma_f32_16x16x32_bf16 v[68:71], v[196:199], v[164:167], v[68:71]
  s_waitcnt lgkmcnt(4)
  v_mfma_f32_16x16x32_bf16 v[16:19], v[176:179], v[168:171], v[16:19]
  ds_read_b128 v[196:199], v5 offset:62464
  v_mfma_f32_16x16x32_bf16 v[20:23], v[176:179], v[172:175], v[20:23]
  buffer_load_dwordx4 v[160:163], v2, s[40:43], s77 offen sc1
  buffer_load_dwordx4 v[164:167], v2, s[40:43], s77 offen offset:1024 sc1
  s_waitcnt lgkmcnt(4)
  v_mfma_f32_16x16x32_bf16 v[24:27], v[180:183], v[168:171], v[24:27]
  ds_read_b128 v[176:179], v5 offset:63488
  v_mfma_f32_16x16x32_bf16 v[28:31], v[180:183], v[172:175], v[28:31]
  s_waitcnt lgkmcnt(4)
  v_mfma_f32_16x16x32_bf16 v[32:35], v[184:187], v[168:171], v[32:35]
  ds_read_b128 v[180:183], v6 offset:0
  v_mfma_f32_16x16x32_bf16 v[36:39], v[184:187], v[172:175], v[36:39]
  s_waitcnt lgkmcnt(4)
  v_mfma_f32_16x16x32_bf16 v[40:43], v[188:191], v[168:171], v[40:43]
  ds_read_b128 v[184:187], v6 offset:1024
  v_mfma_f32_16x16x32_bf16 v[44:47], v[188:191], v[172:175], v[44:47]
  s_waitcnt lgkmcnt(4)
  v_mfma_f32_16x16x32_bf16 v[48:51], v[192:195], v[168:171], v[48:51]
  ds_read_b128 v[188:191], v6 offset:2048
  v_mfma_f32_16x16x32_bf16 v[52:55], v[192:195], v[172:175], v[52:55]
  s_waitcnt vmcnt(9)
  v_swap_b32 v130, v132
  v_swap_b32 v131, v133
  s_waitcnt lgkmcnt(4)
  v_mfma_f32_16x16x32_bf16 v[56:59], v[196:199], v[168:171], v[56:59]
  ds_read_b128 v[192:195], v6 offset:3072
  v_mfma_f32_16x16x32_bf16 v[60:63], v[196:199], v[172:175], v[60:63]
  s_waitcnt lgkmcnt(4)
  v_mfma_f32_16x16x32_bf16 v[64:67], v[176:179], v[168:171], v[64:67]
  ds_read_b128 v[196:199], v6 offset:4096
  v_mfma_f32_16x16x32_bf16 v[68:71], v[176:179], v[172:175], v[68:71]
  s_waitcnt lgkmcnt(4)
  v_mfma_f32_16x16x32_bf16 v[16:19], v[180:183], v[128:131], v[16:19]
  ds_read_b128 v[176:179], v6 offset:5120
  v_mfma_f32_16x16x32_bf16 v[20:23], v[180:183], v[132:135], v[20:23]
  buffer_load_dwordx4 v[168:171], v2, s[40:43], s78 offen sc1
  buffer_load_dwordx4 v[172:175], v2, s[40:43], s78 offen offset:1024 sc1
  s_waitcnt lgkmcnt(4)
  v_mfma_f32_16x16x32_bf16 v[24:27], v[184:187], v[128:131], v[24:27]
  ds_read_b128 v[180:183], v6 offset:6144
  v_mfma_f32_16x16x32_bf16 v[28:31], v[184:187], v[132:135], v[28:31]
  s_waitcnt lgkmcnt(4)
  v_mfma_f32_16x16x32_bf16 v[32:35], v[188:191], v[128:131], v[32:35]
  ds_read_b128 v[184:187], v6 offset:7168
  v_mfma_f32_16x16x32_bf16 v[36:39], v[188:191], v[132:135], v[36:39]
  s_waitcnt lgkmcnt(4)
  v_mfma_f32_16x16x32_bf16 v[40:43], v[192:195], v[128:131], v[40:43]
  ds_read_b128 v[188:191], v6 offset:8192
  v_mfma_f32_16x16x32_bf16 v[44:47], v[192:195], v[132:135], v[44:47]
  s_waitcnt lgkmcnt(4)
  v_mfma_f32_16x16x32_bf16 v[48:51], v[196:199], v[128:131], v[48:51]
  ds_read_b128 v[192:195], v6 offset:9216
  v_mfma_f32_16x16x32_bf16 v[52:55], v[196:199], v[132:135], v[52:55]
  s_waitcnt vmcnt(9)
  v_swap_b32 v138, v140
  v_swap_b32 v139, v141
  s_waitcnt lgkmcnt(4)
  v_mfma_f32_16x16x32_bf16 v[56:59], v[176:179], v[128:131], v[56:59]
  ds_read_b128 v[196:199], v6 offset:10240
  v_mfma_f32_16x16x32_bf16 v[60:63], v[176:179], v[132:135], v[60:63]
  s_waitcnt lgkmcnt(4)
  v_mfma_f32_16x16x32_bf16 v[64:67], v[180:183], v[128:131], v[64:67]
  ds_read_b128 v[176:179], v6 offset:11264
  v_mfma_f32_16x16x32_bf16 v[68:71], v[180:183], v[132:135], v[68:71]
  s_waitcnt lgkmcnt(4)
  v_mfma_f32_16x16x32_bf16 v[16:19], v[184:187], v[136:139], v[16:19]
  ds_read_b128 v[180:183], v6 offset:12288
  v_mfma_f32_16x16x32_bf16 v[20:23], v[184:187], v[140:143], v[20:23]
  buffer_load_dwordx4 v[128:131], v2, s[40:43], s79 offen sc1
  buffer_load_dwordx4 v[132:135], v2, s[40:43], s79 offen offset:1024 sc1
  s_waitcnt lgkmcnt(4)
  v_mfma_f32_16x16x32_bf16 v[24:27], v[188:191], v[136:139], v[24:27]
  ds_read_b128 v[184:187], v6 offset:13312
  v_mfma_f32_16x16x32_bf16 v[28:31], v[188:191], v[140:143], v[28:31]
  s_waitcnt lgkmcnt(4)
  v_mfma_f32_16x16x32_bf16 v[32:35], v[192:195], v[136:139], v[32:35]
  ds_read_b128 v[188:191], v6 offset:14336
  v_mfma_f32_16x16x32_bf16 v[36:39], v[192:195], v[140:143], v[36:39]
  s_waitcnt lgkmcnt(4)
  v_mfma_f32_16x16x32_bf16 v[40:43], v[196:199], v[136:139], v[40:43]
  ds_read_b128 v[192:195], v6 offset:15360
  v_mfma_f32_16x16x32_bf16 v[44:47], v[196:199], v[140:143], v[44:47]
  s_waitcnt lgkmcnt(4)
  v_mfma_f32_16x16x32_bf16 v[48:51], v[176:179], v[136:139], v[48:51]
  ds_read_b128 v[196:199], v6 offset:16384
  v_mfma_f32_16x16x32_bf16 v[52:55], v[176:179], v[140:143], v[52:55]
  s_waitcnt vmcnt(9)
  v_swap_b32 v146, v148
  v_swap_b32 v147, v149
  s_waitcnt lgkmcnt(4)
  v_mfma_f32_16x16x32_bf16 v[56:59], v[180:183], v[136:139], v[56:59]
  ds_read_b128 v[176:179], v6 offset:17408
  s_waitcnt vmcnt(6)
  v_cmp_gt_u32 vcc, 8, v231
  v_mfma_f32_16x16x32_bf16 v[60:63], v[180:183], v[140:143], v[60:63]
  s_and_b32 vcc_lo, vcc_lo, 0xf
  s_cbranch_scc1 L_cp_29
L_cpb_30:
  s_waitcnt lgkmcnt(4)
  v_mfma_f32_16x16x32_bf16 v[64:67], v[184:187], v[136:139], v[64:67]
  ds_read_b128 v[180:183], v6 offset:18432
  v_mfma_f32_16x16x32_bf16 v[68:71], v[184:187], v[140:143], v[68:71]
  s_waitcnt lgkmcnt(4)
  v_mfma_f32_16x16x32_bf16 v[16:19], v[188:191], v[144:147], v[16:19]
  ds_read_b128 v[184:187], v6 offset:19456
  v_mfma_f32_16x16x32_bf16 v[20:23], v[188:191], v[148:151], v[20:23]
  s_add_u32 s40, s28, 0x1828000
  s_addc_u32 s41, s29, 0
  buffer_load_dwordx4 v[136:139], v2, s[40:43], s60 offen sc1
  buffer_load_dwordx4 v[140:143], v2, s[40:43], s60 offen offset:1024 sc1
  s_waitcnt lgkmcnt(4)
  v_mfma_f32_16x16x32_bf16 v[24:27], v[192:195], v[144:147], v[24:27]
  ds_read_b128 v[188:191], v6 offset:20480
  v_mfma_f32_16x16x32_bf16 v[28:31], v[192:195], v[148:151], v[28:31]
  s_waitcnt lgkmcnt(4)
  v_mfma_f32_16x16x32_bf16 v[32:35], v[196:199], v[144:147], v[32:35]
  ds_read_b128 v[192:195], v6 offset:21504
  v_mfma_f32_16x16x32_bf16 v[36:39], v[196:199], v[148:151], v[36:39]
  s_sub_u32 s80, s32, s100
  s_lshl_b32 s80, s80, 11
  s_waitcnt lgkmcnt(4)
  v_mfma_f32_16x16x32_bf16 v[40:43], v[176:179], v[144:147], v[40:43]
  ds_read_b128 v[196:199], v6 offset:22528
  s_sub_u32 s81, s90, s30
  v_mfma_f32_16x16x32_bf16 v[44:47], v[176:179], v[148:151], v[44:47]
  s_lshl_b32 s81, s81, 14
  s_add_u32 s80, s80, s81
  s_waitcnt lgkmcnt(4)
  v_mfma_f32_16x16x32_bf16 v[48:51], v[180:183], v[144:147], v[48:51]
  ds_read_b128 v[176:179], v6 offset:23552
  s_add_u32 s80, s80, 0x80000
  v_mfma_f32_16x16x32_bf16 v[52:55], v[180:183], v[148:151], v[52:55]
  v_swap_b32 v154, v156
  v_swap_b32 v155, v157
  s_waitcnt lgkmcnt(4)
  v_mfma_f32_16x16x32_bf16 v[56:59], v[184:187], v[144:147], v[56:59]
  ds_read_b128 v[180:183], v6 offset:24576
  buffer_load_dwordx4 v[216:219], v13, s[36:39], s80 offen offset:0 sc1
  v_mfma_f32_16x16x32_bf16 v[60:63], v[184:187], v[148:151], v[60:63]
  buffer_load_dwordx4 v[220:223], v13, s[36:39], s80 offen offset:256 sc1
  s_waitcnt lgkmcnt(4)
  v_mfma_f32_16x16x32_bf16 v[64:67], v[188:191], v[144:147], v[64:67]
  ds_read_b128 v[184:187], v6 offset:25600
  v_mfma_f32_16x16x32_bf16 v[68:71], v[188:191], v[148:151], v[68:71]
  s_waitcnt lgkmcnt(4)
  v_mfma_f32_16x16x32_bf16 v[16:19], v[192:195], v[152:155], v[16:19]
  ds_read_b128 v[188:191], v6 offset:26624
  v_mfma_f32_16x16x32_bf16 v[20:23], v[192:195], v[156:159], v[20:23]
  buffer_load_dwordx4 v[144:147], v2, s[40:43], s61 offen sc1
  buffer_load_dwordx4 v[148:151], v2, s[40:43], s61 offen offset:1024 sc1
  s_waitcnt lgkmcnt(4)
  v_mfma_f32_16x16x32_bf16 v[24:27], v[196:199], v[152:155], v[24:27]
  ds_read_b128 v[192:195], v6 offset:27648
  v_mfma_f32_16x16x32_bf16 v[28:31], v[196:199], v[156:159], v[28:31]
  s_waitcnt lgkmcnt(4)
  v_mfma_f32_16x16x32_bf16 v[32:35], v[176:179], v[152:155], v[32:35]
  ds_read_b128 v[196:199], v6 offset:28672
  v_mfma_f32_16x16x32_bf16 v[36:39], v[176:179], v[156:159], v[36:39]
  s_waitcnt lgkmcnt(4)
  v_mfma_f32_16x16x32_bf16 v[40:43], v[180:183], v[152:155], v[40:43]
  ds_read_b128 v[176:179], v6 offset:29696
  v_mfma_f32_16x16x32_bf16 v[44:47], v[180:183], v[156:159], v[44:47]
  s_waitcnt lgkmcnt(4)
  v_mfma_f32_16x16x32_bf16 v[48:51], v[184:187], v[152:155], v[48:51]
  ds_read_b128 v[180:183], v6 offset:30720
  v_mfma_f32_16x16x32_bf16 v[52:55], v[184:187], v[156:159], v[52:55]
  s_waitcnt vmcnt(10)
  v_swap_b32 v162, v164
  v_swap_b32 v163, v165
  s_waitcnt lgkmcnt(4)
  v_mfma_f32_16x16x32_bf16 v[56:59], v[188:191], v[152:155], v[56:59]
  ds_read_b128 v[184:187], v6 offset:31744
  v_mfma_f32_16x16x32_bf16 v[60:63], v[188:191], v[156:159], v[60:63]
  s_waitcnt lgkmcnt(4)
  v_mfma_f32_16x16x32_bf16 v[64:67], v[192:195], v[152:155], v[64:67]
  ds_read_b128 v[188:191], v6 offset:32768
  v_mfma_f32_16x16x32_bf16 v[68:71], v[192:195], v[156:159], v[68:71]
  s_waitcnt lgkmcnt(4)
  v_mfma_f32_16x16x32_bf16 v[16:19], v[196:199], v[160:163], v[16:19]
  ds_read_b128 v[192:195], v6 offset:33792
  v_mfma_f32_16x16x32_bf16 v[20:23], v[196:199], v[164:167], v[20:23]
  buffer_load_dwordx4 v[152:155], v2, s[40:43], s62 offen sc1
  buffer_load_dwordx4 v[156:159], v2, s[40:43], s62 offen offset:1024 sc1
  s_waitcnt lgkmcnt(4)
  v_mfma_f32_16x16x32_bf16 v[24:27], v[176:179], v[160:163], v[24:27]
  ds_read_b128 v[196:199], v6 offset:34816
  v_mfma_f32_16x16x32_bf16 v[28:31], v[176:179], v[164:167], v[28:31]
  s_waitcnt lgkmcnt(4)
  v_mfma_f32_16x16x32_bf16 v[32:35], v[180:183], v[160:163], v[32:35]
  ds_read_b128 v[176:179], v6 offset:35840
  v_mfma_f32_16x16x32_bf16 v[36:39], v[180:183], v[164:167], v[36:39]
  s_waitcnt lgkmcnt(4)
  v_mfma_f32_16x16x32_bf16 v[40:43], v[184:187], v[160:163], v[40:43]
  ds_read_b128 v[180:183], v6 offset:36864
  v_mfma_f32_16x16x32_bf16 v[44:47], v[184:187], v[164:167], v[44:47]
  s_waitcnt lgkmcnt(4)
  v_mfma_f32_16x16x32_bf16 v[48:51], v[188:191], v[160:163], v[48:51]
  ds_read_b128 v[184:187], v6 offset:37888
  v_mfma_f32_16x16x32_bf16 v[52:55], v[188:191], v[164:167], v[52:55]
  s_waitcnt vmcnt(10)
  v_swap_b32 v170, v172
  v_swap_b32 v171, v173
  s_waitcnt lgkmcnt(4)
  v_mfma_f32_16x16x32_bf16 v[56:59], v[192:195], v[160:163], v[56:59]
  ds_read_b128 v[188:191], v6 offset:38912
  v_mfma_f32_16x16x32_bf16 v[60:63], v[192:195], v[164:167], v[60:63]
  s_waitcnt lgkmcnt(4)
  v_mfma_f32_16x16x32_bf16 v[64:67], v[196:199], v[160:163], v[64:67]
  ds_read_b128 v[192:195], v6 offset:39936
  s_waitcnt vmcnt(4)
  v_add_f32 v216, v216, v220
  v_mfma_f32_16x16x32_bf16 v[68:71], v[196:199], v[164:167], v[68:71]
  v_add_f32 v217, v217, v221
  v_add_f32 v218, v218, v222
  s_waitcnt lgkmcnt(4)
  v_mfma_f32_16x16x32_bf16 v[16:19], v[176:179], v[168:171], v[16:19]
  ds_read_b128 v[196:199], v6 offset:40960
  v_add_f32 v219, v219, v223
  v_mfma_f32_16x16x32_bf16 v[20:23], v[176:179], v[172:175], v[20:23]
  buffer_load_dwordx4 v[160:163], v2, s[40:43], s63 offen sc1
  buffer_load_dwordx4 v[164:167], v2, s[40:43], s63 offen offset:1024 sc1
  s_waitcnt lgkmcnt(4)
  v_mfma_f32_16x16x32_bf16 v[24:27], v[180:183], v[168:171], v[24:27]
  ds_read_b128 v[176:179], v6 offset:41984
  v_permlane32_swap_b32 v216, v218
  v_mfma_f32_16x16x32_bf16 v[28:31], v[180:183], v[172:175], v[28:31]
  v_permlane32_swap_b32 v217, v219
  v_add_f32 v216, v216, v218
  s_waitcnt lgkmcnt(4)
  v_mfma_f32_16x16x32_bf16 v[32:35], v[184:187], v[168:171], v[32:35]
  ds_read_b128 v[180:183], v6 offset:43008
  v_add_f32 v217, v217, v219
  v_mfma_f32_16x16x32_bf16 v[36:39], v[184:187], v[172:175], v[36:39]
  s_nop 0
  v_permlane16_swap_b32 v216, v217
  v_add_f32 v216, v216, v217
  s_waitcnt lgkmcnt(4)
  v_mfma_f32_16x16x32_bf16 v[40:43], v[188:191], v[168:171], v[40:43]
  ds_read_b128 v[184:187], v6 offset:44032
  v_mov_b32 v217, v216
  v_mfma_f32_16x16x32_bf16 v[44:47], v[188:191], v[172:175], v[44:47]
  s_nop 0
  v_permlane16_swap_b32 v216, v217
  v_mov_b32 v218, v216
  s_waitcnt lgkmcnt(4)
  v_mfma_f32_16x16x32_bf16 v[48:51], v[192:195], v[168:171], v[48:51]
  ds_read_b128 v[188:191], v6 offset:45056
  v_mov_b32 v219, v217
  v_mfma_f32_16x16x32_bf16 v[52:55], v[192:195], v[172:175], v[52:55]
  v_swap_b32 v130, v132
  v_swap_b32 v131, v133
  s_waitcnt lgkmcnt(4)
  v_mfma_f32_16x16x32_bf16 v[56:59], v[196:199], v[168:171], v[56:59]
  ds_read_b128 v[192:195], v6 offset:46080
  v_permlane32_swap_b32 v216, v218
  v_mfma_f32_16x16x32_bf16 v[60:63], v[196:199], v[172:175], v[60:63]
  v_permlane32_swap_b32 v217, v219
  v_mul_f32 v216, 0x3acccccd, v216
  s_waitcnt lgkmcnt(4)
  v_mfma_f32_16x16x32_bf16 v[64:67], v[176:179], v[168:171], v[64:67]
  ds_read_b128 v[196:199], v6 offset:47104
  v_mul_f32 v217, 0x3acccccd, v217
  v_mfma_f32_16x16x32_bf16 v[68:71], v[176:179], v[172:175], v[68:71]
  v_mul_f32 v218, 0x3acccccd, v218
  v_mul_f32 v219, 0x3acccccd, v219
  s_waitcnt lgkmcnt(4)
  v_mfma_f32_16x16x32_bf16 v[16:19], v[180:183], v[128:131], v[16:19]
  ds_read_b128 v[176:179], v6 offset:48128
  v_fma_f32 v217, -v216, v216, v217
  v_mfma_f32_16x16x32_bf16 v[20:23], v[180:183], v[132:135], v[20:23]
  buffer_load_dwordx4 v[168:171], v2, s[40:43], s64 offen sc1
  buffer_load_dwordx4 v[172:175], v2, s[40:43], s64 offen offset:1024 sc1
  s_waitcnt lgkmcnt(4)
  v_mfma_f32_16x16x32_bf16 v[24:27], v[184:187], v[128:131], v[24:27]
  ds_read_b128 v[180:183], v6 offset:49152
  v_fma_f32 v219, -v218, v218, v219
  v_mfma_f32_16x16x32_bf16 v[28:31], v[184:187], v[132:135], v[28:31]
  v_max_f32 v217, 0, v217
  v_max_f32 v219, 0, v219
  s_waitcnt lgkmcnt(4)
  v_mfma_f32_16x16x32_bf16 v[32:35], v[188:191], v[128:131], v[32:35]
  ds_read_b128 v[184:187], v6 offset:50176
  v_add_f32 v217, 0x3727c5ac, v217
  v_mfma_f32_16x16x32_bf16 v[36:39], v[188:191], v[132:135], v[36:39]
  v_add_f32 v219, 0x3727c5ac, v219
  s_waitcnt lgkmcnt(4)
  v_mfma_f32_16x16x32_bf16 v[40:43], v[192:195], v[128:131], v[40:43]
  ds_read_b128 v[188:191], v6 offset:51200
  v_mfma_f32_16x16x32_bf16 v[44:47], v[192:195], v[132:135], v[44:47]
  v_rsq_f32 v216, v217
  s_waitcnt lgkmcnt(4)
  v_mfma_f32_16x16x32_bf16 v[48:51], v[196:199], v[128:131], v[48:51]
  ds_read_b128 v[192:195], v6 offset:52224
  v_mfma_f32_16x16x32_bf16 v[52:55], v[196:199], v[132:135], v[52:55]
  v_swap_b32 v138, v140
  v_swap_b32 v139, v141
  s_waitcnt lgkmcnt(4)
  v_mfma_f32_16x16x32_bf16 v[56:59], v[176:179], v[128:131], v[56:59]
  ds_read_b128 v[196:199], v6 offset:53248
  v_mfma_f32_16x16x32_bf16 v[60:63], v[176:179], v[132:135], v[60:63]
  v_rsq_f32 v218, v219
  s_waitcnt lgkmcnt(4)
  v_mfma_f32_16x16x32_bf16 v[64:67], v[180:183], v[128:131], v[64:67]
  ds_read_b128 v[176:179], v6 offset:54272
  v_mfma_f32_16x16x32_bf16 v[68:71], v[180:183], v[132:135], v[68:71]
  v_rcp_f32 v201, v217
  v_rcp_f32 v204, v219
  v_mul_f32 v200, 0xc0135761, v216
  v_mov_b32 v202, v217
  v_mul_f32 v203, 0xc0135761, v218
  v_mov_b32 v205, v219
  v_mul_f32 v201, 0x3d372713, v201
  v_mul_f32 v204, 0x3d372713, v204
  v_mul_f32 v201, v201, v200
  v_mul_f32 v204, v204, v203
  s_waitcnt lgkmcnt(4)
  v_mfma_f32_16x16x32_bf16 v[72:75], v[184:187], v[136:139], 0
  ds_read_b128 v[180:183], v6 offset:55296
  v_mul_f32 v212, v64, v64
  v_mul_f32 v213, v65, v65
  v_mfma_f32_16x16x32_bf16 v[76:79], v[184:187], v[140:143], 0
  buffer_load_dwordx4 v[128:131], v2, s[40:43], s65 offen sc1
  buffer_load_dwordx4 v[132:135], v2, s[40:43], s65 offen offset:1024 sc1
  v_fma_f32 v212, v212, v201, v200
  s_waitcnt lgkmcnt(4)
  v_mfma_f32_16x16x32_bf16 v[80:83], v[188:191], v[136:139], 0
  ds_read_b128 v[184:187], v6 offset:56320
  v_fma_f32 v213, v213, v201, v200
  v_mul_f32 v212, v212, v64
  v_mfma_f32_16x16x32_bf16 v[84:87], v[188:191], v[140:143], 0
  v_mul_f32 v213, v213, v65
  v_exp_f32 v212, v212
  s_waitcnt lgkmcnt(4)
  v_mfma_f32_16x16x32_bf16 v[88:91], v[192:195], v[136:139], 0
  ds_read_b128 v[188:191], v6 offset:57344
  v_exp_f32 v213, v213
  v_mfma_f32_16x16x32_bf16 v[92:95], v[192:195], v[140:143], 0
  v_mul_f32 v64, v64, v66
  v_mul_f32 v65, v65, v67
  v_fma_f32 v212, v212, v202, v202
  s_waitcnt lgkmcnt(4)
  v_mfma_f32_16x16x32_bf16 v[96:99], v[196:199], v[136:139], 0
  ds_read_b128 v[192:195], v6 offset:58368
  v_fma_f32 v213, v213, v202, v202
  v_mfma_f32_16x16x32_bf16 v[100:103], v[196:199], v[140:143], 0
  v_rcp_f32 v212, v212
  s_waitcnt lgkmcnt(4)
  v_mfma_f32_16x16x32_bf16 v[104:107], v[176:179], v[136:139], 0
  ds_read_b128 v[196:199], v6 offset:59392
  v_rcp_f32 v213, v213
  v_mfma_f32_16x16x32_bf16 v[108:111], v[176:179], v[140:143], 0
  s_waitcnt vmcnt(8)
  v_swap_b32 v146, v148
  v_swap_b32 v147, v149
  v_mul_f32 v64, v64, v212
  s_waitcnt lgkmcnt(4)
  v_mfma_f32_16x16x32_bf16 v[112:115], v[180:183], v[136:139], 0
  ds_read_b128 v[176:179], v6 offset:60416
  v_mul_f32 v65, v65, v213
  v_cvt_pk_bf16_f32 v208, v64, v65
  v_mfma_f32_16x16x32_bf16 v[116:119], v[180:183], v[140:143], 0
  v_mul_f32 v212, v68, v68
  v_mul_f32 v213, v69, v69
  v_fma_f32 v212, v212, v204, v203
  s_waitcnt lgkmcnt(4)
  v_mfma_f32_16x16x32_bf16 v[120:123], v[184:187], v[136:139], 0
  ds_read_b128 v[180:183], v6 offset:61440
  v_fma_f32 v213, v213, v204, v203
  v_mul_f32 v212, v212, v68
  v_mfma_f32_16x16x32_bf16 v[124:127], v[184:187], v[140:143], 0
  v_mul_f32 v213, v213, v69
  v_exp_f32 v212, v212
  s_waitcnt lgkmcnt(4)
  v_mfma_f32_16x16x32_bf16 v[72:75], v[188:191], v[144:147], v[72:75]
  ds_read_b128 v[184:187], v6 offset:62464
  v_exp_f32 v213, v213
  v_mfma_f32_16x16x32_bf16 v[76:79], v[188:191], v[148:151], v[76:79]
  buffer_load_dwordx4 v[136:139], v2, s[40:43], s66 offen sc1
  buffer_load_dwordx4 v[140:143], v2, s[40:43], s66 offen offset:1024 sc1
  v_mul_f32 v68, v68, v70
  s_waitcnt lgkmcnt(4)
  v_mfma_f32_16x16x32_bf16 v[80:83], v[192:195], v[144:147], v[80:83]
  ds_read_b128 v[188:191], v6 offset:63488
  v_mul_f32 v69, v69, v71
  v_fma_f32 v212, v212, v205, v205
  v_mfma_f32_16x16x32_bf16 v[84:87], v[192:195], v[148:151], v[84:87]
  v_fma_f32 v213, v213, v205, v205
  v_rcp_f32 v212, v212
  s_waitcnt lgkmcnt(4)
  v_mfma_f32_16x16x32_bf16 v[88:91], v[196:199], v[144:147], v[88:91]
  ds_read_b128 v[192:195], v7 offset:0
  v_rcp_f32 v213, v213
  v_mfma_f32_16x16x32_bf16 v[92:95], v[196:199], v[148:151], v[92:95]
  v_mul_f32 v68, v68, v212
  v_mul_f32 v69, v69, v213
  v_cvt_pk_bf16_f32 v209, v68, v69
  s_waitcnt lgkmcnt(4)
  v_mfma_f32_16x16x32_bf16 v[96:99], v[176:179], v[144:147], v[96:99]
  ds_read_b128 v[196:199], v7 offset:1024
  v_permlane16_swap_b32 v208, v209
  s_mov_b32 s80, 0x2200000
  v_mfma_f32_16x16x32_bf16 v[100:103], v[176:179], v[148:151], v[100:103]
  buffer_store_dwordx2 v[208:209], v9, s[36:39], s80 offen sc1
  v_mul_f32 v212, v16, v16
  v_mul_f32 v213, v17, v17
  s_waitcnt lgkmcnt(4)
  v_mfma_f32_16x16x32_bf16 v[104:107], v[180:183], v[144:147], v[104:107]
  ds_read_b128 v[176:179], v7 offset:2048
  v_mul_f32 v214, v18, v18
  v_mul_f32 v215, v19, v19
  v_mfma_f32_16x16x32_bf16 v[108:111], v[180:183], v[148:151], v[108:111]
  s_waitcnt vmcnt(9)
  v_swap_b32 v154, v156
  v_swap_b32 v155, v157
  v_fma_f32 v212, v212, v201, v200
  s_waitcnt lgkmcnt(4)
  v_mfma_f32_16x16x32_bf16 v[112:115], v[184:187], v[144:147], v[112:115]
  ds_read_b128 v[180:183], v7 offset:3072
  v_fma_f32 v213, v213, v201, v200
  v_fma_f32 v214, v214, v201, v200
  v_mfma_f32_16x16x32_bf16 v[116:119], v[184:187], v[148:151], v[116:119]
  v_fma_f32 v215, v215, v201, v200
  v_mul_f32 v212, v212, v16
  v_mul_f32 v213, v213, v17
  s_waitcnt lgkmcnt(4)
  v_mfma_f32_16x16x32_bf16 v[120:123], v[188:191], v[144:147], v[120:123]
  ds_read_b128 v[184:187], v7 offset:4096
  v_mul_f32 v214, v214, v18
  v_mul_f32 v215, v215, v19
  v_mfma_f32_16x16x32_bf16 v[124:127], v[188:191], v[148:151], v[124:127]
  v_exp_f32 v212, v212
  s_waitcnt lgkmcnt(4)
  v_mfma_f32_16x16x32_bf16 v[72:75], v[192:195], v[152:155], v[72:75]
  ds_read_b128 v[188:191], v7 offset:5120
  v_exp_f32 v213, v213
  v_mfma_f32_16x16x32_bf16 v[76:79], v[192:195], v[156:159], v[76:79]
  buffer_load_dwordx4 v[144:147], v2, s[40:43], s67 offen sc1
  buffer_load_dwordx4 v[148:151], v2, s[40:43], s67 offen offset:1024 sc1
  s_waitcnt lgkmcnt(4)
  v_mfma_f32_16x16x32_bf16 v[80:83], v[196:199], v[152:155], v[80:83]
  ds_read_b128 v[192:195], v7 offset:6144
  v_exp_f32 v214, v214
  v_mfma_f32_16x16x32_bf16 v[84:87], v[196:199], v[156:159], v[84:87]
  v_exp_f32 v215, v215
  v_mul_f32 v16, v16, v24
  s_waitcnt lgkmcnt(4)
  v_mfma_f32_16x16x32_bf16 v[88:91], v[176:179], v[152:155], v[88:91]
  ds_read_b128 v[196:199], v7 offset:7168
  v_mul_f32 v17, v17, v25
  v_mul_f32 v18, v18, v26
  v_mfma_f32_16x16x32_bf16 v[92:95], v[176:179], v[156:159], v[92:95]
  v_mul_f32 v19, v19, v27
  v_fma_f32 v212, v212, v202, v202
  v_fma_f32 v213, v213, v202, v202
  s_waitcnt lgkmcnt(4)
  v_mfma_f32_16x16x32_bf16 v[96:99], v[180:183], v[152:155], v[96:99]
  ds_read_b128 v[176:179], v7 offset:8192
  v_fma_f32 v214, v214, v202, v202
  v_fma_f32 v215, v215, v202, v202
  v_mfma_f32_16x16x32_bf16 v[100:103], v[180:183], v[156:159], v[100:103]
  v_rcp_f32 v212, v212
  s_waitcnt lgkmcnt(4)
  v_mfma_f32_16x16x32_bf16 v[104:107], v[184:187], v[152:155], v[104:107]
  ds_read_b128 v[180:183], v7 offset:9216
  v_rcp_f32 v213, v213
  v_mfma_f32_16x16x32_bf16 v[108:111], v[184:187], v[156:159], v[108:111]
  s_waitcnt vmcnt(9)
  v_swap_b32 v162, v164
  v_swap_b32 v163, v165
  s_waitcnt lgkmcnt(4)
  v_mfma_f32_16x16x32_bf16 v[112:115], v[188:191], v[152:155], v[112:115]
  ds_read_b128 v[184:187], v7 offset:10240
  v_rcp_f32 v214, v214
  v_mfma_f32_16x16x32_bf16 v[116:119], v[188:191], v[156:159], v[116:119]
  v_rcp_f32 v215, v215
  v_mul_f32 v16, v16, v212
  s_waitcnt lgkmcnt(4)
  v_mfma_f32_16x16x32_bf16 v[120:123], v[192:195], v[152:155], v[120:123]
  ds_read_b128 v[188:191], v7 offset:11264
  v_mul_f32 v17, v17, v213
  v_mul_f32 v18, v18, v214
  v_mfma_f32_16x16x32_bf16 v[124:127], v[192:195], v[156:159], v[124:127]
  v_mul_f32 v19, v19, v215
  v_cvt_pk_bf16_f32 v208, v16, v17
  v_cvt_pk_bf16_f32 v209, v18, v19
  s_waitcnt lgkmcnt(4)
  v_mfma_f32_16x16x32_bf16 v[72:75], v[196:199], v[160:163], v[72:75]
  ds_read_b128 v[192:195], v7 offset:12288
  v_mul_f32 v212, v20, v20
  v_mul_f32 v213, v21, v21
  v_mfma_f32_16x16x32_bf16 v[76:79], v[196:199], v[164:167], v[76:79]
  buffer_load_dwordx4 v[152:155], v2, s[40:43], s68 offen sc1
  buffer_load_dwordx4 v[156:159], v2, s[40:43], s68 offen offset:1024 sc1
  v_mul_f32 v214, v22, v22
  s_waitcnt lgkmcnt(4)
  v_mfma_f32_16x16x32_bf16 v[80:83], v[176:179], v[160:163], v[80:83]
  ds_read_b128 v[196:199], v7 offset:13312
  v_mul_f32 v215, v23, v23
  v_fma_f32 v212, v212, v204, v203
  v_mfma_f32_16x16x32_bf16 v[84:87], v[176:179], v[164:167], v[84:87]
  v_fma_f32 v213, v213, v204, v203
  v_fma_f32 v214, v214, v204, v203
  v_fma_f32 v215, v215, v204, v203
  s_waitcnt lgkmcnt(4)
  v_mfma_f32_16x16x32_bf16 v[88:91], v[180:183], v[160:163], v[88:91]
  ds_read_b128 v[176:179], v5 offset:0
  v_mul_f32 v212, v212, v20
  v_mul_f32 v213, v213, v21
  v_mfma_f32_16x16x32_bf16 v[92:95], v[180:183], v[164:167], v[92:95]
  v_mul_f32 v214, v214, v22
  v_mul_f32 v215, v215, v23
  s_waitcnt lgkmcnt(4)
  v_mfma_f32_16x16x32_bf16 v[96:99], v[184:187], v[160:163], v[96:99]
  ds_read_b128 v[180:183], v5 offset:1024
  v_exp_f32 v212, v212
  v_mfma_f32_16x16x32_bf16 v[100:103], v[184:187], v[164:167], v[100:103]
  v_exp_f32 v213, v213
  s_waitcnt lgkmcnt(4)
  v_mfma_f32_16x16x32_bf16 v[104:107], v[188:191], v[160:163], v[104:107]
  ds_read_b128 v[184:187], v5 offset:2048
  v_exp_f32 v214, v214
  v_mfma_f32_16x16x32_bf16 v[108:111], v[188:191], v[164:167], v[108:111]
  s_waitcnt vmcnt(9)
  v_swap_b32 v170, v172
  v_swap_b32 v171, v173
  s_waitcnt lgkmcnt(4)
  v_mfma_f32_16x16x32_bf16 v[112:115], v[192:195], v[160:163], v[112:115]
  ds_read_b128 v[188:191], v5 offset:3072
  v_exp_f32 v215, v215
  v_mfma_f32_16x16x32_bf16 v[116:119], v[192:195], v[164:167], v[116:119]
  v_mul_f32 v20, v20, v28
  v_mul_f32 v21, v21, v29
  v_mul_f32 v22, v22, v30
  s_waitcnt lgkmcnt(4)
  v_mfma_f32_16x16x32_bf16 v[120:123], v[196:199], v[160:163], v[120:123]
  ds_read_b128 v[192:195], v5 offset:4096
  v_mul_f32 v23, v23, v31
  v_fma_f32 v212, v212, v205, v205
  v_mfma_f32_16x16x32_bf16 v[124:127], v[196:199], v[164:167], v[124:127]
  v_fma_f32 v213, v213, v205, v205
  v_fma_f32 v214, v214, v205, v205
  v_fma_f32 v215, v215, v205, v205
  s_waitcnt lgkmcnt(4)
  v_mfma_f32_16x16x32_bf16 v[72:75], v[176:179], v[168:171], v[72:75]
  ds_read_b128 v[196:199], v5 offset:5120
  v_rcp_f32 v212, v212
  v_mfma_f32_16x16x32_bf16 v[76:79], v[176:179], v[172:175], v[76:79]
  buffer_load_dwordx4 v[160:163], v2, s[40:43], s69 offen sc1
  buffer_load_dwordx4 v[164:167], v2, s[40:43], s69 offen offset:1024 sc1
  s_waitcnt lgkmcnt(4)
  v_mfma_f32_16x16x32_bf16 v[80:83], v[180:183], v[168:171], v[80:83]
  ds_read_b128 v[176:179], v5 offset:6144
  v_rcp_f32 v213, v213
  v_mfma_f32_16x16x32_bf16 v[84:87], v[180:183], v[172:175], v[84:87]
  v_rcp_f32 v214, v214
  s_waitcnt lgkmcnt(4)
  v_mfma_f32_16x16x32_bf16 v[88:91], v[184:187], v[168:171], v[88:91]
  ds_read_b128 v[180:183], v5 offset:7168
  v_rcp_f32 v215, v215
  v_mfma_f32_16x16x32_bf16 v[92:95], v[184:187], v[172:175], v[92:95]
  v_mul_f32 v20, v20, v212
  v_mul_f32 v21, v21, v213
  v_mul_f32 v22, v22, v214
  s_waitcnt lgkmcnt(4)
  v_mfma_f32_16x16x32_bf16 v[96:99], v[188:191], v[168:171], v[96:99]
  ds_read_b128 v[184:187], v5 offset:8192
  v_mul_f32 v23, v23, v215
  v_cvt_pk_bf16_f32 v210, v20, v21
  v_mfma_f32_16x16x32_bf16 v[100:103], v[188:191], v[172:175], v[100:103]
  v_cvt_pk_bf16_f32 v211, v22, v23
  s_mov_b32 s80, 0x2200000
  buffer_store_dwordx4 v[208:211], v8, s[36:39], s80 offen sc1
  s_waitcnt lgkmcnt(4)
  v_mfma_f32_16x16x32_bf16 v[104:107], v[192:195], v[168:171], v[104:107]
  ds_read_b128 v[188:191], v5 offset:9216
  v_mul_f32 v212, v32, v32
  v_mul_f32 v213, v33, v33
  v_mfma_f32_16x16x32_bf16 v[108:111], v[192:195], v[172:175], v[108:111]
  s_waitcnt vmcnt(10)
  v_swap_b32 v130, v132
  v_swap_b32 v131, v133
  v_mul_f32 v214, v34, v34
  s_waitcnt lgkmcnt(4)
  v_mfma_f32_16x16x32_bf16 v[112:115], v[196:199], v[168:171], v[112:115]
  ds_read_b128 v[192:195], v5 offset:10240
  v_mul_f32 v215, v35, v35
  v_fma_f32 v212, v212, v201, v200
  v_mfma_f32_16x16x32_bf16 v[116:119], v[196:199], v[172:175], v[116:119]
  v_fma_f32 v213, v213, v201, v200
  v_fma_f32 v214, v214, v201, v200
  v_fma_f32 v215, v215, v201, v200
  s_waitcnt lgkmcnt(4)
  v_mfma_f32_16x16x32_bf16 v[120:123], v[176:179], v[168:171], v[120:123]
  ds_read_b128 v[196:199], v5 offset:11264
  v_mul_f32 v212, v212, v32
  v_mul_f32 v213, v213, v33
  v_mfma_f32_16x16x32_bf16 v[124:127], v[176:179], v[172:175], v[124:127]
  v_mul_f32 v214, v214, v34
  v_mul_f32 v215, v215, v35
  s_waitcnt lgkmcnt(4)
  v_mfma_f32_16x16x32_bf16 v[72:75], v[180:183], v[128:131], v[72:75]
  ds_read_b128 v[176:179], v5 offset:12288
  v_exp_f32 v212, v212
  v_mfma_f32_16x16x32_bf16 v[76:79], v[180:183], v[132:135], v[76:79]
  buffer_load_dwordx4 v[168:171], v2, s[40:43], s70 offen sc1
  buffer_load_dwordx4 v[172:175], v2, s[40:43], s70 offen offset:1024 sc1
  s_waitcnt lgkmcnt(4)
  v_mfma_f32_16x16x32_bf16 v[80:83], v[184:187], v[128:131], v[80:83]
  ds_read_b128 v[180:183], v5 offset:13312
  v_exp_f32 v213, v213
  v_mfma_f32_16x16x32_bf16 v[84:87], v[184:187], v[132:135], v[84:87]
  v_exp_f32 v214, v214
  s_waitcnt lgkmcnt(4)
  v_mfma_f32_16x16x32_bf16 v[88:91], v[188:191], v[128:131], v[88:91]
  ds_read_b128 v[184:187], v5 offset:14336
  v_exp_f32 v215, v215
  v_mfma_f32_16x16x32_bf16 v[92:95], v[188:191], v[132:135], v[92:95]
  v_mul_f32 v32, v32, v40
  v_mul_f32 v33, v33, v41
  v_mul_f32 v34, v34, v42
  s_waitcnt lgkmcnt(4)
  v_mfma_f32_16x16x32_bf16 v[96:99], v[192:195], v[128:131], v[96:99]
  ds_read_b128 v[188:191], v5 offset:15360
  v_mul_f32 v35, v35, v43
  v_fma_f32 v212, v212, v202, v202
  v_mfma_f32_16x16x32_bf16 v[100:103], v[192:195], v[132:135], v[100:103]
  v_fma_f32 v213, v213, v202, v202
  v_fma_f32 v214, v214, v202, v202
  v_fma_f32 v215, v215, v202, v202
  s_waitcnt lgkmcnt(4)
  v_mfma_f32_16x16x32_bf16 v[104:107], v[196:199], v[128:131], v[104:107]
  ds_read_b128 v[192:195], v5 offset:16384
  v_rcp_f32 v212, v212
  v_mfma_f32_16x16x32_bf16 v[108:111], v[196:199], v[132:135], v[108:111]
  s_waitcnt vmcnt(10)
  v_swap_b32 v138, v140
  v_swap_b32 v139, v141
  s_waitcnt lgkmcnt(4)
  v_mfma_f32_16x16x32_bf16 v[112:115], v[176:179], v[128:131], v[112:115]
  ds_read_b128 v[196:199], v5 offset:17408
  v_rcp_f32 v213, v213
  v_mfma_f32_16x16x32_bf16 v[116:119], v[176:179], v[132:135], v[116:119]
  v_rcp_f32 v214, v214
  s_waitcnt lgkmcnt(4)
  v_mfma_f32_16x16x32_bf16 v[120:123], v[180:183], v[128:131], v[120:123]
  ds_read_b128 v[176:179], v5 offset:18432
  v_rcp_f32 v215, v215
  v_mfma_f32_16x16x32_bf16 v[124:127], v[180:183], v[132:135], v[124:127]
  v_mul_f32 v32, v32, v212
  v_mul_f32 v33, v33, v213
  v_mul_f32 v34, v34, v214
  s_waitcnt lgkmcnt(4)
  v_mfma_f32_16x16x32_bf16 v[72:75], v[184:187], v[136:139], v[72:75]
  ds_read_b128 v[180:183], v5 offset:19456
  v_mul_f32 v35, v35, v215
  v_cvt_pk_bf16_f32 v208, v32, v33
  v_mfma_f32_16x16x32_bf16 v[76:79], v[184:187], v[140:143], v[76:79]
  buffer_load_dwordx4 v[128:131], v2, s[40:43], s71 offen sc1
  buffer_load_dwordx4 v[132:135], v2, s[40:43], s71 offen offset:1024 sc1
  v_cvt_pk_bf16_f32 v209, v34, v35
  s_waitcnt lgkmcnt(4)
  v_mfma_f32_16x16x32_bf16 v[80:83], v[188:191], v[136:139], v[80:83]
  ds_read_b128 v[184:187], v5 offset:20480
  v_mul_f32 v212, v36, v36
  v_mul_f32 v213, v37, v37
  v_mfma_f32_16x16x32_bf16 v[84:87], v[188:191], v[140:143], v[84:87]
  v_mul_f32 v214, v38, v38
  v_mul_f32 v215, v39, v39
  v_fma_f32 v212, v212, v204, v203
  s_waitcnt lgkmcnt(4)
  v_mfma_f32_16x16x32_bf16 v[88:91], v[192:195], v[136:139], v[88:91]
  ds_read_b128 v[188:191], v5 offset:21504
  v_fma_f32 v213, v213, v204, v203
  v_fma_f32 v214, v214, v204, v203
  v_mfma_f32_16x16x32_bf16 v[92:95], v[192:195], v[140:143], v[92:95]
  v_fma_f32 v215, v215, v204, v203
  v_mul_f32 v212, v212, v36
  v_mul_f32 v213, v213, v37
  s_waitcnt lgkmcnt(4)
  v_mfma_f32_16x16x32_bf16 v[96:99], v[196:199], v[136:139], v[96:99]
  ds_read_b128 v[192:195], v5 offset:22528
  v_mul_f32 v214, v214, v38
  v_mul_f32 v215, v215, v39
  v_mfma_f32_16x16x32_bf16 v[100:103], v[196:199], v[140:143], v[100:103]
  v_exp_f32 v212, v212
  s_waitcnt lgkmcnt(4)
  v_mfma_f32_16x16x32_bf16 v[104:107], v[176:179], v[136:139], v[104:107]
  ds_read_b128 v[196:199], v5 offset:23552
  v_exp_f32 v213, v213
  v_mfma_f32_16x16x32_bf16 v[108:111], v[176:179], v[140:143], v[108:111]
  s_waitcnt vmcnt(9)
  v_swap_b32 v146, v148
  v_swap_b32 v147, v149
  s_waitcnt lgkmcnt(4)
  v_mfma_f32_16x16x32_bf16 v[112:115], v[180:183], v[136:139], v[112:115]
  ds_read_b128 v[176:179], v5 offset:24576
  v_exp_f32 v214, v214
  v_mfma_f32_16x16x32_bf16 v[116:119], v[180:183], v[140:143], v[116:119]
  v_exp_f32 v215, v215
  v_mul_f32 v36, v36, v44
  s_waitcnt lgkmcnt(4)
  v_mfma_f32_16x16x32_bf16 v[120:123], v[184:187], v[136:139], v[120:123]
  ds_read_b128 v[180:183], v5 offset:25600
  v_mul_f32 v37, v37, v45
  v_mul_f32 v38, v38, v46
  v_mfma_f32_16x16x32_bf16 v[124:127], v[184:187], v[140:143], v[124:127]
  v_mul_f32 v39, v39, v47
  v_fma_f32 v212, v212, v205, v205
  v_fma_f32 v213, v213, v205, v205
  s_waitcnt lgkmcnt(4)
  v_mfma_f32_16x16x32_bf16 v[72:75], v[188:191], v[144:147], v[72:75]
  ds_read_b128 v[184:187], v5 offset:26624
  v_fma_f32 v214, v214, v205, v205
  v_fma_f32 v215, v215, v205, v205
  v_mfma_f32_16x16x32_bf16 v[76:79], v[188:191], v[148:151], v[76:79]
  buffer_load_dwordx4 v[136:139], v2, s[40:43], s72 offen sc1
  buffer_load_dwordx4 v[140:143], v2, s[40:43], s72 offen offset:1024 sc1
  s_waitcnt lgkmcnt(4)
  v_mfma_f32_16x16x32_bf16 v[80:83], v[192:195], v[144:147], v[80:83]
  ds_read_b128 v[188:191], v5 offset:27648
  v_rcp_f32 v212, v212
  v_mfma_f32_16x16x32_bf16 v[84:87], v[192:195], v[148:151], v[84:87]
  v_rcp_f32 v213, v213
  s_waitcnt lgkmcnt(4)
  v_mfma_f32_16x16x32_bf16 v[88:91], v[196:199], v[144:147], v[88:91]
  ds_read_b128 v[192:195], v5 offset:28672
  v_rcp_f32 v214, v214
  v_mfma_f32_16x16x32_bf16 v[92:95], v[196:199], v[148:151], v[92:95]
  v_rcp_f32 v215, v215
  v_mul_f32 v36, v36, v212
  s_waitcnt lgkmcnt(4)
  v_mfma_f32_16x16x32_bf16 v[96:99], v[176:179], v[144:147], v[96:99]
  ds_read_b128 v[196:199], v5 offset:29696
  v_mul_f32 v37, v37, v213
  v_mul_f32 v38, v38, v214
  v_mfma_f32_16x16x32_bf16 v[100:103], v[176:179], v[148:151], v[100:103]
  v_mul_f32 v39, v39, v215
  v_cvt_pk_bf16_f32 v210, v36, v37
  v_cvt_pk_bf16_f32 v211, v38, v39
  s_waitcnt lgkmcnt(4)
  v_mfma_f32_16x16x32_bf16 v[104:107], v[180:183], v[144:147], v[104:107]
  ds_read_b128 v[176:179], v5 offset:30720
  s_mov_b32 s80, 0x2201000
  buffer_store_dwordx4 v[208:211], v8, s[36:39], s80 offen sc1
  v_mfma_f32_16x16x32_bf16 v[108:111], v[180:183], v[148:151], v[108:111]
  s_waitcnt vmcnt(10)
  v_swap_b32 v154, v156
  v_swap_b32 v155, v157
  v_mul_f32 v212, v48, v48
  s_waitcnt lgkmcnt(4)
  v_mfma_f32_16x16x32_bf16 v[112:115], v[184:187], v[144:147], v[112:115]
  ds_read_b128 v[180:183], v5 offset:31744
  v_mul_f32 v213, v49, v49
  v_mul_f32 v214, v50, v50
  v_mfma_f32_16x16x32_bf16 v[116:119], v[184:187], v[148:151], v[116:119]
  v_mul_f32 v215, v51, v51
  v_fma_f32 v212, v212, v201, v200
  v_fma_f32 v213, v213, v201, v200
  s_waitcnt lgkmcnt(4)
  v_mfma_f32_16x16x32_bf16 v[120:123], v[188:191], v[144:147], v[120:123]
  ds_read_b128 v[184:187], v5 offset:32768
  v_fma_f32 v214, v214, v201, v200
  v_fma_f32 v215, v215, v201, v200
  v_mfma_f32_16x16x32_bf16 v[124:127], v[188:191], v[148:151], v[124:127]
  v_mul_f32 v212, v212, v48
  v_mul_f32 v213, v213, v49
  v_mul_f32 v214, v214, v50
  s_waitcnt lgkmcnt(4)
  v_mfma_f32_16x16x32_bf16 v[72:75], v[192:195], v[152:155], v[72:75]
  ds_read_b128 v[188:191], v5 offset:33792
  v_mul_f32 v215, v215, v51
  v_mfma_f32_16x16x32_bf16 v[76:79], v[192:195], v[156:159], v[76:79]
  buffer_load_dwordx4 v[144:147], v2, s[40:43], s73 offen sc1
  buffer_load_dwordx4 v[148:151], v2, s[40:43], s73 offen offset:1024 sc1
  s_waitcnt lgkmcnt(4)
  v_mfma_f32_16x16x32_bf16 v[80:83], v[196:199], v[152:155], v[80:83]
  ds_read_b128 v[192:195], v5 offset:34816
  v_exp_f32 v212, v212
  v_mfma_f32_16x16x32_bf16 v[84:87], v[196:199], v[156:159], v[84:87]
  v_exp_f32 v213, v213
  s_waitcnt lgkmcnt(4)
  v_mfma_f32_16x16x32_bf16 v[88:91], v[176:179], v[152:155], v[88:91]
  ds_read_b128 v[196:199], v5 offset:35840
  v_exp_f32 v214, v214
  v_mfma_f32_16x16x32_bf16 v[92:95], v[176:179], v[156:159], v[92:95]
  v_exp_f32 v215, v215
  v_mul_f32 v48, v48, v56
  s_waitcnt lgkmcnt(4)
  v_mfma_f32_16x16x32_bf16 v[96:99], v[180:183], v[152:155], v[96:99]
  ds_read_b128 v[176:179], v5 offset:36864
  v_mul_f32 v49, v49, v57
  v_mul_f32 v50, v50, v58
  v_mfma_f32_16x16x32_bf16 v[100:103], v[180:183], v[156:159], v[100:103]
  v_mul_f32 v51, v51, v59
  v_fma_f32 v212, v212, v202, v202
  v_fma_f32 v213, v213, v202, v202
  s_waitcnt lgkmcnt(4)
  v_mfma_f32_16x16x32_bf16 v[104:107], v[184:187], v[152:155], v[104:107]
  ds_read_b128 v[180:183], v5 offset:37888
  v_fma_f32 v214, v214, v202, v202
  v_fma_f32 v215, v215, v202, v202
  v_mfma_f32_16x16x32_bf16 v[108:111], v[184:187], v[156:159], v[108:111]
  s_waitcnt vmcnt(10)
  v_swap_b32 v162, v164
  v_swap_b32 v163, v165
  s_waitcnt lgkmcnt(4)
  v_mfma_f32_16x16x32_bf16 v[112:115], v[188:191], v[152:155], v[112:115]
  ds_read_b128 v[184:187], v5 offset:38912
  v_rcp_f32 v212, v212
  v_mfma_f32_16x16x32_bf16 v[116:119], v[188:191], v[156:159], v[116:119]
  v_rcp_f32 v213, v213
  s_waitcnt lgkmcnt(4)
  v_mfma_f32_16x16x32_bf16 v[120:123], v[192:195], v[152:155], v[120:123]
  ds_read_b128 v[188:191], v5 offset:39936
  v_rcp_f32 v214, v214
  v_mfma_f32_16x16x32_bf16 v[124:127], v[192:195], v[156:159], v[124:127]
  v_rcp_f32 v215, v215
  v_mul_f32 v48, v48, v212
  s_waitcnt lgkmcnt(4)
  v_mfma_f32_16x16x32_bf16 v[72:75], v[196:199], v[160:163], v[72:75]
  ds_read_b128 v[192:195], v5 offset:40960
  v_mul_f32 v49, v49, v213
  v_mul_f32 v50, v50, v214
  v_mfma_f32_16x16x32_bf16 v[76:79], v[196:199], v[164:167], v[76:79]
  buffer_load_dwordx4 v[152:155], v2, s[40:43], s74 offen sc1
  buffer_load_dwordx4 v[156:159], v2, s[40:43], s74 offen offset:1024 sc1
  v_mul_f32 v51, v51, v215
  s_waitcnt lgkmcnt(4)
  v_mfma_f32_16x16x32_bf16 v[80:83], v[176:179], v[160:163], v[80:83]
  ds_read_b128 v[196:199], v5 offset:41984
  v_cvt_pk_bf16_f32 v208, v48, v49
  v_cvt_pk_bf16_f32 v209, v50, v51
  v_mfma_f32_16x16x32_bf16 v[84:87], v[176:179], v[164:167], v[84:87]
  v_mul_f32 v212, v52, v52
  v_mul_f32 v213, v53, v53
  v_mul_f32 v214, v54, v54
  s_waitcnt lgkmcnt(4)
  v_mfma_f32_16x16x32_bf16 v[88:91], v[180:183], v[160:163], v[88:91]
  ds_read_b128 v[176:179], v5 offset:43008
  v_mul_f32 v215, v55, v55
  v_fma_f32 v212, v212, v204, v203
  v_mfma_f32_16x16x32_bf16 v[92:95], v[180:183], v[164:167], v[92:95]
  v_fma_f32 v213, v213, v204, v203
  v_fma_f32 v214, v214, v204, v203
  v_fma_f32 v215, v215, v204, v203
  s_waitcnt lgkmcnt(4)
  v_mfma_f32_16x16x32_bf16 v[96:99], v[184:187], v[160:163], v[96:99]
  ds_read_b128 v[180:183], v5 offset:44032
  v_mul_f32 v212, v212, v52
  v_mul_f32 v213, v213, v53
  v_mfma_f32_16x16x32_bf16 v[100:103], v[184:187], v[164:167], v[100:103]
  v_mul_f32 v214, v214, v54
  v_mul_f32 v215, v215, v55
  s_waitcnt lgkmcnt(4)
  v_mfma_f32_16x16x32_bf16 v[104:107], v[188:191], v[160:163], v[104:107]
  ds_read_b128 v[184:187], v5 offset:45056
  v_exp_f32 v212, v212
  v_mfma_f32_16x16x32_bf16 v[108:111], v[188:191], v[164:167], v[108:111]
  s_waitcnt vmcnt(9)
  v_swap_b32 v170, v172
  v_swap_b32 v171, v173
  s_waitcnt lgkmcnt(4)
  v_mfma_f32_16x16x32_bf16 v[112:115], v[192:195], v[160:163], v[112:115]
  ds_read_b128 v[188:191], v5 offset:46080
  v_exp_f32 v213, v213
  v_mfma_f32_16x16x32_bf16 v[116:119], v[192:195], v[164:167], v[116:119]
  v_exp_f32 v214, v214
  s_waitcnt lgkmcnt(4)
  v_mfma_f32_16x16x32_bf16 v[120:123], v[196:199], v[160:163], v[120:123]
  ds_read_b128 v[192:195], v5 offset:47104
  v_exp_f32 v215, v215
  v_mfma_f32_16x16x32_bf16 v[124:127], v[196:199], v[164:167], v[124:127]
  v_mul_f32 v52, v52, v60
  v_mul_f32 v53, v53, v61
  v_mul_f32 v54, v54, v62
  s_waitcnt lgkmcnt(4)
  v_mfma_f32_16x16x32_bf16 v[72:75], v[176:179], v[168:171], v[72:75]
  ds_read_b128 v[196:199], v5 offset:48128
  v_mul_f32 v55, v55, v63
  v_fma_f32 v212, v212, v205, v205
  v_mfma_f32_16x16x32_bf16 v[76:79], v[176:179], v[172:175], v[76:79]
  buffer_load_dwordx4 v[160:163], v2, s[40:43], s75 offen sc1
  buffer_load_dwordx4 v[164:167], v2, s[40:43], s75 offen offset:1024 sc1
  v_fma_f32 v213, v213, v205, v205
  s_waitcnt lgkmcnt(4)
  v_mfma_f32_16x16x32_bf16 v[80:83], v[180:183], v[168:171], v[80:83]
  ds_read_b128 v[176:179], v5 offset:49152
  v_fma_f32 v214, v214, v205, v205
  v_fma_f32 v215, v215, v205, v205
  v_mfma_f32_16x16x32_bf16 v[84:87], v[180:183], v[172:175], v[84:87]
  v_rcp_f32 v212, v212
  s_waitcnt lgkmcnt(4)
  v_mfma_f32_16x16x32_bf16 v[88:91], v[184:187], v[168:171], v[88:91]
  ds_read_b128 v[180:183], v5 offset:50176
  v_rcp_f32 v213, v213
  v_mfma_f32_16x16x32_bf16 v[92:95], v[184:187], v[172:175], v[92:95]
  v_rcp_f32 v214, v214
  s_waitcnt lgkmcnt(4)
  v_mfma_f32_16x16x32_bf16 v[96:99], v[188:191], v[168:171], v[96:99]
  ds_read_b128 v[184:187], v5 offset:51200
  v_rcp_f32 v215, v215
  v_mfma_f32_16x16x32_bf16 v[100:103], v[188:191], v[172:175], v[100:103]
  v_mul_f32 v52, v52, v212
  v_mul_f32 v53, v53, v213
  v_mul_f32 v54, v54, v214
  s_waitcnt lgkmcnt(4)
  v_mfma_f32_16x16x32_bf16 v[104:107], v[192:195], v[168:171], v[104:107]
  ds_read_b128 v[188:191], v5 offset:52224
  v_mul_f32 v55, v55, v215
  v_cvt_pk_bf16_f32 v210, v52, v53
  v_mfma_f32_16x16x32_bf16 v[108:111], v[192:195], v[172:175], v[108:111]
  s_waitcnt vmcnt(9)
  v_swap_b32 v130, v132
  v_swap_b32 v131, v133
  v_cvt_pk_bf16_f32 v211, v54, v55
  s_waitcnt lgkmcnt(4)
  v_mfma_f32_16x16x32_bf16 v[112:115], v[196:199], v[168:171], v[112:115]
  ds_read_b128 v[192:195], v5 offset:53248
  s_mov_b32 s80, 0x2202000
  buffer_store_dwordx4 v[208:211], v8, s[36:39], s80 offen sc1
  v_mfma_f32_16x16x32_bf16 v[116:119], v[196:199], v[172:175], v[116:119]
  s_sub_u32 s80, s32, s100
  s_lshl_b32 s80, s80, 11
  s_waitcnt lgkmcnt(4)
  v_mfma_f32_16x16x32_bf16 v[120:123], v[176:179], v[168:171], v[120:123]
  ds_read_b128 v[196:199], v5 offset:54272
  s_sub_u32 s81, s90, s30
  v_mfma_f32_16x16x32_bf16 v[124:127], v[176:179], v[172:175], v[124:127]
  s_lshl_b32 s81, s81, 14
  s_add_u32 s80, s80, s81
  s_waitcnt lgkmcnt(4)
  v_mfma_f32_16x16x32_bf16 v[72:75], v[180:183], v[128:131], v[72:75]
  ds_read_b128 v[176:179], v5 offset:55296
  s_add_u32 s80, s80, 0x82000
  v_mfma_f32_16x16x32_bf16 v[76:79], v[180:183], v[132:135], v[76:79]
  buffer_load_dwordx4 v[168:171], v2, s[40:43], s76 offen sc1
  buffer_load_dwordx4 v[172:175], v2, s[40:43], s76 offen offset:1024 sc1
  s_waitcnt lgkmcnt(4)
  v_mfma_f32_16x16x32_bf16 v[80:83], v[184:187], v[128:131], v[80:83]
  ds_read_b128 v[180:183], v5 offset:56320
  buffer_load_dwordx4 v[216:219], v13, s[36:39], s80 offen offset:0 sc1
  v_mfma_f32_16x16x32_bf16 v[84:87], v[184:187], v[132:135], v[84:87]
  buffer_load_dwordx4 v[220:223], v13, s[36:39], s80 offen offset:256 sc1
  s_waitcnt lgkmcnt(4)
  v_mfma_f32_16x16x32_bf16 v[88:91], v[188:191], v[128:131], v[88:91]
  ds_read_b128 v[184:187], v5 offset:57344
  v_mfma_f32_16x16x32_bf16 v[92:95], v[188:191], v[132:135], v[92:95]
  s_waitcnt lgkmcnt(4)
  v_mfma_f32_16x16x32_bf16 v[96:99], v[192:195], v[128:131], v[96:99]
  ds_read_b128 v[188:191], v5 offset:58368
  v_mfma_f32_16x16x32_bf16 v[100:103], v[192:195], v[132:135], v[100:103]
  s_waitcnt lgkmcnt(4)
  v_mfma_f32_16x16x32_bf16 v[104:107], v[196:199], v[128:131], v[104:107]
  ds_read_b128 v[192:195], v5 offset:59392
  v_mfma_f32_16x16x32_bf16 v[108:111], v[196:199], v[132:135], v[108:111]
  s_waitcnt vmcnt(12)
  v_swap_b32 v138, v140
  v_swap_b32 v139, v141
  s_waitcnt lgkmcnt(4)
  v_mfma_f32_16x16x32_bf16 v[112:115], v[176:179], v[128:131], v[112:115]
  ds_read_b128 v[196:199], v5 offset:60416
  v_mfma_f32_16x16x32_bf16 v[116:119], v[176:179], v[132:135], v[116:119]
  s_waitcnt lgkmcnt(4)
  v_mfma_f32_16x16x32_bf16 v[120:123], v[180:183], v[128:131], v[120:123]
  ds_read_b128 v[176:179], v5 offset:61440
  v_mfma_f32_16x16x32_bf16 v[124:127], v[180:183], v[132:135], v[124:127]
  s_waitcnt lgkmcnt(4)
  v_mfma_f32_16x16x32_bf16 v[72:75], v[184:187], v[136:139], v[72:75]
  ds_read_b128 v[180:183], v5 offset:62464
  v_mfma_f32_16x16x32_bf16 v[76:79], v[184:187], v[140:143], v[76:79]
  buffer_load_dwordx4 v[128:131], v2, s[40:43], s77 offen sc1
  buffer_load_dwordx4 v[132:135], v2, s[40:43], s77 offen offset:1024 sc1
  s_waitcnt lgkmcnt(4)
  v_mfma_f32_16x16x32_bf16 v[80:83], v[188:191], v[136:139], v[80:83]
  ds_read_b128 v[184:187], v5 offset:63488
  v_mfma_f32_16x16x32_bf16 v[84:87], v[188:191], v[140:143], v[84:87]
  s_waitcnt lgkmcnt(4)
  v_mfma_f32_16x16x32_bf16 v[88:91], v[192:195], v[136:139], v[88:91]
  ds_read_b128 v[188:191], v6 offset:0
  v_mfma_f32_16x16x32_bf16 v[92:95], v[192:195], v[140:143], v[92:95]
  s_waitcnt lgkmcnt(4)
  v_mfma_f32_16x16x32_bf16 v[96:99], v[196:199], v[136:139], v[96:99]
  ds_read_b128 v[192:195], v6 offset:1024
  v_mfma_f32_16x16x32_bf16 v[100:103], v[196:199], v[140:143], v[100:103]
  s_waitcnt lgkmcnt(4)
  v_mfma_f32_16x16x32_bf16 v[104:107], v[176:179], v[136:139], v[104:107]
  ds_read_b128 v[196:199], v6 offset:2048
  v_mfma_f32_16x16x32_bf16 v[108:111], v[176:179], v[140:143], v[108:111]
  s_waitcnt vmcnt(11)
  v_swap_b32 v146, v148
  v_swap_b32 v147, v149
  s_waitcnt lgkmcnt(4)
  v_mfma_f32_16x16x32_bf16 v[112:115], v[180:183], v[136:139], v[112:115]
  ds_read_b128 v[176:179], v6 offset:3072
  v_mfma_f32_16x16x32_bf16 v[116:119], v[180:183], v[140:143], v[116:119]
  s_waitcnt lgkmcnt(4)
  v_mfma_f32_16x16x32_bf16 v[120:123], v[184:187], v[136:139], v[120:123]
  ds_read_b128 v[180:183], v6 offset:4096
  v_mfma_f32_16x16x32_bf16 v[124:127], v[184:187], v[140:143], v[124:127]
  s_waitcnt lgkmcnt(4)
  v_mfma_f32_16x16x32_bf16 v[72:75], v[188:191], v[144:147], v[72:75]
  ds_read_b128 v[184:187], v6 offset:5120
  v_mfma_f32_16x16x32_bf16 v[76:79], v[188:191], v[148:151], v[76:79]
  buffer_load_dwordx4 v[136:139], v2, s[40:43], s78 offen sc1
  buffer_load_dwordx4 v[140:143], v2, s[40:43], s78 offen offset:1024 sc1
  s_waitcnt lgkmcnt(4)
  v_mfma_f32_16x16x32_bf16 v[80:83], v[192:195], v[144:147], v[80:83]
  ds_read_b128 v[188:191], v6 offset:6144
  v_mfma_f32_16x16x32_bf16 v[84:87], v[192:195], v[148:151], v[84:87]
  s_waitcnt lgkmcnt(4)
  v_mfma_f32_16x16x32_bf16 v[88:91], v[196:199], v[144:147], v[88:91]
  ds_read_b128 v[192:195], v6 offset:7168
  v_mfma_f32_16x16x32_bf16 v[92:95], v[196:199], v[148:151], v[92:95]
  s_waitcnt lgkmcnt(4)
  v_mfma_f32_16x16x32_bf16 v[96:99], v[176:179], v[144:147], v[96:99]
  ds_read_b128 v[196:199], v6 offset:8192
  v_mfma_f32_16x16x32_bf16 v[100:103], v[176:179], v[148:151], v[100:103]
  s_waitcnt lgkmcnt(4)
  v_mfma_f32_16x16x32_bf16 v[104:107], v[180:183], v[144:147], v[104:107]
  ds_read_b128 v[176:179], v6 offset:9216
  s_lshr_b32 s81, s91, 3
  v_mfma_f32_16x16x32_bf16 v[108:111], v[180:183], v[148:151], v[108:111]
  s_waitcnt vmcnt(11)
  v_swap_b32 v154, v156
  v_swap_b32 v155, v157
  s_waitcnt lgkmcnt(4)
  v_mfma_f32_16x16x32_bf16 v[112:115], v[184:187], v[144:147], v[112:115]
  ds_read_b128 v[180:183], v6 offset:10240
  s_lshl_b32 s80, s90, 3
  v_mfma_f32_16x16x32_bf16 v[116:119], v[184:187], v[148:151], v[116:119]
  s_add_u32 s80, s80, s81
  s_lshl_b32 s80, s80, 2
  s_waitcnt lgkmcnt(4)
  v_mfma_f32_16x16x32_bf16 v[120:123], v[188:191], v[144:147], v[120:123]
  ds_read_b128 v[184:187], v6 offset:11264
  s_add_u32 s80, s80, s32
  v_mfma_f32_16x16x32_bf16 v[124:127], v[188:191], v[148:151], v[124:127]
  s_lshl_b32 s80, s80, 7
  s_add_u32 s80, s80, 65536
  s_waitcnt vmcnt(8)
  s_waitcnt lgkmcnt(4)
  v_mfma_f32_16x16x32_bf16 v[72:75], v[192:195], v[152:155], v[72:75]
  ds_read_b128 v[188:191], v6 offset:12288
  v_or_b32 v230, s80, v206
  v_mfma_f32_16x16x32_bf16 v[76:79], v[192:195], v[156:159], v[76:79]
  buffer_load_dwordx4 v[144:147], v2, s[40:43], s79 offen sc1
  buffer_load_dwordx4 v[148:151], v2, s[40:43], s79 offen offset:1024 sc1
  s_waitcnt lgkmcnt(4)
  v_mfma_f32_16x16x32_bf16 v[80:83], v[196:199], v[152:155], v[80:83]
  ds_read_b128 v[192:195], v6 offset:13312
  v_mov_b32 v231, 1
  v_mfma_f32_16x16x32_bf16 v[84:87], v[196:199], v[156:159], v[84:87]
  buffer_atomic_add v231, v230, s[36:39], 0 offen sc1
  s_waitcnt vmcnt(7)
  v_add_f32 v216, v216, v220
  s_waitcnt lgkmcnt(4)
  v_mfma_f32_16x16x32_bf16 v[88:91], v[176:179], v[152:155], v[88:91]
  ds_read_b128 v[196:199], v6 offset:14336
  v_add_f32 v217, v217, v221
  v_mfma_f32_16x16x32_bf16 v[92:95], v[176:179], v[156:159], v[92:95]
  v_add_f32 v218, v218, v222
  v_add_f32 v219, v219, v223
  s_waitcnt lgkmcnt(4)
  v_mfma_f32_16x16x32_bf16 v[96:99], v[180:183], v[152:155], v[96:99]
  ds_read_b128 v[176:179], v6 offset:15360
  v_permlane32_swap_b32 v216, v218
  v_mfma_f32_16x16x32_bf16 v[100:103], v[180:183], v[156:159], v[100:103]
  v_permlane32_swap_b32 v217, v219
  v_add_f32 v216, v216, v218
  s_waitcnt lgkmcnt(4)
  v_mfma_f32_16x16x32_bf16 v[104:107], v[184:187], v[152:155], v[104:107]
  ds_read_b128 v[180:183], v6 offset:16384
  v_add_f32 v217, v217, v219
  v_mfma_f32_16x16x32_bf16 v[108:111], v[184:187], v[156:159], v[108:111]
  v_swap_b32 v162, v164
  v_swap_b32 v163, v165
  s_waitcnt lgkmcnt(4)
  v_mfma_f32_16x16x32_bf16 v[112:115], v[188:191], v[152:155], v[112:115]
  ds_read_b128 v[184:187], v6 offset:17408
  v_permlane16_swap_b32 v216, v217
  v_mfma_f32_16x16x32_bf16 v[116:119], v[188:191], v[156:159], v[116:119]
  v_add_f32 v216, v216, v217
  v_mov_b32 v217, v216
  s_waitcnt lgkmcnt(4)
  v_mfma_f32_16x16x32_bf16 v[120:123], v[192:195], v[152:155], v[120:123]
  ds_read_b128 v[188:191], v6 offset:18432
  v_permlane16_swap_b32 v216, v217
  v_mfma_f32_16x16x32_bf16 v[124:127], v[192:195], v[156:159], v[124:127]
  v_mov_b32 v218, v216
  v_mov_b32 v219, v217
  s_waitcnt lgkmcnt(4)
  v_mfma_f32_16x16x32_bf16 v[72:75], v[196:199], v[160:163], v[72:75]
  ds_read_b128 v[192:195], v6 offset:19456
  v_permlane32_swap_b32 v216, v218
  v_mfma_f32_16x16x32_bf16 v[76:79], v[196:199], v[164:167], v[76:79]
  v_permlane32_swap_b32 v217, v219
  v_mul_f32 v216, 0x3acccccd, v216
  s_waitcnt lgkmcnt(4)
  v_mfma_f32_16x16x32_bf16 v[80:83], v[176:179], v[160:163], v[80:83]
  ds_read_b128 v[196:199], v6 offset:20480
  v_mul_f32 v217, 0x3acccccd, v217
  v_mfma_f32_16x16x32_bf16 v[84:87], v[176:179], v[164:167], v[84:87]
  v_mul_f32 v218, 0x3acccccd, v218
  v_mul_f32 v219, 0x3acccccd, v219
  s_waitcnt lgkmcnt(4)
  v_mfma_f32_16x16x32_bf16 v[88:91], v[180:183], v[160:163], v[88:91]
  ds_read_b128 v[176:179], v6 offset:21504
  v_fma_f32 v217, -v216, v216, v217
  v_mfma_f32_16x16x32_bf16 v[92:95], v[180:183], v[164:167], v[92:95]
  v_fma_f32 v219, -v218, v218, v219
  v_max_f32 v217, 0, v217
  s_waitcnt lgkmcnt(4)
  v_mfma_f32_16x16x32_bf16 v[96:99], v[184:187], v[160:163], v[96:99]
  ds_read_b128 v[180:183], v6 offset:22528
  v_max_f32 v219, 0, v219
  v_mfma_f32_16x16x32_bf16 v[100:103], v[184:187], v[164:167], v[100:103]
  v_add_f32 v217, 0x3727c5ac, v217
  v_add_f32 v219, 0x3727c5ac, v219
  s_waitcnt lgkmcnt(4)
  v_mfma_f32_16x16x32_bf16 v[104:107], v[188:191], v[160:163], v[104:107]
  ds_read_b128 v[184:187], v6 offset:23552
  v_mfma_f32_16x16x32_bf16 v[108:111], v[188:191], v[164:167], v[108:111]
  v_swap_b32 v170, v172
  v_swap_b32 v171, v173
  s_waitcnt lgkmcnt(4)
  v_mfma_f32_16x16x32_bf16 v[112:115], v[192:195], v[160:163], v[112:115]
  ds_read_b128 v[188:191], v6 offset:24576
  v_mfma_f32_16x16x32_bf16 v[116:119], v[192:195], v[164:167], v[116:119]
  v_rsq_f32 v216, v217
  s_waitcnt lgkmcnt(4)
  v_mfma_f32_16x16x32_bf16 v[120:123], v[196:199], v[160:163], v[120:123]
  ds_read_b128 v[192:195], v6 offset:25600
  v_mfma_f32_16x16x32_bf16 v[124:127], v[196:199], v[164:167], v[124:127]
  v_rsq_f32 v218, v219
  s_waitcnt lgkmcnt(4)
  v_mfma_f32_16x16x32_bf16 v[72:75], v[176:179], v[168:171], v[72:75]
  ds_read_b128 v[196:199], v6 offset:26624
  v_mfma_f32_16x16x32_bf16 v[76:79], v[176:179], v[172:175], v[76:79]
  v_rcp_f32 v201, v217
  s_waitcnt lgkmcnt(4)
  v_mfma_f32_16x16x32_bf16 v[80:83], v[180:183], v[168:171], v[80:83]
  ds_read_b128 v[176:179], v6 offset:27648
  v_mfma_f32_16x16x32_bf16 v[84:87], v[180:183], v[172:175], v[84:87]
  v_rcp_f32 v204, v219
  s_waitcnt lgkmcnt(4)
  v_mfma_f32_16x16x32_bf16 v[88:91], v[184:187], v[168:171], v[88:91]
  ds_read_b128 v[180:183], v6 offset:28672
  v_mul_f32 v200, 0xc0135761, v216
  v_mfma_f32_16x16x32_bf16 v[92:95], v[184:187], v[172:175], v[92:95]
  v_mov_b32 v202, v217
  v_mul_f32 v203, 0xc0135761, v218
  s_waitcnt lgkmcnt(4)
  v_mfma_f32_16x16x32_bf16 v[96:99], v[188:191], v[168:171], v[96:99]
  ds_read_b128 v[184:187], v6 offset:29696
  v_mov_b32 v205, v219
  v_mfma_f32_16x16x32_bf16 v[100:103], v[188:191], v[172:175], v[100:103]
  v_mul_f32 v201, 0x3d372713, v201
  v_mul_f32 v204, 0x3d372713, v204
  s_waitcnt lgkmcnt(4)
  v_mfma_f32_16x16x32_bf16 v[104:107], v[192:195], v[168:171], v[104:107]
  ds_read_b128 v[188:191], v6 offset:30720
  v_mul_f32 v201, v201, v200
  v_mfma_f32_16x16x32_bf16 v[108:111], v[192:195], v[172:175], v[108:111]
  s_waitcnt vmcnt(5)
  v_swap_b32 v130, v132
  v_swap_b32 v131, v133
  s_waitcnt lgkmcnt(4)
  v_mfma_f32_16x16x32_bf16 v[112:115], v[196:199], v[168:171], v[112:115]
  ds_read_b128 v[192:195], v6 offset:31744
  v_mul_f32 v204, v204, v203
  v_mfma_f32_16x16x32_bf16 v[116:119], v[196:199], v[172:175], v[116:119]
  s_waitcnt lgkmcnt(4)
  v_mfma_f32_16x16x32_bf16 v[120:123], v[176:179], v[168:171], v[120:123]
  ds_read_b128 v[196:199], v6 offset:32768
  v_mfma_f32_16x16x32_bf16 v[124:127], v[176:179], v[172:175], v[124:127]
  s_waitcnt lgkmcnt(4)
  v_mfma_f32_16x16x32_bf16 v[72:75], v[180:183], v[128:131], v[72:75]
  ds_read_b128 v[176:179], v6 offset:33792
  v_mfma_f32_16x16x32_bf16 v[76:79], v[180:183], v[132:135], v[76:79]
  s_waitcnt lgkmcnt(4)
  v_mfma_f32_16x16x32_bf16 v[80:83], v[184:187], v[128:131], v[80:83]
  ds_read_b128 v[180:183], v6 offset:34816
  v_mfma_f32_16x16x32_bf16 v[84:87], v[184:187], v[132:135], v[84:87]
  s_waitcnt lgkmcnt(4)
  v_mfma_f32_16x16x32_bf16 v[88:91], v[188:191], v[128:131], v[88:91]
  ds_read_b128 v[184:187], v6 offset:35840
  v_mfma_f32_16x16x32_bf16 v[92:95], v[188:191], v[132:135], v[92:95]
  s_waitcnt lgkmcnt(4)
  v_mfma_f32_16x16x32_bf16 v[96:99], v[192:195], v[128:131], v[96:99]
  ds_read_b128 v[188:191], v6 offset:36864
  v_mfma_f32_16x16x32_bf16 v[100:103], v[192:195], v[132:135], v[100:103]
  s_waitcnt lgkmcnt(4)
  v_mfma_f32_16x16x32_bf16 v[104:107], v[196:199], v[128:131], v[104:107]
  ds_read_b128 v[192:195], v6 offset:37888
  v_mfma_f32_16x16x32_bf16 v[108:111], v[196:199], v[132:135], v[108:111]
  s_waitcnt vmcnt(3)
  v_swap_b32 v138, v140
  v_swap_b32 v139, v141
  s_waitcnt lgkmcnt(4)
  v_mfma_f32_16x16x32_bf16 v[112:115], v[176:179], v[128:131], v[112:115]
  ds_read_b128 v[196:199], v6 offset:38912
  v_mfma_f32_16x16x32_bf16 v[116:119], v[176:179], v[132:135], v[116:119]
  s_waitcnt lgkmcnt(4)
  v_mfma_f32_16x16x32_bf16 v[120:123], v[180:183], v[128:131], v[120:123]
  ds_read_b128 v[176:179], v6 offset:39936
  v_mfma_f32_16x16x32_bf16 v[124:127], v[180:183], v[132:135], v[124:127]
  s_waitcnt lgkmcnt(4)
  v_mfma_f32_16x16x32_bf16 v[72:75], v[184:187], v[136:139], v[72:75]
  ds_read_b128 v[180:183], v6 offset:40960
  v_mfma_f32_16x16x32_bf16 v[76:79], v[184:187], v[140:143], v[76:79]
  s_waitcnt lgkmcnt(4)
  v_mfma_f32_16x16x32_bf16 v[80:83], v[188:191], v[136:139], v[80:83]
  ds_read_b128 v[184:187], v6 offset:41984
  v_mfma_f32_16x16x32_bf16 v[84:87], v[188:191], v[140:143], v[84:87]
  s_lshl_b32 s80, s30, 3
  s_add_u32 s80, s80, s32
  s_waitcnt lgkmcnt(4)
  v_mfma_f32_16x16x32_bf16 v[88:91], v[192:195], v[136:139], v[88:91]
  ds_read_b128 v[188:191], v6 offset:43008
  s_lshl_b32 s80, s80, 2
  v_mfma_f32_16x16x32_bf16 v[92:95], v[192:195], v[140:143], v[92:95]
  s_add_u32 s80, s80, s100
  s_lshl_b32 s80, s80, 7
  s_waitcnt lgkmcnt(4)
  v_mfma_f32_16x16x32_bf16 v[96:99], v[196:199], v[136:139], v[96:99]
  ds_read_b128 v[192:195], v6 offset:44032
  s_add_u32 s80, s80, 65536
  v_mfma_f32_16x16x32_bf16 v[100:103], v[196:199], v[140:143], v[100:103]
  v_add_u32 v230, s80, v206
  buffer_load_dword v231, v230, s[36:39], 0 offen sc1
  s_waitcnt lgkmcnt(4)
  v_mfma_f32_16x16x32_bf16 v[104:107], v[176:179], v[136:139], v[104:107]
  ds_read_b128 v[196:199], v6 offset:45056
  v_mfma_f32_16x16x32_bf16 v[108:111], v[176:179], v[140:143], v[108:111]
  s_waitcnt vmcnt(2)
  v_swap_b32 v146, v148
  v_swap_b32 v147, v149
  s_waitcnt lgkmcnt(4)
  v_mfma_f32_16x16x32_bf16 v[112:115], v[180:183], v[136:139], v[112:115]
  ds_read_b128 v[176:179], v6 offset:46080
  v_mfma_f32_16x16x32_bf16 v[116:119], v[180:183], v[140:143], v[116:119]
  s_waitcnt lgkmcnt(4)
  v_mfma_f32_16x16x32_bf16 v[120:123], v[184:187], v[136:139], v[120:123]
  ds_read_b128 v[180:183], v6 offset:47104
  v_mfma_f32_16x16x32_bf16 v[124:127], v[184:187], v[140:143], v[124:127]
  s_waitcnt lgkmcnt(4)
  v_mfma_f32_16x16x32_bf16 v[72:75], v[188:191], v[144:147], v[72:75]
  ds_read_b128 v[184:187], v6 offset:48128
  v_mfma_f32_16x16x32_bf16 v[76:79], v[188:191], v[148:151], v[76:79]
  s_waitcnt lgkmcnt(4)
  v_mfma_f32_16x16x32_bf16 v[80:83], v[192:195], v[144:147], v[80:83]
  ds_read_b128 v[188:191], v6 offset:49152
  v_mfma_f32_16x16x32_bf16 v[84:87], v[192:195], v[148:151], v[84:87]
  s_waitcnt lgkmcnt(4)
  v_mfma_f32_16x16x32_bf16 v[88:91], v[196:199], v[144:147], v[88:91]
  v_mfma_f32_16x16x32_bf16 v[92:95], v[196:199], v[148:151], v[92:95]
  s_waitcnt lgkmcnt(3)
  v_mfma_f32_16x16x32_bf16 v[96:99], v[176:179], v[144:147], v[96:99]
  v_mfma_f32_16x16x32_bf16 v[100:103], v[176:179], v[148:151], v[100:103]
  s_waitcnt lgkmcnt(2)
  v_mfma_f32_16x16x32_bf16 v[104:107], v[180:183], v[144:147], v[104:107]
  v_mfma_f32_16x16x32_bf16 v[108:111], v[180:183], v[148:151], v[108:111]
  s_waitcnt lgkmcnt(1)
  v_mfma_f32_16x16x32_bf16 v[112:115], v[184:187], v[144:147], v[112:115]
  v_mfma_f32_16x16x32_bf16 v[116:119], v[184:187], v[148:151], v[116:119]
  s_waitcnt lgkmcnt(0)
  v_mfma_f32_16x16x32_bf16 v[120:123], v[188:191], v[144:147], v[120:123]
  v_mfma_f32_16x16x32_bf16 v[124:127], v[188:191], v[148:151], v[124:127]
  s_nop 6
  v_mul_f32 v212, v120, v120
  v_mul_f32 v213, v121, v121
  v_fma_f32 v212, v212, v201, v200
  v_fma_f32 v213, v213, v201, v200
  v_mul_f32 v212, v212, v120
  v_mul_f32 v213, v213, v121
  v_exp_f32 v212, v212
  v_exp_f32 v213, v213
  s_waitcnt vmcnt(0)
  v_cmp_gt_u32 vcc, 8, v231
  s_nop 0
  s_and_b32 vcc_lo, vcc_lo, 0x1
  s_cbranch_scc1 L_cp_31
L_cpb_32:
  s_add_u32 s44, s28, 0x2200000
  s_addc_u32 s45, s29, 0
  buffer_load_dwordx4 v[152:155], v3, s[44:47], s60 offen sc1
  v_mul_f32 v120, v120, v122
  v_mul_f32 v121, v121, v123
  v_fma_f32 v212, v212, v202, v202
  v_fma_f32 v213, v213, v202, v202
  v_rcp_f32 v212, v212
  v_rcp_f32 v213, v213
  buffer_load_dwordx4 v[156:159], v3, s[44:47], s60 offen offset:1024 sc1
  v_mul_f32 v120, v120, v212
  v_mul_f32 v121, v121, v213
  v_cvt_pk_bf16_f32 v208, v120, v121
  v_mul_f32 v212, v124, v124
  v_mul_f32 v213, v125, v125
  v_fma_f32 v212, v212, v204, v203
  v_fma_f32 v213, v213, v204, v203
  v_mul_f32 v212, v212, v124
  buffer_load_dwordx4 v[160:163], v3, s[44:47], s61 offen sc1
  v_mul_f32 v213, v213, v125
  v_exp_f32 v212, v212
  v_exp_f32 v213, v213
  v_mul_f32 v124, v124, v126
  v_mul_f32 v125, v125, v127
  v_fma_f32 v212, v212, v205, v205
  buffer_load_dwordx4 v[164:167], v3, s[44:47], s61 offen offset:1024 sc1
  v_fma_f32 v213, v213, v205, v205
  v_rcp_f32 v212, v212
  v_rcp_f32 v213, v213
  v_mul_f32 v124, v124, v212
  v_mul_f32 v125, v125, v213
  v_cvt_pk_bf16_f32 v209, v124, v125
  buffer_load_dwordx4 v[168:171], v3, s[44:47], s62 offen sc1
  s_nop 0
  v_permlane16_swap_b32 v208, v209
  s_mov_b32 s80, 0x2270000
  buffer_store_dwordx2 v[208:209], v9, s[36:39], s80 offen sc1
  v_mul_f32 v212, v72, v72
  v_mul_f32 v213, v73, v73
  v_mul_f32 v214, v74, v74
  v_mul_f32 v215, v75, v75
  v_fma_f32 v212, v212, v201, v200
  buffer_load_dwordx4 v[172:175], v3, s[44:47], s62 offen offset:1024 sc1
  v_fma_f32 v213, v213, v201, v200
  v_fma_f32 v214, v214, v201, v200
  v_fma_f32 v215, v215, v201, v200
  v_mul_f32 v212, v212, v72
  v_mul_f32 v213, v213, v73
  v_mul_f32 v214, v214, v74
  v_mul_f32 v215, v215, v75
  v_exp_f32 v212, v212
  buffer_load_dwordx4 v[128:131], v3, s[44:47], s63 offen sc1
  v_exp_f32 v213, v213
  v_exp_f32 v214, v214
  v_exp_f32 v215, v215
  v_mul_f32 v72, v72, v80
  buffer_load_dwordx4 v[132:135], v3, s[44:47], s63 offen offset:1024 sc1
  v_mul_f32 v73, v73, v81
  v_mul_f32 v74, v74, v82
  v_mul_f32 v75, v75, v83
  v_fma_f32 v212, v212, v202, v202
  v_fma_f32 v213, v213, v202, v202
  v_fma_f32 v214, v214, v202, v202
  v_fma_f32 v215, v215, v202, v202
  v_rcp_f32 v212, v212
  buffer_load_dwordx4 v[136:139], v3, s[44:47], s64 offen sc1
  v_rcp_f32 v213, v213
  v_rcp_f32 v214, v214
  v_rcp_f32 v215, v215
  v_mul_f32 v72, v72, v212
  buffer_load_dwordx4 v[140:143], v3, s[44:47], s64 offen offset:1024 sc1
  v_mul_f32 v73, v73, v213
  v_mul_f32 v74, v74, v214
  v_mul_f32 v75, v75, v215
  v_cvt_pk_bf16_f32 v208, v72, v73
  v_cvt_pk_bf16_f32 v209, v74, v75
  v_mul_f32 v212, v76, v76
  v_mul_f32 v213, v77, v77
  v_mul_f32 v214, v78, v78
  buffer_load_dwordx4 v[144:147], v3, s[44:47], s65 offen sc1
  v_mul_f32 v215, v79, v79
  v_fma_f32 v212, v212, v204, v203
  v_fma_f32 v213, v213, v204, v203
  v_fma_f32 v214, v214, v204, v203
  v_fma_f32 v215, v215, v204, v203
  v_mul_f32 v212, v212, v76
  v_mul_f32 v213, v213, v77
  v_mul_f32 v214, v214, v78
  buffer_load_dwordx4 v[148:151], v3, s[44:47], s65 offen offset:1024 sc1
  v_mul_f32 v215, v215, v79
  v_exp_f32 v212, v212
  v_exp_f32 v213, v213
  v_exp_f32 v214, v214
  v_exp_f32 v215, v215
  v_mul_f32 v76, v76, v84
  v_mul_f32 v77, v77, v85
  v_mul_f32 v78, v78, v86
  s_waitcnt vmcnt(11)
  v_swap_b32 v154, v156
  v_swap_b32 v155, v157
  s_nop 1
  v_mfma_f32_16x16x32_bf16 v[16:19], a[0:3], v[152:155], 0
  v_mul_f32 v79, v79, v87
  v_fma_f32 v212, v212, v205, v205
  v_fma_f32 v213, v213, v205, v205
  v_fma_f32 v214, v214, v205, v205
  v_mfma_f32_16x16x32_bf16 v[20:23], a[0:3], v[156:159], 0
  buffer_load_dwordx4 v[176:179], v3, s[44:47], s66 offen sc1
  buffer_load_dwordx4 v[180:183], v3, s[44:47], s66 offen offset:1024 sc1
  v_fma_f32 v215, v215, v205, v205
  v_mfma_f32_16x16x32_bf16 v[24:27], a[4:7], v[152:155], 0
  v_rcp_f32 v212, v212
  v_rcp_f32 v213, v213
  v_mfma_f32_16x16x32_bf16 v[28:31], a[4:7], v[156:159], 0
  v_rcp_f32 v214, v214
  v_rcp_f32 v215, v215
  v_mfma_f32_16x16x32_bf16 v[32:35], a[8:11], v[152:155], 0
  v_mul_f32 v76, v76, v212
  v_mul_f32 v77, v77, v213
  v_mul_f32 v78, v78, v214
  v_mul_f32 v79, v79, v215
  v_mfma_f32_16x16x32_bf16 v[36:39], a[8:11], v[156:159], 0
  v_cvt_pk_bf16_f32 v210, v76, v77
  v_cvt_pk_bf16_f32 v211, v78, v79
  s_mov_b32 s80, 0x2270000
  buffer_store_dwordx4 v[208:211], v8, s[36:39], s80 offen sc1
  v_mfma_f32_16x16x32_bf16 v[40:43], a[12:15], v[152:155], 0
  v_mul_f32 v212, v88, v88
  v_mul_f32 v213, v89, v89
  v_mul_f32 v214, v90, v90
  v_mul_f32 v215, v91, v91
  v_mfma_f32_16x16x32_bf16 v[44:47], a[12:15], v[156:159], 0
  s_waitcnt vmcnt(12)
  v_swap_b32 v162, v164
  v_swap_b32 v163, v165
  v_fma_f32 v212, v212, v201, v200
  v_fma_f32 v213, v213, v201, v200
  v_mfma_f32_16x16x32_bf16 v[48:51], a[16:19], v[152:155], 0
  v_fma_f32 v214, v214, v201, v200
  v_fma_f32 v215, v215, v201, v200
  v_mul_f32 v212, v212, v88
  v_mul_f32 v213, v213, v89
  v_mfma_f32_16x16x32_bf16 v[52:55], a[16:19], v[156:159], 0
  v_mul_f32 v214, v214, v90
  v_mul_f32 v215, v215, v91
  v_exp_f32 v212, v212
  v_mfma_f32_16x16x32_bf16 v[16:19], a[20:23], v[160:163], v[16:19]
  v_exp_f32 v213, v213
  v_exp_f32 v214, v214
  v_mfma_f32_16x16x32_bf16 v[20:23], a[20:23], v[164:167], v[20:23]
  buffer_load_dwordx4 v[184:187], v3, s[44:47], s67 offen sc1
  buffer_load_dwordx4 v[188:191], v3, s[44:47], s67 offen offset:1024 sc1
  v_exp_f32 v215, v215
  v_mfma_f32_16x16x32_bf16 v[24:27], a[24:27], v[160:163], v[24:27]
  v_mul_f32 v88, v88, v96
  v_mul_f32 v89, v89, v97
  v_mul_f32 v90, v90, v98
  v_mul_f32 v91, v91, v99
  v_mfma_f32_16x16x32_bf16 v[28:31], a[24:27], v[164:167], v[28:31]
  v_fma_f32 v212, v212, v202, v202
  v_fma_f32 v213, v213, v202, v202
  v_fma_f32 v214, v214, v202, v202
  v_fma_f32 v215, v215, v202, v202
  v_mfma_f32_16x16x32_bf16 v[32:35], a[28:31], v[160:163], v[32:35]
  v_rcp_f32 v212, v212
  v_rcp_f32 v213, v213
  v_mfma_f32_16x16x32_bf16 v[36:39], a[28:31], v[164:167], v[36:39]
  v_rcp_f32 v214, v214
  v_rcp_f32 v215, v215
  v_mfma_f32_16x16x32_bf16 v[40:43], a[32:35], v[160:163], v[40:43]
  v_mul_f32 v88, v88, v212
  v_mul_f32 v89, v89, v213
  v_mul_f32 v90, v90, v214
  v_mul_f32 v91, v91, v215
  v_mfma_f32_16x16x32_bf16 v[44:47], a[32:35], v[164:167], v[44:47]
  s_waitcnt vmcnt(11)
  v_swap_b32 v170, v172
  v_swap_b32 v171, v173
  v_cvt_pk_bf16_f32 v208, v88, v89
  v_cvt_pk_bf16_f32 v209, v90, v91
  v_mfma_f32_16x16x32_bf16 v[48:51], a[36:39], v[160:163], v[48:51]
  v_mul_f32 v212, v92, v92
  v_mul_f32 v213, v93, v93
  v_mul_f32 v214, v94, v94
  v_mul_f32 v215, v95, v95
  v_mfma_f32_16x16x32_bf16 v[52:55], a[36:39], v[164:167], v[52:55]
  v_fma_f32 v212, v212, v204, v203
  v_fma_f32 v213, v213, v204, v203
  v_fma_f32 v214, v214, v204, v203
  v_fma_f32 v215, v215, v204, v203
  v_mfma_f32_16x16x32_bf16 v[16:19], a[40:43], v[168:171], v[16:19]
  v_mul_f32 v212, v212, v92
  v_mul_f32 v213, v213, v93
  v_mul_f32 v214, v214, v94
  v_mul_f32 v215, v215, v95
  v_mfma_f32_16x16x32_bf16 v[20:23], a[40:43], v[172:175], v[20:23]
  buffer_load_dwordx4 v[192:195], v3, s[44:47], s68 offen sc1
  buffer_load_dwordx4 v[196:199], v3, s[44:47], s68 offen offset:1024 sc1
  v_exp_f32 v212, v212
  v_mfma_f32_16x16x32_bf16 v[24:27], a[44:47], v[168:171], v[24:27]
  v_exp_f32 v213, v213
  v_exp_f32 v214, v214
  v_mfma_f32_16x16x32_bf16 v[28:31], a[44:47], v[172:175], v[28:31]
  v_exp_f32 v215, v215
  v_mul_f32 v92, v92, v100
  v_mul_f32 v93, v93, v101
  v_mfma_f32_16x16x32_bf16 v[32:35], a[48:51], v[168:171], v[32:35]
  v_mul_f32 v94, v94, v102
  v_mul_f32 v95, v95, v103
  v_fma_f32 v212, v212, v205, v205
  v_fma_f32 v213, v213, v205, v205
  v_mfma_f32_16x16x32_bf16 v[36:39], a[48:51], v[172:175], v[36:39]
  v_fma_f32 v214, v214, v205, v205
  v_fma_f32 v215, v215, v205, v205
  v_rcp_f32 v212, v212
  v_mfma_f32_16x16x32_bf16 v[40:43], a[52:55], v[168:171], v[40:43]
  v_rcp_f32 v213, v213
  v_rcp_f32 v214, v214
  v_mfma_f32_16x16x32_bf16 v[44:47], a[52:55], v[172:175], v[44:47]
  s_waitcnt vmcnt(11)
  v_swap_b32 v130, v132
  v_swap_b32 v131, v133
  v_rcp_f32 v215, v215
  v_mfma_f32_16x16x32_bf16 v[48:51], a[56:59], v[168:171], v[48:51]
  v_mul_f32 v92, v92, v212
  v_mul_f32 v93, v93, v213
  v_mul_f32 v94, v94, v214
  v_mul_f32 v95, v95, v215
  v_mfma_f32_16x16x32_bf16 v[52:55], a[56:59], v[172:175], v[52:55]
  v_cvt_pk_bf16_f32 v210, v92, v93
  v_cvt_pk_bf16_f32 v211, v94, v95
  s_mov_b32 s80, 0x2271000
  buffer_store_dwordx4 v[208:211], v8, s[36:39], s80 offen sc1
  v_mfma_f32_16x16x32_bf16 v[16:19], a[60:63], v[128:131], v[16:19]
  v_mul_f32 v212, v104, v104
  v_mul_f32 v213, v105, v105
  v_mul_f32 v214, v106, v106
  v_mul_f32 v215, v107, v107
  v_mfma_f32_16x16x32_bf16 v[20:23], a[60:63], v[132:135], v[20:23]
  buffer_load_dwordx4 v[152:155], v3, s[44:47], s69 offen sc1
  buffer_load_dwordx4 v[156:159], v3, s[44:47], s69 offen offset:1024 sc1
  v_fma_f32 v212, v212, v201, v200
  v_fma_f32 v213, v213, v201, v200
  v_mfma_f32_16x16x32_bf16 v[24:27], a[64:67], v[128:131], v[24:27]
  v_fma_f32 v214, v214, v201, v200
  v_fma_f32 v215, v215, v201, v200
  v_mul_f32 v212, v212, v104
  v_mul_f32 v213, v213, v105
  v_mfma_f32_16x16x32_bf16 v[28:31], a[64:67], v[132:135], v[28:31]
  v_mul_f32 v214, v214, v106
  v_mul_f32 v215, v215, v107
  v_exp_f32 v212, v212
  v_mfma_f32_16x16x32_bf16 v[32:35], a[68:71], v[128:131], v[32:35]
  v_exp_f32 v213, v213
  v_exp_f32 v214, v214
  v_mfma_f32_16x16x32_bf16 v[36:39], a[68:71], v[132:135], v[36:39]
  v_exp_f32 v215, v215
  v_mul_f32 v104, v104, v112
  v_mul_f32 v105, v105, v113
  v_mfma_f32_16x16x32_bf16 v[40:43], a[72:75], v[128:131], v[40:43]
  v_mul_f32 v106, v106, v114
  v_mul_f32 v107, v107, v115
  v_fma_f32 v212, v212, v202, v202
  v_fma_f32 v213, v213, v202, v202
  v_mfma_f32_16x16x32_bf16 v[44:47], a[72:75], v[132:135], v[44:47]
  s_waitcnt vmcnt(12)
  v_swap_b32 v138, v140
  v_swap_b32 v139, v141
  v_fma_f32 v214, v214, v202, v202
  v_fma_f32 v215, v215, v202, v202
  v_mfma_f32_16x16x32_bf16 v[48:51], a[76:79], v[128:131], v[48:51]
  v_rcp_f32 v212, v212
  v_rcp_f32 v213, v213
  v_mfma_f32_16x16x32_bf16 v[52:55], a[76:79], v[132:135], v[52:55]
  v_rcp_f32 v214, v214
  v_rcp_f32 v215, v215
  v_mfma_f32_16x16x32_bf16 v[16:19], a[80:83], v[136:139], v[16:19]
  v_mul_f32 v104, v104, v212
  v_mul_f32 v105, v105, v213
  v_mul_f32 v106, v106, v214
  v_mul_f32 v107, v107, v215
  v_mfma_f32_16x16x32_bf16 v[20:23], a[80:83], v[140:143], v[20:23]
  buffer_load_dwordx4 v[160:163], v3, s[44:47], s70 offen sc1
  buffer_load_dwordx4 v[164:167], v3, s[44:47], s70 offen offset:1024 sc1
  v_cvt_pk_bf16_f32 v208, v104, v105
  v_cvt_pk_bf16_f32 v209, v106, v107
  v_mfma_f32_16x16x32_bf16 v[24:27], a[84:87], v[136:139], v[24:27]
  v_mul_f32 v212, v108, v108
  v_mul_f32 v213, v109, v109
  v_mul_f32 v214, v110, v110
  v_mul_f32 v215, v111, v111
  v_mfma_f32_16x16x32_bf16 v[28:31], a[84:87], v[140:143], v[28:31]
  v_fma_f32 v212, v212, v204, v203
  v_fma_f32 v213, v213, v204, v203
  v_fma_f32 v214, v214, v204, v203
  v_fma_f32 v215, v215, v204, v203
  v_mfma_f32_16x16x32_bf16 v[32:35], a[88:91], v[136:139], v[32:35]
  v_mul_f32 v212, v212, v108
  v_mul_f32 v213, v213, v109
  v_mul_f32 v214, v214, v110
  v_mul_f32 v215, v215, v111
  v_mfma_f32_16x16x32_bf16 v[36:39], a[88:91], v[140:143], v[36:39]
  v_exp_f32 v212, v212
  v_exp_f32 v213, v213
  v_mfma_f32_16x16x32_bf16 v[40:43], a[92:95], v[136:139], v[40:43]
  v_exp_f32 v214, v214
  v_exp_f32 v215, v215
  v_mfma_f32_16x16x32_bf16 v[44:47], a[92:95], v[140:143], v[44:47]
  s_waitcnt vmcnt(12)
  v_swap_b32 v146, v148
  v_swap_b32 v147, v149
  v_mul_f32 v108, v108, v116
  v_mul_f32 v109, v109, v117
  v_mfma_f32_16x16x32_bf16 v[48:51], a[96:99], v[136:139], v[48:51]
  v_mul_f32 v110, v110, v118
  v_mul_f32 v111, v111, v119
  v_fma_f32 v212, v212, v205, v205
  v_fma_f32 v213, v213, v205, v205
  v_mfma_f32_16x16x32_bf16 v[52:55], a[96:99], v[140:143], v[52:55]
  v_fma_f32 v214, v214, v205, v205
  v_fma_f32 v215, v215, v205, v205
  v_rcp_f32 v212, v212
  v_mfma_f32_16x16x32_bf16 v[16:19], a[100:103], v[144:147], v[16:19]
  v_rcp_f32 v213, v213
  v_rcp_f32 v214, v214
  v_mfma_f32_16x16x32_bf16 v[20:23], a[100:103], v[148:151], v[20:23]
  buffer_load_dwordx4 v[168:171], v3, s[44:47], s71 offen sc1
  buffer_load_dwordx4 v[172:175], v3, s[44:47], s71 offen offset:1024 sc1
  v_rcp_f32 v215, v215
  v_mfma_f32_16x16x32_bf16 v[24:27], a[104:107], v[144:147], v[24:27]
  v_mul_f32 v108, v108, v212
  v_mul_f32 v109, v109, v213
  v_mul_f32 v110, v110, v214
  v_mul_f32 v111, v111, v215
  v_mfma_f32_16x16x32_bf16 v[28:31], a[104:107], v[148:151], v[28:31]
  v_cvt_pk_bf16_f32 v210, v108, v109
  v_cvt_pk_bf16_f32 v211, v110, v111
  s_mov_b32 s80, 0x2272000
  buffer_store_dwordx4 v[208:211], v8, s[36:39], s80 offen sc1
  v_mfma_f32_16x16x32_bf16 v[32:35], a[108:111], v[144:147], v[32:35]
  v_mfma_f32_16x16x32_bf16 v[36:39], a[108:111], v[148:151], v[36:39]
  v_mfma_f32_16x16x32_bf16 v[40:43], a[112:115], v[144:147], v[40:43]
  v_mfma_f32_16x16x32_bf16 v[44:47], a[112:115], v[148:151], v[44:47]
  s_waitcnt vmcnt(13)
  v_swap_b32 v178, v180
  v_swap_b32 v179, v181
  v_mfma_f32_16x16x32_bf16 v[48:51], a[116:119], v[144:147], v[48:51]
  v_mfma_f32_16x16x32_bf16 v[52:55], a[116:119], v[148:151], v[52:55]
  v_mfma_f32_16x16x32_bf16 v[16:19], a[120:123], v[176:179], v[16:19]
  s_mov_b32 s83, 0x1800000
  buffer_load_dwordx4 v[56:59], v10, s[36:39], s83 offen sc1
  buffer_load_dword v60, v4, s[36:39], s83 offen sc1
  v_mfma_f32_16x16x32_bf16 v[20:23], a[120:123], v[180:183], v[20:23]
  buffer_load_dwordx4 v[128:131], v15, s[44:47], s72 offen sc1
  buffer_load_dwordx4 v[132:135], v15, s[44:47], s72 offen offset:1024 sc1
  v_mfma_f32_16x16x32_bf16 v[24:27], a[124:127], v[176:179], v[24:27]
  v_mfma_f32_16x16x32_bf16 v[28:31], a[124:127], v[180:183], v[28:31]
  v_mfma_f32_16x16x32_bf16 v[32:35], a[128:131], v[176:179], v[32:35]
  v_mfma_f32_16x16x32_bf16 v[36:39], a[128:131], v[180:183], v[36:39]
  v_mfma_f32_16x16x32_bf16 v[40:43], a[132:135], v[176:179], v[40:43]
  v_mfma_f32_16x16x32_bf16 v[44:47], a[132:135], v[180:183], v[44:47]
  s_waitcnt vmcnt(14)
  v_swap_b32 v186, v188
  v_swap_b32 v187, v189
  v_mfma_f32_16x16x32_bf16 v[48:51], a[136:139], v[176:179], v[48:51]
  v_mfma_f32_16x16x32_bf16 v[52:55], a[136:139], v[180:183], v[52:55]
  v_mfma_f32_16x16x32_bf16 v[16:19], a[140:143], v[184:187], v[16:19]
  v_mfma_f32_16x16x32_bf16 v[20:23], a[140:143], v[188:191], v[20:23]
  buffer_load_dwordx4 v[136:139], v15, s[44:47], s73 offen sc1
  buffer_load_dwordx4 v[140:143], v15, s[44:47], s73 offen offset:1024 sc1
  v_mfma_f32_16x16x32_bf16 v[24:27], a[144:147], v[184:187], v[24:27]
  v_mfma_f32_16x16x32_bf16 v[28:31], a[144:147], v[188:191], v[28:31]
  v_mfma_f32_16x16x32_bf16 v[32:35], a[148:151], v[184:187], v[32:35]
  v_mfma_f32_16x16x32_bf16 v[36:39], a[148:151], v[188:191], v[36:39]
  v_mfma_f32_16x16x32_bf16 v[40:43], a[152:155], v[184:187], v[40:43]
  v_mfma_f32_16x16x32_bf16 v[44:47], a[152:155], v[188:191], v[44:47]
  s_waitcnt vmcnt(14)
  v_swap_b32 v194, v196
  v_swap_b32 v195, v197
  v_mfma_f32_16x16x32_bf16 v[48:51], a[156:159], v[184:187], v[48:51]
  v_mfma_f32_16x16x32_bf16 v[52:55], a[156:159], v[188:191], v[52:55]
  v_mfma_f32_16x16x32_bf16 v[16:19], a[160:163], v[192:195], v[16:19]
  v_mfma_f32_16x16x32_bf16 v[20:23], a[160:163], v[196:199], v[20:23]
  v_mfma_f32_16x16x32_bf16 v[24:27], a[164:167], v[192:195], v[24:27]
  v_mfma_f32_16x16x32_bf16 v[28:31], a[164:167], v[196:199], v[28:31]
  v_mfma_f32_16x16x32_bf16 v[32:35], a[168:171], v[192:195], v[32:35]
  v_mfma_f32_16x16x32_bf16 v[36:39], a[168:171], v[196:199], v[36:39]
  v_mfma_f32_16x16x32_bf16 v[40:43], a[172:175], v[192:195], v[40:43]
  v_mfma_f32_16x16x32_bf16 v[44:47], a[172:175], v[196:199], v[44:47]
  s_waitcnt vmcnt(11)
  v_swap_b32 v154, v156
  v_swap_b32 v155, v157
  v_mfma_f32_16x16x32_bf16 v[48:51], a[176:179], v[192:195], v[48:51]
  v_mfma_f32_16x16x32_bf16 v[52:55], a[176:179], v[196:199], v[52:55]
  v_mfma_f32_16x16x32_bf16 v[16:19], a[180:183], v[152:155], v[16:19]
  v_mfma_f32_16x16x32_bf16 v[20:23], a[180:183], v[156:159], v[20:23]
  v_mfma_f32_16x16x32_bf16 v[24:27], a[184:187], v[152:155], v[24:27]
  v_mfma_f32_16x16x32_bf16 v[28:31], a[184:187], v[156:159], v[28:31]
  v_mfma_f32_16x16x32_bf16 v[32:35], a[188:191], v[152:155], v[32:35]
  v_mfma_f32_16x16x32_bf16 v[36:39], a[188:191], v[156:159], v[36:39]
  s_lshr_b32 s81, s91, 3
  s_lshl_b32 s80, s90, 3
  v_mfma_f32_16x16x32_bf16 v[40:43], a[192:195], v[152:155], v[40:43]
  s_add_u32 s80, s80, s81
  s_lshl_b32 s80, s80, 2
  v_mfma_f32_16x16x32_bf16 v[44:47], a[192:195], v[156:159], v[44:47]
  s_waitcnt vmcnt(9)
  v_swap_b32 v162, v164
  v_swap_b32 v163, v165
  v_mfma_f32_16x16x32_bf16 v[48:51], a[196:199], v[152:155], v[48:51]
  s_add_u32 s80, s80, s32
  s_lshl_b32 s80, s80, 7
  v_mfma_f32_16x16x32_bf16 v[52:55], a[196:199], v[156:159], v[52:55]
  s_add_u32 s80, s80, 67584
  s_waitcnt vmcnt(6)
  v_or_b32 v230, s80, v206
  v_mfma_f32_16x16x32_bf16 v[16:19], a[200:203], v[160:163], v[16:19]
  v_mov_b32 v231, 1
  buffer_atomic_add v231, v230, s[36:39], 0 offen sc1
  v_mfma_f32_16x16x32_bf16 v[20:23], a[200:203], v[164:167], v[20:23]
  v_mfma_f32_16x16x32_bf16 v[24:27], a[204:207], v[160:163], v[24:27]
  v_mfma_f32_16x16x32_bf16 v[28:31], a[204:207], v[164:167], v[28:31]
  v_mfma_f32_16x16x32_bf16 v[32:35], a[208:211], v[160:163], v[32:35]
  v_mfma_f32_16x16x32_bf16 v[36:39], a[208:211], v[164:167], v[36:39]
  v_mfma_f32_16x16x32_bf16 v[40:43], a[212:215], v[160:163], v[40:43]
  v_mfma_f32_16x16x32_bf16 v[44:47], a[212:215], v[164:167], v[44:47]
  v_swap_b32 v170, v172
  v_swap_b32 v171, v173
  v_mfma_f32_16x16x32_bf16 v[48:51], a[216:219], v[160:163], v[48:51]
  v_mfma_f32_16x16x32_bf16 v[52:55], a[216:219], v[164:167], v[52:55]
  v_mfma_f32_16x16x32_bf16 v[16:19], a[220:223], v[168:171], v[16:19]
  v_mfma_f32_16x16x32_bf16 v[20:23], a[220:223], v[172:175], v[20:23]
  v_mfma_f32_16x16x32_bf16 v[24:27], a[224:227], v[168:171], v[24:27]
  v_mfma_f32_16x16x32_bf16 v[28:31], a[224:227], v[172:175], v[28:31]
  v_mfma_f32_16x16x32_bf16 v[32:35], a[228:231], v[168:171], v[32:35]
  v_mfma_f32_16x16x32_bf16 v[36:39], a[228:231], v[172:175], v[36:39]
  v_mfma_f32_16x16x32_bf16 v[40:43], a[232:235], v[168:171], v[40:43]
  v_mfma_f32_16x16x32_bf16 v[44:47], a[232:235], v[172:175], v[44:47]
  s_waitcnt vmcnt(3)
  v_swap_b32 v130, v132
  v_swap_b32 v131, v133
  v_mfma_f32_16x16x32_bf16 v[48:51], a[236:239], v[168:171], v[48:51]
  v_mfma_f32_16x16x32_bf16 v[52:55], a[236:239], v[172:175], v[52:55]
  v_mfma_f32_16x16x32_bf16 v[16:19], a[240:243], v[128:131], v[16:19]
  v_mfma_f32_16x16x32_bf16 v[20:23], a[240:243], v[132:135], v[20:23]
  v_mfma_f32_16x16x32_bf16 v[24:27], a[244:247], v[128:131], v[24:27]
  v_mfma_f32_16x16x32_bf16 v[28:31], a[244:247], v[132:135], v[28:31]
  v_mfma_f32_16x16x32_bf16 v[32:35], a[248:251], v[128:131], v[32:35]
  v_mfma_f32_16x16x32_bf16 v[36:39], a[248:251], v[132:135], v[36:39]
  v_mfma_f32_16x16x32_bf16 v[40:43], a[252:255], v[128:131], v[40:43]
  v_mfma_f32_16x16x32_bf16 v[44:47], a[252:255], v[132:135], v[44:47]
  s_waitcnt vmcnt(1)
  v_swap_b32 v138, v140
  v_swap_b32 v139, v141
  v_mfma_f32_16x16x32_bf16 v[48:51], v[232:235], v[128:131], v[48:51]
  v_mfma_f32_16x16x32_bf16 v[52:55], v[232:235], v[132:135], v[52:55]
  v_mfma_f32_16x16x32_bf16 v[16:19], v[236:239], v[136:139], v[16:19]
  v_mfma_f32_16x16x32_bf16 v[20:23], v[236:239], v[140:143], v[20:23]
  v_mfma_f32_16x16x32_bf16 v[24:27], v[240:243], v[136:139], v[24:27]
  v_mfma_f32_16x16x32_bf16 v[28:31], v[240:243], v[140:143], v[28:31]
  v_mfma_f32_16x16x32_bf16 v[32:35], v[244:247], v[136:139], v[32:35]
  v_mfma_f32_16x16x32_bf16 v[36:39], v[244:247], v[140:143], v[36:39]
  v_mfma_f32_16x16x32_bf16 v[40:43], v[248:251], v[136:139], v[40:43]
  v_mfma_f32_16x16x32_bf16 v[44:47], v[248:251], v[140:143], v[44:47]
  v_mfma_f32_16x16x32_bf16 v[48:51], v[252:255], v[136:139], v[48:51]
  v_mfma_f32_16x16x32_bf16 v[52:55], v[252:255], v[140:143], v[52:55]
  s_lshl_b32 s80, s32, 12
  v_add_u32 v216, s80, v14
  v_xor_b32 v217, 0x2000, v216
  ds_write_b128 v216, v[32:35] offset:0
  ds_write_b128 v216, v[36:39] offset:1024
  ds_write_b128 v216, v[40:43] offset:2048
  ds_write_b128 v216, v[44:47] offset:3072
  v_xor_b32 v218, 0x3000, v216
  v_lshrrev_b32 v219, 4, v1
  v_xor_b32 v219, 2, v219
  v_and_b32 v220, 0xf0, v14
  v_lshl_add_u32 v219, v219, 12, v220
  s_lshl_b32 s80, s32, 8
  v_add_u32 v219, s80, v219
  s_waitcnt lgkmcnt(0)
  s_barrier
  ds_read_b128 v[96:99], v217 offset:2048
  ds_read_b128 v[100:103], v217 offset:3072
  ds_read_b128 v[88:91], v217 offset:0
  ds_read_b128 v[92:95], v217 offset:1024
  s_waitcnt lgkmcnt(3)
  v_pk_add_f32 v[24:25], v[24:25], v[96:97]
  v_pk_add_f32 v[26:27], v[26:27], v[98:99]
  s_waitcnt lgkmcnt(2)
  v_pk_add_f32 v[28:29], v[28:29], v[100:101]
  v_pk_add_f32 v[30:31], v[30:31], v[102:103]
  s_waitcnt lgkmcnt(0)
  ds_write_b128 v217, v[24:27] offset:0
  ds_write_b128 v217, v[28:31] offset:1024
  ds_write_b128 v217, v[48:51] offset:2048
  ds_write_b128 v217, v[52:55] offset:3072
  v_pk_add_f32 v[16:17], v[16:17], v[88:89]
  v_pk_add_f32 v[18:19], v[18:19], v[90:91]
  v_pk_add_f32 v[20:21], v[20:21], v[92:93]
  v_pk_add_f32 v[22:23], v[22:23], v[94:95]
  v_lshlrev_b32 v212, 16, v56
  v_and_b32 v213, 0xffff0000, v56
  v_pk_add_f32 v[16:17], v[16:17], v[212:213]
  v_lshlrev_b32 v214, 16, v57
  v_and_b32 v215, 0xffff0000, v57
  v_pk_add_f32 v[18:19], v[18:19], v[214:215]
  v_lshlrev_b32 v212, 16, v58
  v_and_b32 v213, 0xffff0000, v58
  v_pk_add_f32 v[20:21], v[20:21], v[212:213]
  v_lshlrev_b32 v214, 16, v59
  v_and_b32 v215, 0xffff0000, v59
  v_pk_add_f32 v[22:23], v[22:23], v[214:215]
  s_lshl_b32 s80, s30, 3
  s_add_u32 s80, s80, s32
  s_lshl_b32 s80, s80, 2
  s_add_u32 s80, s80, s100
  s_lshl_b32 s80, s80, 7
  s_add_u32 s80, s80, 67584
  v_add_u32 v230, s80, v206
  buffer_load_dword v231, v230, s[36:39], 0 offen sc1
  s_waitcnt lgkmcnt(0)
  s_barrier
  ds_read_b128 v[96:99], v219 offset:2048
  ds_read_b128 v[100:103], v219 offset:3072
  ds_read_b128 v[88:91], v218 offset:0
  ds_read_b128 v[92:95], v218 offset:1024
  v_lshlrev_b32 v24, 16, v60
  v_and_b32 v25, 0xffff0000, v60
  s_waitcnt lgkmcnt(2)
  v_permlane32_swap_b32 v96, v100
  v_permlane32_swap_b32 v97, v101
  v_permlane32_swap_b32 v98, v102
  v_permlane32_swap_b32 v99, v103
  v_pk_add_f32 v[96:97], v[96:97], v[100:101]
  v_pk_add_f32 v[98:99], v[98:99], v[102:103]
  s_waitcnt lgkmcnt(1)
  v_pk_add_f32 v[16:17], v[16:17], v[88:89]
  v_pk_add_f32 v[18:19], v[18:19], v[90:91]
  s_waitcnt lgkmcnt(0)
  v_pk_add_f32 v[20:21], v[20:21], v[92:93]
  v_pk_add_f32 v[22:23], v[22:23], v[94:95]
  v_permlane16_swap_b32 v96, v98
  v_permlane16_swap_b32 v97, v99
  v_pk_add_f32 v[24:25], v[24:25], v[96:97]
  v_pk_add_f32 v[24:25], v[24:25], v[98:99]
  s_waitcnt vmcnt(0)
  v_cmp_gt_u32 vcc, 8, v231
  s_nop 0
  s_and_b32 vcc_lo, vcc_lo, 0x1
  s_cbranch_scc1 L_cp_33
L_cpb_34:
  s_add_u32 s44, s28, 0x2270000
  s_addc_u32 s45, s29, 0
  buffer_load_dwordx4 v[144:147], v3, s[44:47], s60 offen sc1
  v_cvt_pk_bf16_f32 v26, v16, v17
  v_cvt_pk_bf16_f32 v27, v18, v19
  v_cvt_pk_bf16_f32 v28, v20, v21
  v_cvt_pk_bf16_f32 v29, v22, v23
  v_cvt_pk_bf16_f32 v30, v24, v25
  buffer_load_dwordx4 v[148:151], v3, s[44:47], s60 offen offset:1024 sc1
  v_and_b32 v216, 15, v1
  v_lshrrev_b32 v217, 4, v1
  v_mul_u32_u24 v216, 320, v216
  s_lshl_b32 s80, s32, 5
  v_lshl_add_u32 v218, v217, 3, v216
  buffer_load_dwordx4 v[176:179], v3, s[44:47], s61 offen sc1
  s_add_u32 s80, s80, 24576
  v_add_u32 v218, s80, v218
  ds_write2_b64 v218, v[26:27], v[28:29] offset0:0 offset1:20
  v_lshrrev_b32 v219, 1, v217
  v_mul_u32_u24 v219, 160, v219
  buffer_load_dwordx4 v[180:183], v3, s[44:47], s61 offen offset:1024 sc1
  v_and_b32 v217, 1, v217
  v_lshl_add_u32 v219, v217, 2, v219
  s_lshl_b32 s80, s32, 3
  v_add3_u32 v219, v219, v216, s80
  ds_write_b32 v219, v30 offset:24704
  buffer_load_dwordx4 v[184:187], v3, s[44:47], s62 offen sc1
  v_lshrrev_b32 v216, 3, v1
  v_and_b32 v217, 7, v1
  s_mul_i32 s80, s32, 1280
  v_mul_u32_u24 v218, 160, v216
  v_add_u32 v218, s80, v218
  buffer_load_dwordx4 v[188:191], v3, s[44:47], s62 offen offset:1024 sc1
  v_lshl_add_u32 v219, v217, 2, v218
  v_lshl_add_u32 v218, v217, 4, v218
  s_lshl_b32 s80, s30, 4
  s_lshl_b32 s81, s100, 2
  s_add_u32 s80, s80, s81
  buffer_load_dwordx4 v[192:195], v3, s[44:47], s63 offen sc1
  s_add_u32 s80, s80, s32
  s_mul_i32 s80, s80, 10240
  s_mul_i32 s81, s101, 160
  s_add_u32 s80, s80, s81
  v_mul_u32_u24 v216, 1280, v216
  buffer_load_dwordx4 v[196:199], v3, s[44:47], s63 offen offset:1024 sc1
  v_add_u32 v216, s80, v216
  v_lshl_add_u32 v220, v217, 2, v216
  v_lshl_add_u32 v216, v217, 4, v216
  s_mov_b32 s52, s24
  s_mov_b32 s53, s25
  buffer_load_dwordx4 v[152:155], v3, s[44:47], s64 offen sc1
  s_mov_b32 s54, 0x280000
  s_mov_b32 s55, 0x00020000
  s_waitcnt lgkmcnt(0)
  s_barrier
  ds_read_b128 v[224:227], v218 offset:24576
  ds_read_b32 v228, v219 offset:24704
  buffer_load_dwordx4 v[156:159], v3, s[44:47], s64 offen offset:1024 sc1
  s_mov_b32 s80, 0
  s_waitcnt lgkmcnt(1)
  buffer_store_dwordx4 v[224:227], v216, s[52:55], s80 offen
  s_waitcnt lgkmcnt(0)
  buffer_store_dword v228, v220, s[52:55], s80 offen offset:128
  buffer_load_dwordx4 v[160:163], v3, s[44:47], s65 offen sc1
  buffer_load_dwordx4 v[164:167], v3, s[44:47], s65 offen offset:1024 sc1
  s_waitcnt vmcnt(12)
  v_swap_b32 v146, v148
  v_swap_b32 v147, v149
  s_nop 1
  v_mfma_f32_16x16x32_bf16 v[72:75], a[0:3], v[144:147], 0
  v_mfma_f32_16x16x32_bf16 v[76:79], a[0:3], v[148:151], 0
  buffer_load_dwordx4 v[168:171], v3, s[44:47], s66 offen sc1
  buffer_load_dwordx4 v[172:175], v3, s[44:47], s66 offen offset:1024 sc1
  v_mfma_f32_16x16x32_bf16 v[80:83], a[4:7], v[144:147], 0
  v_mfma_f32_16x16x32_bf16 v[84:87], a[4:7], v[148:151], 0
  v_mfma_f32_16x16x32_bf16 v[88:91], a[8:11], v[144:147], 0
  v_mfma_f32_16x16x32_bf16 v[92:95], a[8:11], v[148:151], 0
  v_mfma_f32_16x16x32_bf16 v[96:99], a[12:15], v[144:147], 0
  v_mfma_f32_16x16x32_bf16 v[100:103], a[12:15], v[148:151], 0
  s_waitcnt vmcnt(12)
  v_swap_b32 v178, v180
  v_swap_b32 v179, v181
  v_mfma_f32_16x16x32_bf16 v[104:107], a[16:19], v[144:147], 0
  v_mfma_f32_16x16x32_bf16 v[108:111], a[16:19], v[148:151], 0
  v_mfma_f32_16x16x32_bf16 v[72:75], a[20:23], v[176:179], v[72:75]
  v_mfma_f32_16x16x32_bf16 v[76:79], a[20:23], v[180:183], v[76:79]
  buffer_load_dwordx4 v[128:131], v3, s[44:47], s67 offen sc1
  buffer_load_dwordx4 v[132:135], v3, s[44:47], s67 offen offset:1024 sc1
  v_mfma_f32_16x16x32_bf16 v[80:83], a[24:27], v[176:179], v[80:83]
  v_mfma_f32_16x16x32_bf16 v[84:87], a[24:27], v[180:183], v[84:87]
  v_mfma_f32_16x16x32_bf16 v[88:91], a[28:31], v[176:179], v[88:91]
  v_mfma_f32_16x16x32_bf16 v[92:95], a[28:31], v[180:183], v[92:95]
  v_mfma_f32_16x16x32_bf16 v[96:99], a[32:35], v[176:179], v[96:99]
  v_mfma_f32_16x16x32_bf16 v[100:103], a[32:35], v[180:183], v[100:103]
  s_waitcnt vmcnt(12)
  v_swap_b32 v186, v188
  v_swap_b32 v187, v189
  v_mfma_f32_16x16x32_bf16 v[104:107], a[36:39], v[176:179], v[104:107]
  v_mfma_f32_16x16x32_bf16 v[108:111], a[36:39], v[180:183], v[108:111]
  v_mfma_f32_16x16x32_bf16 v[72:75], a[40:43], v[184:187], v[72:75]
  v_mfma_f32_16x16x32_bf16 v[76:79], a[40:43], v[188:191], v[76:79]
  buffer_load_dwordx4 v[136:139], v3, s[44:47], s68 offen sc1
  buffer_load_dwordx4 v[140:143], v3, s[44:47], s68 offen offset:1024 sc1
  v_mfma_f32_16x16x32_bf16 v[80:83], a[44:47], v[184:187], v[80:83]
  v_mfma_f32_16x16x32_bf16 v[84:87], a[44:47], v[188:191], v[84:87]
  v_mfma_f32_16x16x32_bf16 v[88:91], a[48:51], v[184:187], v[88:91]
  v_mfma_f32_16x16x32_bf16 v[92:95], a[48:51], v[188:191], v[92:95]
  v_mfma_f32_16x16x32_bf16 v[96:99], a[52:55], v[184:187], v[96:99]
  v_mfma_f32_16x16x32_bf16 v[100:103], a[52:55], v[188:191], v[100:103]
  s_waitcnt vmcnt(12)
  v_swap_b32 v194, v196
  v_swap_b32 v195, v197
  v_mfma_f32_16x16x32_bf16 v[104:107], a[56:59], v[184:187], v[104:107]
  v_mfma_f32_16x16x32_bf16 v[108:111], a[56:59], v[188:191], v[108:111]
  v_mfma_f32_16x16x32_bf16 v[72:75], a[60:63], v[192:195], v[72:75]
  v_mfma_f32_16x16x32_bf16 v[76:79], a[60:63], v[196:199], v[76:79]
  buffer_load_dwordx4 v[144:147], v3, s[44:47], s69 offen sc1
  buffer_load_dwordx4 v[148:151], v3, s[44:47], s69 offen offset:1024 sc1
  v_mfma_f32_16x16x32_bf16 v[80:83], a[64:67], v[192:195], v[80:83]
  v_mfma_f32_16x16x32_bf16 v[84:87], a[64:67], v[196:199], v[84:87]
  v_mfma_f32_16x16x32_bf16 v[88:91], a[68:71], v[192:195], v[88:91]
  v_mfma_f32_16x16x32_bf16 v[92:95], a[68:71], v[196:199], v[92:95]
  v_mfma_f32_16x16x32_bf16 v[96:99], a[72:75], v[192:195], v[96:99]
  v_mfma_f32_16x16x32_bf16 v[100:103], a[72:75], v[196:199], v[100:103]
  s_waitcnt vmcnt(12)
  v_swap_b32 v154, v156
  v_swap_b32 v155, v157
  v_mfma_f32_16x16x32_bf16 v[104:107], a[76:79], v[192:195], v[104:107]
  v_mfma_f32_16x16x32_bf16 v[108:111], a[76:79], v[196:199], v[108:111]
  v_mfma_f32_16x16x32_bf16 v[72:75], a[80:83], v[152:155], v[72:75]
  v_mfma_f32_16x16x32_bf16 v[76:79], a[80:83], v[156:159], v[76:79]
  buffer_load_dwordx4 v[176:179], v3, s[44:47], s70 offen sc1
  buffer_load_dwordx4 v[180:183], v3, s[44:47], s70 offen offset:1024 sc1
  v_mfma_f32_16x16x32_bf16 v[80:83], a[84:87], v[152:155], v[80:83]
  v_mfma_f32_16x16x32_bf16 v[84:87], a[84:87], v[156:159], v[84:87]
  v_mfma_f32_16x16x32_bf16 v[88:91], a[88:91], v[152:155], v[88:91]
  v_mfma_f32_16x16x32_bf16 v[92:95], a[88:91], v[156:159], v[92:95]
  v_mfma_f32_16x16x32_bf16 v[96:99], a[92:95], v[152:155], v[96:99]
  v_mfma_f32_16x16x32_bf16 v[100:103], a[92:95], v[156:159], v[100:103]
  s_waitcnt vmcnt(10)
  v_swap_b32 v162, v164
  v_swap_b32 v163, v165
  v_mfma_f32_16x16x32_bf16 v[104:107], a[96:99], v[152:155], v[104:107]
  v_mfma_f32_16x16x32_bf16 v[108:111], a[96:99], v[156:159], v[108:111]
  v_mfma_f32_16x16x32_bf16 v[72:75], a[100:103], v[160:163], v[72:75]
  v_mfma_f32_16x16x32_bf16 v[76:79], a[100:103], v[164:167], v[76:79]
  buffer_load_dwordx4 v[184:187], v3, s[44:47], s71 offen sc1
  buffer_load_dwordx4 v[188:191], v3, s[44:47], s71 offen offset:1024 sc1
  v_mfma_f32_16x16x32_bf16 v[80:83], a[104:107], v[160:163], v[80:83]
  v_mfma_f32_16x16x32_bf16 v[84:87], a[104:107], v[164:167], v[84:87]
  v_mfma_f32_16x16x32_bf16 v[88:91], a[108:111], v[160:163], v[88:91]
  v_mfma_f32_16x16x32_bf16 v[92:95], a[108:111], v[164:167], v[92:95]
  v_mfma_f32_16x16x32_bf16 v[96:99], a[112:115], v[160:163], v[96:99]
  v_mfma_f32_16x16x32_bf16 v[100:103], a[112:115], v[164:167], v[100:103]
  s_waitcnt vmcnt(10)
  v_swap_b32 v170, v172
  v_swap_b32 v171, v173
  v_mfma_f32_16x16x32_bf16 v[104:107], a[116:119], v[160:163], v[104:107]
  v_mfma_f32_16x16x32_bf16 v[108:111], a[116:119], v[164:167], v[108:111]
  v_mfma_f32_16x16x32_bf16 v[72:75], a[120:123], v[168:171], v[72:75]
  s_mov_b32 s83, 0x1828000
  buffer_load_dwordx4 v[112:115], v10, s[36:39], s83 offen sc1
  buffer_load_dword v116, v4, s[36:39], s83 offen sc1
  v_mfma_f32_16x16x32_bf16 v[76:79], a[120:123], v[172:175], v[76:79]
  buffer_load_dwordx4 v[192:195], v15, s[44:47], s72 offen sc1
  buffer_load_dwordx4 v[196:199], v15, s[44:47], s72 offen offset:1024 sc1
  v_mfma_f32_16x16x32_bf16 v[80:83], a[124:127], v[168:171], v[80:83]
  v_mfma_f32_16x16x32_bf16 v[84:87], a[124:127], v[172:175], v[84:87]
  v_mfma_f32_16x16x32_bf16 v[88:91], a[128:131], v[168:171], v[88:91]
  v_mfma_f32_16x16x32_bf16 v[92:95], a[128:131], v[172:175], v[92:95]
  v_mfma_f32_16x16x32_bf16 v[96:99], a[132:135], v[168:171], v[96:99]
  v_mfma_f32_16x16x32_bf16 v[100:103], a[132:135], v[172:175], v[100:103]
  s_waitcnt vmcnt(12)
  v_swap_b32 v130, v132
  v_swap_b32 v131, v133
  v_mfma_f32_16x16x32_bf16 v[104:107], a[136:139], v[168:171], v[104:107]
  v_mfma_f32_16x16x32_bf16 v[108:111], a[136:139], v[172:175], v[108:111]
  v_mfma_f32_16x16x32_bf16 v[72:75], a[140:143], v[128:131], v[72:75]
  v_mfma_f32_16x16x32_bf16 v[76:79], a[140:143], v[132:135], v[76:79]
  buffer_load_dwordx4 v[152:155], v15, s[44:47], s73 offen sc1
  buffer_load_dwordx4 v[156:159], v15, s[44:47], s73 offen offset:1024 sc1
  v_mfma_f32_16x16x32_bf16 v[80:83], a[144:147], v[128:131], v[80:83]
  v_mfma_f32_16x16x32_bf16 v[84:87], a[144:147], v[132:135], v[84:87]
  v_mfma_f32_16x16x32_bf16 v[88:91], a[148:151], v[128:131], v[88:91]
  v_mfma_f32_16x16x32_bf16 v[92:95], a[148:151], v[132:135], v[92:95]
  v_mfma_f32_16x16x32_bf16 v[96:99], a[152:155], v[128:131], v[96:99]
  v_mfma_f32_16x16x32_bf16 v[100:103], a[152:155], v[132:135], v[100:103]
  s_waitcnt vmcnt(12)
  v_swap_b32 v138, v140
  v_swap_b32 v139, v141
  v_mfma_f32_16x16x32_bf16 v[104:107], a[156:159], v[128:131], v[104:107]
  v_mfma_f32_16x16x32_bf16 v[108:111], a[156:159], v[132:135], v[108:111]
  v_mfma_f32_16x16x32_bf16 v[72:75], a[160:163], v[136:139], v[72:75]
  v_mfma_f32_16x16x32_bf16 v[76:79], a[160:163], v[140:143], v[76:79]
  v_mfma_f32_16x16x32_bf16 v[80:83], a[164:167], v[136:139], v[80:83]
  v_mfma_f32_16x16x32_bf16 v[84:87], a[164:167], v[140:143], v[84:87]
  v_mfma_f32_16x16x32_bf16 v[88:91], a[168:171], v[136:139], v[88:91]
  v_mfma_f32_16x16x32_bf16 v[92:95], a[168:171], v[140:143], v[92:95]
  v_mfma_f32_16x16x32_bf16 v[96:99], a[172:175], v[136:139], v[96:99]
  v_mfma_f32_16x16x32_bf16 v[100:103], a[172:175], v[140:143], v[100:103]
  s_waitcnt vmcnt(10)
  v_swap_b32 v146, v148
  v_swap_b32 v147, v149
  v_mfma_f32_16x16x32_bf16 v[104:107], a[176:179], v[136:139], v[104:107]
  v_mfma_f32_16x16x32_bf16 v[108:111], a[176:179], v[140:143], v[108:111]
  v_mfma_f32_16x16x32_bf16 v[72:75], a[180:183], v[144:147], v[72:75]
  v_mfma_f32_16x16x32_bf16 v[76:79], a[180:183], v[148:151], v[76:79]
  v_mfma_f32_16x16x32_bf16 v[80:83], a[184:187], v[144:147], v[80:83]
  v_mfma_f32_16x16x32_bf16 v[84:87], a[184:187], v[148:151], v[84:87]
  v_mfma_f32_16x16x32_bf16 v[88:91], a[188:191], v[144:147], v[88:91]
  v_mfma_f32_16x16x32_bf16 v[92:95], a[188:191], v[148:151], v[92:95]
  v_mfma_f32_16x16x32_bf16 v[96:99], a[192:195], v[144:147], v[96:99]
  v_mfma_f32_16x16x32_bf16 v[100:103], a[192:195], v[148:151], v[100:103]
  s_waitcnt vmcnt(8)
  v_swap_b32 v178, v180
  v_swap_b32 v179, v181
  v_mfma_f32_16x16x32_bf16 v[104:107], a[196:199], v[144:147], v[104:107]
  v_mfma_f32_16x16x32_bf16 v[108:111], a[196:199], v[148:151], v[108:111]
  v_mfma_f32_16x16x32_bf16 v[72:75], a[200:203], v[176:179], v[72:75]
  v_mfma_f32_16x16x32_bf16 v[76:79], a[200:203], v[180:183], v[76:79]
  v_mfma_f32_16x16x32_bf16 v[80:83], a[204:207], v[176:179], v[80:83]
  v_mfma_f32_16x16x32_bf16 v[84:87], a[204:207], v[180:183], v[84:87]
  v_mfma_f32_16x16x32_bf16 v[88:91], a[208:211], v[176:179], v[88:91]
  v_mfma_f32_16x16x32_bf16 v[92:95], a[208:211], v[180:183], v[92:95]
  v_mfma_f32_16x16x32_bf16 v[96:99], a[212:215], v[176:179], v[96:99]
  v_mfma_f32_16x16x32_bf16 v[100:103], a[212:215], v[180:183], v[100:103]
  s_waitcnt vmcnt(6)
  v_swap_b32 v186, v188
  v_swap_b32 v187, v189
  v_mfma_f32_16x16x32_bf16 v[104:107], a[216:219], v[176:179], v[104:107]
  v_mfma_f32_16x16x32_bf16 v[108:111], a[216:219], v[180:183], v[108:111]
  v_mfma_f32_16x16x32_bf16 v[72:75], a[220:223], v[184:187], v[72:75]
  v_mfma_f32_16x16x32_bf16 v[76:79], a[220:223], v[188:191], v[76:79]
  v_mfma_f32_16x16x32_bf16 v[80:83], a[224:227], v[184:187], v[80:83]
  v_mfma_f32_16x16x32_bf16 v[84:87], a[224:227], v[188:191], v[84:87]
  v_mfma_f32_16x16x32_bf16 v[88:91], a[228:231], v[184:187], v[88:91]
  v_mfma_f32_16x16x32_bf16 v[92:95], a[228:231], v[188:191], v[92:95]
  v_mfma_f32_16x16x32_bf16 v[96:99], a[232:235], v[184:187], v[96:99]
  v_mfma_f32_16x16x32_bf16 v[100:103], a[232:235], v[188:191], v[100:103]
  s_waitcnt vmcnt(2)
  v_swap_b32 v194, v196
  v_swap_b32 v195, v197
  v_mfma_f32_16x16x32_bf16 v[104:107], a[236:239], v[184:187], v[104:107]
  v_mfma_f32_16x16x32_bf16 v[108:111], a[236:239], v[188:191], v[108:111]
  v_mfma_f32_16x16x32_bf16 v[72:75], a[240:243], v[192:195], v[72:75]
  v_mfma_f32_16x16x32_bf16 v[76:79], a[240:243], v[196:199], v[76:79]
  v_mfma_f32_16x16x32_bf16 v[80:83], a[244:247], v[192:195], v[80:83]
  v_mfma_f32_16x16x32_bf16 v[84:87], a[244:247], v[196:199], v[84:87]
  v_mfma_f32_16x16x32_bf16 v[88:91], a[248:251], v[192:195], v[88:91]
  v_mfma_f32_16x16x32_bf16 v[92:95], a[248:251], v[196:199], v[92:95]
  v_mfma_f32_16x16x32_bf16 v[96:99], a[252:255], v[192:195], v[96:99]
  v_mfma_f32_16x16x32_bf16 v[100:103], a[252:255], v[196:199], v[100:103]
  s_waitcnt vmcnt(0)
  v_swap_b32 v154, v156
  v_swap_b32 v155, v157
  v_mfma_f32_16x16x32_bf16 v[104:107], v[232:235], v[192:195], v[104:107]
  v_mfma_f32_16x16x32_bf16 v[108:111], v[232:235], v[196:199], v[108:111]
  v_mfma_f32_16x16x32_bf16 v[72:75], v[236:239], v[152:155], v[72:75]
  v_mfma_f32_16x16x32_bf16 v[76:79], v[236:239], v[156:159], v[76:79]
  v_mfma_f32_16x16x32_bf16 v[80:83], v[240:243], v[152:155], v[80:83]
  v_mfma_f32_16x16x32_bf16 v[84:87], v[240:243], v[156:159], v[84:87]
  v_mfma_f32_16x16x32_bf16 v[88:91], v[244:247], v[152:155], v[88:91]
  v_mfma_f32_16x16x32_bf16 v[92:95], v[244:247], v[156:159], v[92:95]
  v_mfma_f32_16x16x32_bf16 v[96:99], v[248:251], v[152:155], v[96:99]
  v_mfma_f32_16x16x32_bf16 v[100:103], v[248:251], v[156:159], v[100:103]
  v_mfma_f32_16x16x32_bf16 v[104:107], v[252:255], v[152:155], v[104:107]
  v_mfma_f32_16x16x32_bf16 v[108:111], v[252:255], v[156:159], v[108:111]
  s_lshl_b32 s80, s32, 12
  v_add_u32 v216, s80, v14
  v_xor_b32 v217, 0x2000, v216
  ds_write_b128 v216, v[88:91] offset:0
  ds_write_b128 v216, v[92:95] offset:1024
  ds_write_b128 v216, v[96:99] offset:2048
  ds_write_b128 v216, v[100:103] offset:3072
  v_xor_b32 v218, 0x3000, v216
  v_lshrrev_b32 v219, 4, v1
  v_xor_b32 v219, 2, v219
  v_and_b32 v220, 0xf0, v14
  v_lshl_add_u32 v219, v219, 12, v220
  s_lshl_b32 s80, s32, 8
  v_add_u32 v219, s80, v219
  s_waitcnt lgkmcnt(0)
  s_barrier
  ds_read_b128 v[40:43], v217 offset:2048
  ds_read_b128 v[44:47], v217 offset:3072
  ds_read_b128 v[32:35], v217 offset:0
  ds_read_b128 v[36:39], v217 offset:1024
  s_waitcnt lgkmcnt(3)
  v_pk_add_f32 v[80:81], v[80:81], v[40:41]
  v_pk_add_f32 v[82:83], v[82:83], v[42:43]
  s_waitcnt lgkmcnt(2)
  v_pk_add_f32 v[84:85], v[84:85], v[44:45]
  v_pk_add_f32 v[86:87], v[86:87], v[46:47]
  s_waitcnt lgkmcnt(0)
  ds_write_b128 v217, v[80:83] offset:0
  ds_write_b128 v217, v[84:87] offset:1024
  ds_write_b128 v217, v[104:107] offset:2048
  ds_write_b128 v217, v[108:111] offset:3072
  v_pk_add_f32 v[72:73], v[72:73], v[32:33]
  v_pk_add_f32 v[74:75], v[74:75], v[34:35]
  v_pk_add_f32 v[76:77], v[76:77], v[36:37]
  v_pk_add_f32 v[78:79], v[78:79], v[38:39]
  v_lshlrev_b32 v212, 16, v112
  v_and_b32 v213, 0xffff0000, v112
  v_pk_add_f32 v[72:73], v[72:73], v[212:213]
  v_lshlrev_b32 v214, 16, v113
  v_and_b32 v215, 0xffff0000, v113
  v_pk_add_f32 v[74:75], v[74:75], v[214:215]
  v_lshlrev_b32 v212, 16, v114
  v_and_b32 v213, 0xffff0000, v114
  v_pk_add_f32 v[76:77], v[76:77], v[212:213]
  v_lshlrev_b32 v214, 16, v115
  v_and_b32 v215, 0xffff0000, v115
  v_pk_add_f32 v[78:79], v[78:79], v[214:215]
  s_waitcnt lgkmcnt(0)
  s_barrier
  ds_read_b128 v[40:43], v219 offset:2048
  ds_read_b128 v[44:47], v219 offset:3072
  ds_read_b128 v[32:35], v218 offset:0
  ds_read_b128 v[36:39], v218 offset:1024
  v_lshlrev_b32 v80, 16, v116
  v_and_b32 v81, 0xffff0000, v116
  s_waitcnt lgkmcnt(2)
  v_permlane32_swap_b32 v40, v44
  v_permlane32_swap_b32 v41, v45
  v_permlane32_swap_b32 v42, v46
  v_permlane32_swap_b32 v43, v47
  v_pk_add_f32 v[40:41], v[40:41], v[44:45]
  v_pk_add_f32 v[42:43], v[42:43], v[46:47]
  s_waitcnt lgkmcnt(1)
  v_pk_add_f32 v[72:73], v[72:73], v[32:33]
  v_pk_add_f32 v[74:75], v[74:75], v[34:35]
  s_waitcnt lgkmcnt(0)
  v_pk_add_f32 v[76:77], v[76:77], v[36:37]
  v_pk_add_f32 v[78:79], v[78:79], v[38:39]
  v_permlane16_swap_b32 v40, v42
  v_permlane16_swap_b32 v41, v43
  v_pk_add_f32 v[80:81], v[80:81], v[40:41]
  v_pk_add_f32 v[80:81], v[80:81], v[42:43]
  v_cvt_pk_bf16_f32 v82, v72, v73
  v_cvt_pk_bf16_f32 v83, v74, v75
  v_cvt_pk_bf16_f32 v84, v76, v77
  v_cvt_pk_bf16_f32 v85, v78, v79
  v_cvt_pk_bf16_f32 v86, v80, v81
  v_and_b32 v216, 15, v1
  v_lshrrev_b32 v217, 4, v1
  v_mul_u32_u24 v216, 320, v216
  s_lshl_b32 s80, s32, 5
  v_lshl_add_u32 v218, v217, 3, v216
  s_add_u32 s80, s80, 32768
  v_add_u32 v218, s80, v218
  ds_write2_b64 v218, v[82:83], v[84:85] offset0:0 offset1:20
  v_lshrrev_b32 v219, 1, v217
  v_mul_u32_u24 v219, 160, v219
  v_and_b32 v217, 1, v217
  v_lshl_add_u32 v219, v217, 2, v219
  s_lshl_b32 s80, s32, 3
  v_add3_u32 v219, v219, v216, s80
  ds_write_b32 v219, v86 offset:32896
  v_lshrrev_b32 v216, 3, v1
  v_and_b32 v217, 7, v1
  s_mul_i32 s80, s32, 1280
  v_mul_u32_u24 v218, 160, v216
  v_add_u32 v218, s80, v218
  v_lshl_add_u32 v219, v217, 2, v218
  v_lshl_add_u32 v218, v217, 4, v218
  s_lshl_b32 s80, s30, 4
  s_lshl_b32 s81, s100, 2
  s_add_u32 s80, s80, s81
  s_add_u32 s80, s80, s32
  s_mul_i32 s80, s80, 10240
  s_mul_i32 s81, s101, 160
  s_add_u32 s80, s80, s81
  v_mul_u32_u24 v216, 1280, v216
  v_add_u32 v216, s80, v216
  v_lshl_add_u32 v220, v217, 2, v216
  v_lshl_add_u32 v216, v217, 4, v216
  s_mov_b32 s52, s24
  s_mov_b32 s53, s25
  s_mov_b32 s54, 0x280000
  s_mov_b32 s55, 0x00020000
  s_waitcnt lgkmcnt(0)
  s_barrier
  ds_read_b128 v[224:227], v218 offset:32768
  ds_read_b32 v228, v219 offset:32896
  s_mov_b32 s80, 1310720
  s_waitcnt lgkmcnt(1)
  buffer_store_dwordx4 v[224:227], v216, s[52:55], s80 offen
  s_waitcnt lgkmcnt(0)
  buffer_store_dword v228, v220, s[52:55], s80 offen offset:128
  s_waitcnt vmcnt(0)
  s_endpgm
L_prep:
  s_lshl_b32 s80, s2, 2
  s_add_u32 s80, s80, s32
  s_cmp_lg_u32 s80, 992
  s_cbranch_scc1 L_nr_35
  v_lshlrev_b32 v8, 7, v0
  v_mov_b32 v9, 0
  buffer_store_dword v9, v8, s[36:39], 0 offen sc1
  buffer_store_dword v9, v8, s[36:39], s61 offen sc1
  buffer_store_dword v9, v8, s[36:39], s78 offen sc1
  buffer_store_dword v9, v8, s[36:39], s79 offen sc1
  v_mov_b32 v8, 0
  v_mov_b32 v10, 1
  s_mov_b64 exec, 1
  s_waitcnt vmcnt(0)
  buffer_store_dword v10, v8, s[96:99], 0 offen sc1
  s_mov_b64 exec, -1
L_nr_35:
  s_cmp_lg_u32 s2, 249
  s_cbranch_scc1 L_nr_36
  v_lshlrev_b32 v8, 7, v0
  v_mov_b32 v9, 0
  buffer_store_dword v9, v8, s[36:39], s62 offen sc1
  buffer_store_dword v9, v8, s[36:39], s66 offen sc1
  buffer_store_dword v9, v8, s[36:39], s70 offen sc1
  buffer_store_dword v9, v8, s[36:39], s74 offen sc1
L_nr_36:
  s_sub_u32 s84, s2, 160
  s_cmp_lt_u32 s84, 54
  s_cbranch_scc1 L_wprep
  s_sub_u32 s84, s84, 54
  s_mov_b32 s52, s4
  s_mov_b32 s53, s5
  s_mov_b32 s54, 0x280000
  s_mov_b32 s55, 0x00020000
  s_lshl_b32 s80, s84, 2
  s_add_u32 s80, s80, s32
  s_mul_i32 s81, s80, 20480
  v_lshrrev_b32 v8, 3, v1
  v_and_b32 v9, 7, v1
  v_and_b32 v3, 6, v8
  v_xor_b32 v3, v3, v9
  v_mul_u32_u24 v2, 2560, v8
  v_lshl_add_u32 v2, v3, 4, v2
  v_add_u32 v2, s81, v2
  s_mul_i32 s82, s32, 20480
  s_add_u32 s82, s82, 1024
  s_add_i32 m0, s82, 0
  s_nop 0
  buffer_load_dwordx4 v2, s[52:55], 0 offen offset:0 nt lds
  s_add_i32 m0, s82, -256
  s_nop 0
  buffer_load_dwordx4 v2, s[52:55], 0 offen offset:1280 nt lds
  s_add_i32 m0, s82, 1920
  s_nop 0
  buffer_load_dwordx4 v2, s[52:55], 0 offen offset:128 nt lds
  s_add_i32 m0, s82, 1664
  s_nop 0
  buffer_load_dwordx4 v2, s[52:55], 0 offen offset:1408 nt lds
  s_add_i32 m0, s82, 3840
  s_nop 0
  buffer_load_dwordx4 v2, s[52:55], 0 offen offset:256 nt lds
  s_add_i32 m0, s82, 3584
  s_nop 0
  buffer_load_dwordx4 v2, s[52:55], 0 offen offset:1536 nt lds
  s_add_i32 m0, s82, 5760
  s_nop 0
  buffer_load_dwordx4 v2, s[52:55], 0 offen offset:384 nt lds
  s_add_i32 m0, s82, 5504
  s_nop 0
  buffer_load_dwordx4 v2, s[52:55], 0 offen offset:1664 nt lds
  s_add_i32 m0, s82, 7680
  s_nop 0
  buffer_load_dwordx4 v2, s[52:55], 0 offen offset:512 nt lds
  s_add_i32 m0, s82, 7424
  s_nop 0
  buffer_load_dwordx4 v2, s[52:55], 0 offen offset:1792 nt lds
  s_add_i32 m0, s82, 9600
  s_nop 0
  buffer_load_dwordx4 v2, s[52:55], 0 offen offset:640 nt lds
  s_add_i32 m0, s82, 9344
  s_nop 0
  buffer_load_dwordx4 v2, s[52:55], 0 offen offset:1920 nt lds
  s_add_i32 m0, s82, 11520
  s_nop 0
  buffer_load_dwordx4 v2, s[52:55], 0 offen offset:768 nt lds
  s_add_i32 m0, s82, 11264
  s_nop 0
  buffer_load_dwordx4 v2, s[52:55], 0 offen offset:2048 nt lds
  s_add_i32 m0, s82, 13440
  s_nop 0
  buffer_load_dwordx4 v2, s[52:55], 0 offen offset:896 nt lds
  s_add_i32 m0, s82, 13184
  s_nop 0
  buffer_load_dwordx4 v2, s[52:55], 0 offen offset:2176 nt lds
  s_add_i32 m0, s82, 15360
  s_nop 0
  buffer_load_dwordx4 v2, s[52:55], 0 offen offset:1024 nt lds
  s_add_i32 m0, s82, 15104
  s_nop 0
  buffer_load_dwordx4 v2, s[52:55], 0 offen offset:2304 nt lds
  s_add_i32 m0, s82, 17280
  s_nop 0
  buffer_load_dwordx4 v2, s[52:55], 0 offen offset:1152 nt lds
  s_add_i32 m0, s82, 17024
  s_nop 0
  buffer_load_dwordx4 v2, s[52:55], 0 offen offset:2432 nt lds
  v_lshrrev_b32 v3, 1, v8
  v_and_b32 v4, 6, v9
  v_xor_b32 v3, v3, v4
  v_lshlrev_b32 v3, 4, v3
  v_lshl_add_u32 v3, v9, 7, v3
  v_and_b32 v4, 1, v8
  v_lshl_add_u32 v3, v4, 3, v3
  v_add_u32 v3, s82, v3
  v_xor_b32 v4, 64, v3
  s_cmp_lt_u32 s84, 32
  s_cselect_b32 s83, 0, 0x80000000
  s_add_u32 s81, s81, 0x400000
  s_or_b32 s81, s81, s83
  v_lshl_add_u32 v5, v1, 4, s81
  v_add_u32 v7, 4096, v5
  s_lshl_b32 s80, s80, 7
  s_add_u32 s80, s80, 0x700000
  s_or_b32 s80, s80, s83
  v_lshl_add_u32 v6, v1, 4, s80
  v_cmp_gt_u32 vcc, 8, v1
  v_mov_b32 v8, 0x80000000
  s_nop 0
  v_cndmask_b32 v6, v8, v6, vcc
  v_mov_b32 v99, 0
  buffer_load_dword v99, v99, s[96:99], 0 offen sc1
  s_waitcnt vmcnt(1)
  ds_read2st64_b64 v[16:19], v3 offset0:0 offset1:2
  ds_read2st64_b64 v[20:23], v4 offset0:0 offset1:2
  ds_read2st64_b64 v[24:27], v3 offset0:4 offset1:6
  ds_read2st64_b64 v[28:31], v4 offset0:4 offset1:6
  ds_read2st64_b64 v[32:35], v3 offset0:8 offset1:10
  ds_read2st64_b64 v[36:39], v4 offset0:8 offset1:10
  ds_read2st64_b64 v[40:43], v3 offset0:12 offset1:14
  ds_read2st64_b64 v[44:47], v4 offset0:12 offset1:14
  ds_read2st64_b64 v[48:51], v3 offset0:16 offset1:18
  ds_read2st64_b64 v[52:55], v4 offset0:16 offset1:18
  ds_read2st64_b64 v[56:59], v3 offset0:20 offset1:22
  ds_read2st64_b64 v[60:63], v4 offset0:20 offset1:22
  ds_read2st64_b64 v[64:67], v3 offset0:24 offset1:26
  ds_read2st64_b64 v[68:71], v4 offset0:24 offset1:26
  ds_read2st64_b64 v[72:75], v3 offset0:28 offset1:30
  ds_read2st64_b64 v[76:79], v4 offset0:28 offset1:30
  ds_read2st64_b64 v[80:83], v3 offset0:32 offset1:34
  ds_read2st64_b64 v[84:87], v4 offset0:32 offset1:34
  ds_read2st64_b64 v[88:91], v3 offset0:36 offset1:38
  ds_read2st64_b64 v[92:95], v4 offset0:36 offset1:38
  s_mov_b32 s81, 0x3f803f80
  s_waitcnt lgkmcnt(15)
  buffer_store_dwordx4 v[16:19], v5, s[36:39], s60 offen offset:0 sc1
  v_dot2_f32_bf16 v8, v16, s81, 0
  v_dot2_f32_bf16 v9, v16, v16, 0
  v_dot2_f32_bf16 v10, v18, s81, 0
  v_dot2_f32_bf16 v11, v18, v18, 0
  v_dot2_f32_bf16 v8, v17, s81, v8
  v_dot2_f32_bf16 v9, v17, v17, v9
  v_dot2_f32_bf16 v10, v19, s81, v10
  v_dot2_f32_bf16 v11, v19, v19, v11
  s_waitcnt lgkmcnt(15)
  buffer_store_dwordx4 v[20:23], v5, s[36:39], s60 offen offset:1024 sc1
  v_dot2_f32_bf16 v8, v20, s81, v8
  v_dot2_f32_bf16 v9, v20, v20, v9
  v_dot2_f32_bf16 v10, v22, s81, v10
  v_dot2_f32_bf16 v11, v22, v22, v11
  v_dot2_f32_bf16 v8, v21, s81, v8
  v_dot2_f32_bf16 v9, v21, v21, v9
  v_dot2_f32_bf16 v10, v23, s81, v10
  v_dot2_f32_bf16 v11, v23, v23, v11
  s_waitcnt lgkmcnt(15)
  buffer_store_dwordx4 v[24:27], v5, s[36:39], s60 offen offset:2048 sc1
  v_dot2_f32_bf16 v8, v24, s81, v8
  v_dot2_f32_bf16 v9, v24, v24, v9
  v_dot2_f32_bf16 v10, v26, s81, v10
  v_dot2_f32_bf16 v11, v26, v26, v11
  v_dot2_f32_bf16 v8, v25, s81, v8
  v_dot2_f32_bf16 v9, v25, v25, v9
  v_dot2_f32_bf16 v10, v27, s81, v10
  v_dot2_f32_bf16 v11, v27, v27, v11
  s_waitcnt lgkmcnt(15)
  buffer_store_dwordx4 v[28:31], v5, s[36:39], s60 offen offset:3072 sc1
  v_dot2_f32_bf16 v8, v28, s81, v8
  v_dot2_f32_bf16 v9, v28, v28, v9
  v_dot2_f32_bf16 v10, v30, s81, v10
  v_dot2_f32_bf16 v11, v30, v30, v11
  v_dot2_f32_bf16 v8, v29, s81, v8
  v_dot2_f32_bf16 v9, v29, v29, v9
  v_dot2_f32_bf16 v10, v31, s81, v10
  v_dot2_f32_bf16 v11, v31, v31, v11
  s_waitcnt lgkmcnt(15)
  buffer_store_dwordx4 v[32:35], v7, s[36:39], s60 offen offset:0 sc1
  v_dot2_f32_bf16 v8, v32, s81, v8
  v_dot2_f32_bf16 v9, v32, v32, v9
  v_dot2_f32_bf16 v10, v34, s81, v10
  v_dot2_f32_bf16 v11, v34, v34, v11
  v_dot2_f32_bf16 v8, v33, s81, v8
  v_dot2_f32_bf16 v9, v33, v33, v9
  v_dot2_f32_bf16 v10, v35, s81, v10
  v_dot2_f32_bf16 v11, v35, v35, v11
  s_waitcnt lgkmcnt(14)
  buffer_store_dwordx4 v[36:39], v7, s[36:39], s60 offen offset:1024 sc1
  v_dot2_f32_bf16 v8, v36, s81, v8
  v_dot2_f32_bf16 v9, v36, v36, v9
  v_dot2_f32_bf16 v10, v38, s81, v10
  v_dot2_f32_bf16 v11, v38, v38, v11
  v_dot2_f32_bf16 v8, v37, s81, v8
  v_dot2_f32_bf16 v9, v37, v37, v9
  v_dot2_f32_bf16 v10, v39, s81, v10
  v_dot2_f32_bf16 v11, v39, v39, v11
  s_waitcnt lgkmcnt(13)
  buffer_store_dwordx4 v[40:43], v7, s[36:39], s60 offen offset:2048 sc1
  v_dot2_f32_bf16 v8, v40, s81, v8
  v_dot2_f32_bf16 v9, v40, v40, v9
  v_dot2_f32_bf16 v10, v42, s81, v10
  v_dot2_f32_bf16 v11, v42, v42, v11
  v_dot2_f32_bf16 v8, v41, s81, v8
  v_dot2_f32_bf16 v9, v41, v41, v9
  v_dot2_f32_bf16 v10, v43, s81, v10
  v_dot2_f32_bf16 v11, v43, v43, v11
  s_waitcnt lgkmcnt(12)
  buffer_store_dwordx4 v[44:47], v7, s[36:39], s60 offen offset:3072 sc1
  v_dot2_f32_bf16 v8, v44, s81, v8
  v_dot2_f32_bf16 v9, v44, v44, v9
  v_dot2_f32_bf16 v10, v46, s81, v10
  v_dot2_f32_bf16 v11, v46, v46, v11
  v_dot2_f32_bf16 v8, v45, s81, v8
  v_dot2_f32_bf16 v9, v45, v45, v9
  v_dot2_f32_bf16 v10, v47, s81, v10
  v_dot2_f32_bf16 v11, v47, v47, v11
  s_waitcnt lgkmcnt(11)
  buffer_store_dwordx4 v[48:51], v5, s[36:39], s61 offen offset:0 sc1
  v_dot2_f32_bf16 v8, v48, s81, v8
  v_dot2_f32_bf16 v9, v48, v48, v9
  v_dot2_f32_bf16 v10, v50, s81, v10
  v_dot2_f32_bf16 v11, v50, v50, v11
  v_dot2_f32_bf16 v8, v49, s81, v8
  v_dot2_f32_bf16 v9, v49, v49, v9
  v_dot2_f32_bf16 v10, v51, s81, v10
  v_dot2_f32_bf16 v11, v51, v51, v11
  s_waitcnt lgkmcnt(10)
  buffer_store_dwordx4 v[52:55], v5, s[36:39], s61 offen offset:1024 sc1
  v_dot2_f32_bf16 v8, v52, s81, v8
  v_dot2_f32_bf16 v9, v52, v52, v9
  v_dot2_f32_bf16 v10, v54, s81, v10
  v_dot2_f32_bf16 v11, v54, v54, v11
  v_dot2_f32_bf16 v8, v53, s81, v8
  v_dot2_f32_bf16 v9, v53, v53, v9
  v_dot2_f32_bf16 v10, v55, s81, v10
  v_dot2_f32_bf16 v11, v55, v55, v11
  s_waitcnt lgkmcnt(9)
  buffer_store_dwordx4 v[56:59], v5, s[36:39], s61 offen offset:2048 sc1
  v_dot2_f32_bf16 v8, v56, s81, v8
  v_dot2_f32_bf16 v9, v56, v56, v9
  v_dot2_f32_bf16 v10, v58, s81, v10
  v_dot2_f32_bf16 v11, v58, v58, v11
  v_dot2_f32_bf16 v8, v57, s81, v8
  v_dot2_f32_bf16 v9, v57, v57, v9
  v_dot2_f32_bf16 v10, v59, s81, v10
  v_dot2_f32_bf16 v11, v59, v59, v11
  s_waitcnt lgkmcnt(8)
  buffer_store_dwordx4 v[60:63], v5, s[36:39], s61 offen offset:3072 sc1
  v_dot2_f32_bf16 v8, v60, s81, v8
  v_dot2_f32_bf16 v9, v60, v60, v9
  v_dot2_f32_bf16 v10, v62, s81, v10
  v_dot2_f32_bf16 v11, v62, v62, v11
  v_dot2_f32_bf16 v8, v61, s81, v8
  v_dot2_f32_bf16 v9, v61, v61, v9
  v_dot2_f32_bf16 v10, v63, s81, v10
  v_dot2_f32_bf16 v11, v63, v63, v11
  s_waitcnt lgkmcnt(7)
  buffer_store_dwordx4 v[64:67], v7, s[36:39], s61 offen offset:0 sc1
  v_dot2_f32_bf16 v8, v64, s81, v8
  v_dot2_f32_bf16 v9, v64, v64, v9
  v_dot2_f32_bf16 v10, v66, s81, v10
  v_dot2_f32_bf16 v11, v66, v66, v11
  v_dot2_f32_bf16 v8, v65, s81, v8
  v_dot2_f32_bf16 v9, v65, v65, v9
  v_dot2_f32_bf16 v10, v67, s81, v10
  v_dot2_f32_bf16 v11, v67, v67, v11
  s_waitcnt lgkmcnt(6)
  buffer_store_dwordx4 v[68:71], v7, s[36:39], s61 offen offset:1024 sc1
  v_dot2_f32_bf16 v8, v68, s81, v8
  v_dot2_f32_bf16 v9, v68, v68, v9
  v_dot2_f32_bf16 v10, v70, s81, v10
  v_dot2_f32_bf16 v11, v70, v70, v11
  v_dot2_f32_bf16 v8, v69, s81, v8
  v_dot2_f32_bf16 v9, v69, v69, v9
  v_dot2_f32_bf16 v10, v71, s81, v10
  v_dot2_f32_bf16 v11, v71, v71, v11
  s_waitcnt lgkmcnt(5)
  buffer_store_dwordx4 v[72:75], v7, s[36:39], s61 offen offset:2048 sc1
  v_dot2_f32_bf16 v8, v72, s81, v8
  v_dot2_f32_bf16 v9, v72, v72, v9
  v_dot2_f32_bf16 v10, v74, s81, v10
  v_dot2_f32_bf16 v11, v74, v74, v11
  v_dot2_f32_bf16 v8, v73, s81, v8
  v_dot2_f32_bf16 v9, v73, v73, v9
  v_dot2_f32_bf16 v10, v75, s81, v10
  v_dot2_f32_bf16 v11, v75, v75, v11
  s_waitcnt lgkmcnt(4)
  buffer_store_dwordx4 v[76:79], v7, s[36:39], s61 offen offset:3072 sc1
  v_dot2_f32_bf16 v8, v76, s81, v8
  v_dot2_f32_bf16 v9, v76, v76, v9
  v_dot2_f32_bf16 v10, v78, s81, v10
  v_dot2_f32_bf16 v11, v78, v78, v11
  v_dot2_f32_bf16 v8, v77, s81, v8
  v_dot2_f32_bf16 v9, v77, v77, v9
  v_dot2_f32_bf16 v10, v79, s81, v10
  v_dot2_f32_bf16 v11, v79, v79, v11
  s_waitcnt lgkmcnt(3)
  buffer_store_dwordx4 v[80:83], v5, s[36:39], s62 offen offset:0 sc1
  v_dot2_f32_bf16 v8, v80, s81, v8
  v_dot2_f32_bf16 v9, v80, v80, v9
  v_dot2_f32_bf16 v10, v82, s81, v10
  v_dot2_f32_bf16 v11, v82, v82, v11
  v_dot2_f32_bf16 v8, v81, s81, v8
  v_dot2_f32_bf16 v9, v81, v81, v9
  v_dot2_f32_bf16 v10, v83, s81, v10
  v_dot2_f32_bf16 v11, v83, v83, v11
  s_waitcnt lgkmcnt(2)
  buffer_store_dwordx4 v[84:87], v5, s[36:39], s62 offen offset:1024 sc1
  v_dot2_f32_bf16 v8, v84, s81, v8
  v_dot2_f32_bf16 v9, v84, v84, v9
  v_dot2_f32_bf16 v10, v86, s81, v10
  v_dot2_f32_bf16 v11, v86, v86, v11
  v_dot2_f32_bf16 v8, v85, s81, v8
  v_dot2_f32_bf16 v9, v85, v85, v9
  v_dot2_f32_bf16 v10, v87, s81, v10
  v_dot2_f32_bf16 v11, v87, v87, v11
  s_waitcnt lgkmcnt(1)
  buffer_store_dwordx4 v[88:91], v5, s[36:39], s62 offen offset:2048 sc1
  v_dot2_f32_bf16 v8, v88, s81, v8
  v_dot2_f32_bf16 v9, v88, v88, v9
  v_dot2_f32_bf16 v10, v90, s81, v10
  v_dot2_f32_bf16 v11, v90, v90, v11
  v_dot2_f32_bf16 v8, v89, s81, v8
  v_dot2_f32_bf16 v9, v89, v89, v9
  v_dot2_f32_bf16 v10, v91, s81, v10
  v_dot2_f32_bf16 v11, v91, v91, v11
  s_waitcnt lgkmcnt(0)
  buffer_store_dwordx4 v[92:95], v5, s[36:39], s62 offen offset:3072 sc1
  v_dot2_f32_bf16 v8, v92, s81, v8
  v_dot2_f32_bf16 v9, v92, v92, v9
  v_dot2_f32_bf16 v10, v94, s81, v10
  v_dot2_f32_bf16 v11, v94, v94, v11
  v_dot2_f32_bf16 v8, v93, s81, v8
  v_dot2_f32_bf16 v9, v93, v93, v9
  v_dot2_f32_bf16 v10, v95, s81, v10
  v_dot2_f32_bf16 v11, v95, v95, v11
  v_add_f32_dpp v8, v8, v8 row_ror:8 row_mask:0xf bank_mask:0xf
  v_add_f32_dpp v9, v9, v9 row_ror:8 row_mask:0xf bank_mask:0xf
  v_add_f32_dpp v10, v10, v10 row_ror:8 row_mask:0xf bank_mask:0xf
  v_add_f32_dpp v11, v11, v11 row_ror:8 row_mask:0xf bank_mask:0xf
  v_mov_b32 v12, v8
  v_mov_b32 v13, v9
  v_mov_b32 v14, v10
  v_mov_b32 v15, v11
  v_permlane16_swap_b32 v8, v12
  v_permlane16_swap_b32 v9, v13
  v_permlane16_swap_b32 v10, v14
  v_permlane16_swap_b32 v11, v15
  v_add_f32 v8, v8, v12
  v_add_f32 v9, v9, v13
  v_add_f32 v10, v10, v14
  v_add_f32 v11, v11, v15
  v_mov_b32 v12, v8
  v_mov_b32 v13, v9
  v_mov_b32 v14, v10
  v_mov_b32 v15, v11
  v_permlane32_swap_b32 v8, v12
  v_permlane32_swap_b32 v9, v13
  v_permlane32_swap_b32 v10, v14
  v_permlane32_swap_b32 v11, v15
  v_add_f32 v8, v8, v12
  v_add_f32 v9, v9, v13
  v_add_f32 v10, v10, v14
  v_add_f32 v11, v11, v15
  v_mul_f32 v12, 0x3acccccd, v8
  v_mul_f32 v9, 0x3acccccd, v9
  v_fma_f32 v9, -v12, v12, v9
  v_max_f32 v9, 0, v9
  v_add_f32 v9, 0x3727c5ac, v9
  v_rsq_f32 v8, v9
  s_nop 0
  v_mul_f32 v9, -v12, v8
  v_mul_f32 v14, 0x3acccccd, v10
  v_mul_f32 v11, 0x3acccccd, v11
  v_fma_f32 v11, -v14, v14, v11
  v_max_f32 v11, 0, v11
  v_add_f32 v11, 0x3727c5ac, v11
  v_rsq_f32 v10, v11
  s_nop 0
  v_mul_f32 v11, -v14, v10
  buffer_store_dwordx4 v[8:11], v6, s[36:39], 0 offen sc1
  s_waitcnt vmcnt(0)
  v_readfirstlane_b32 s80, v99
  s_nop 0
  s_cmp_eq_u32 s80, 0
  s_cbranch_scc1 L_rc_37
L_rcb_38:
  s_mov_b32 s80, 159744
  s_barrier
  v_lshl_add_u32 v8, v1, 7, s80
  v_mov_b32 v9, 1
  s_cmp_eq_u32 s32, 0
  s_cselect_b32 exec_lo, 0xffff, 0
  s_mov_b32 exec_hi, 0
  buffer_atomic_add v9, v8, s[36:39], 0 offen sc1
  s_mov_b64 exec, -1
  s_branch L_tail
L_wprep:
  v_lshrrev_b32 v8, 3, v1
  v_and_b32 v9, 7, v1
  s_and_b32 s85, s84, 1
  s_lshr_b32 s86, s84, 1
  s_cmp_eq_u32 s85, 0
  s_cselect_b32 s40, s18, s20
  s_cselect_b32 s41, s19, s21
  s_mov_b32 s42, 2211840
  s_mov_b32 s43, 0x00020000
  s_mul_i32 s80, s32, 552960
  s_lshl_b32 s81, s86, 7
  s_add_u32 s80, s80, s81
  v_and_b32 v3, 2, v8
  v_xor_b32 v3, v3, v9
  v_mul_u32_u24 v2, 3456, v8
  v_add_u32 v2, s80, v2
  v_xor_b32 v4, 4, v3
  v_lshl_add_u32 v4, v4, 4, v2
  v_lshl_add_u32 v2, v3, 4, v2
  s_mul_i32 s83, s32, 20480
  s_add_u32 m0, s83, 0
  s_mov_b32 s80, 0
  buffer_load_dwordx4 v2, s[40:43], s80 offen nt lds
  s_add_u32 m0, s83, 1024
  s_mov_b32 s80, 27648
  buffer_load_dwordx4 v4, s[40:43], s80 offen nt lds
  s_add_u32 m0, s83, 2048
  s_mov_b32 s80, 55296
  buffer_load_dwordx4 v2, s[40:43], s80 offen nt lds
  s_add_u32 m0, s83, 3072
  s_mov_b32 s80, 82944
  buffer_load_dwordx4 v4, s[40:43], s80 offen nt lds
  s_add_u32 m0, s83, 4096
  s_mov_b32 s80, 110592
  buffer_load_dwordx4 v2, s[40:43], s80 offen nt lds
  s_add_u32 m0, s83, 5120
  s_mov_b32 s80, 138240
  buffer_load_dwordx4 v4, s[40:43], s80 offen nt lds
  s_add_u32 m0, s83, 6144
  s_mov_b32 s80, 165888
  buffer_load_dwordx4 v2, s[40:43], s80 offen nt lds
  s_add_u32 m0, s83, 7168
  s_mov_b32 s80, 193536
  buffer_load_dwordx4 v4, s[40:43], s80 offen nt lds
  s_add_u32 m0, s83, 8192
  s_mov_b32 s80, 221184
  buffer_load_dwordx4 v2, s[40:43], s80 offen nt lds
  s_add_u32 m0, s83, 9216
  s_mov_b32 s80, 248832
  buffer_load_dwordx4 v4, s[40:43], s80 offen nt lds
  s_add_u32 m0, s83, 10240
  s_mov_b32 s80, 276480
  buffer_load_dwordx4 v2, s[40:43], s80 offen nt lds
  s_add_u32 m0, s83, 11264
  s_mov_b32 s80, 304128
  buffer_load_dwordx4 v4, s[40:43], s80 offen nt lds
  s_add_u32 m0, s83, 12288
  s_mov_b32 s80, 331776
  buffer_load_dwordx4 v2, s[40:43], s80 offen nt lds
  s_add_u32 m0, s83, 13312
  s_mov_b32 s80, 359424
  buffer_load_dwordx4 v4, s[40:43], s80 offen nt lds
  s_add_u32 m0, s83, 14336
  s_mov_b32 s80, 387072
  buffer_load_dwordx4 v2, s[40:43], s80 offen nt lds
  s_add_u32 m0, s83, 15360
  s_mov_b32 s80, 414720
  buffer_load_dwordx4 v4, s[40:43], s80 offen nt lds
  s_add_u32 m0, s83, 16384
  s_mov_b32 s80, 442368
  buffer_load_dwordx4 v2, s[40:43], s80 offen nt lds
  s_add_u32 m0, s83, 17408
  s_mov_b32 s80, 470016
  buffer_load_dwordx4 v4, s[40:43], s80 offen nt lds
  s_add_u32 m0, s83, 18432
  s_mov_b32 s80, 497664
  buffer_load_dwordx4 v2, s[40:43], s80 offen nt lds
  s_add_u32 m0, s83, 19456
  s_mov_b32 s80, 525312
  buffer_load_dwordx4 v4, s[40:43], s80 offen nt lds
  v_lshrrev_b32 v10, 4, v1
  v_bfe_u32 v11, v1, 2, 2
  v_bfe_u32 v12, v1, 1, 1
  v_and_b32 v13, 1, v1
  v_lshlrev_b32 v13, 3, v13
  s_lshl_b32 s80, s32, 1
  v_add_u32 v2, s80, v12
  v_and_b32 v3, 1, v10
  v_lshlrev_b32 v3, 2, v3
  v_and_b32 v4, 2, v11
  v_xor_b32 v2, v2, v3
  v_xor_b32 v2, v2, v4
  v_lshl_add_u32 v2, v2, 4, v13
  v_lshl_add_u32 v3, v10, 3, v11
  v_lshl_add_u32 v2, v3, 7, v2
  v_add_u32 v3, 65536, v2
  s_lshl_b32 s81, s86, 3
  s_add_u32 s80, s80, s81
  s_mul_i32 s80, s80, 20480
  s_lshl_b32 s81, s85, 7
  s_add_u32 s80, s80, s81
  s_add_u32 s80, s80, 0xa00000
  v_and_b32 v5, 1, v8
  v_mul_u32_u24 v5, 20480, v5
  v_lshl_add_u32 v5, v10, 8, v5
  v_lshl_add_u32 v5, v9, 4, v5
  v_add_u32 v5, s80, v5
  v_add_u32 v6, 4096, v5
  v_mov_b32 v99, 0
  buffer_load_dword v99, v99, s[96:99], 0 offen sc1
  s_waitcnt vmcnt(1)
  s_barrier
  s_mov_b32 s80, 0x3f803f80
  s_mov_b32 s81, 0x00003f80
  s_mov_b32 s82, 0x3f800000
  ds_read_b64_tr_b16 v[16:17], v2 offset:0
  ds_read_b64_tr_b16 v[18:19], v2 offset:512
  ds_read_b64_tr_b16 v[20:21], v2 offset:4096
  ds_read_b64_tr_b16 v[22:23], v2 offset:4608
  ds_read_b64_tr_b16 v[24:25], v2 offset:8192
  ds_read_b64_tr_b16 v[26:27], v2 offset:8704
  ds_read_b64_tr_b16 v[28:29], v2 offset:12288
  ds_read_b64_tr_b16 v[30:31], v2 offset:12800
  ds_read_b64_tr_b16 v[32:33], v2 offset:16384
  ds_read_b64_tr_b16 v[34:35], v2 offset:16896
  ds_read_b64_tr_b16 v[36:37], v2 offset:20480
  ds_read_b64_tr_b16 v[38:39], v2 offset:20992
  ds_read_b64_tr_b16 v[40:41], v2 offset:24576
  ds_read_b64_tr_b16 v[42:43], v2 offset:25088
  ds_read_b64_tr_b16 v[44:45], v2 offset:28672
  ds_read_b64_tr_b16 v[46:47], v2 offset:29184
  ds_read_b64_tr_b16 v[48:49], v2 offset:32768
  ds_read_b64_tr_b16 v[50:51], v2 offset:33280
  ds_read_b64_tr_b16 v[52:53], v2 offset:36864
  ds_read_b64_tr_b16 v[54:55], v2 offset:37376
  ds_read_b64_tr_b16 v[56:57], v2 offset:40960
  ds_read_b64_tr_b16 v[58:59], v2 offset:41472
  ds_read_b64_tr_b16 v[60:61], v2 offset:45056
  ds_read_b64_tr_b16 v[62:63], v2 offset:45568
  ds_read_b64_tr_b16 v[64:65], v2 offset:49152
  ds_read_b64_tr_b16 v[66:67], v2 offset:49664
  ds_read_b64_tr_b16 v[68:69], v2 offset:53248
  ds_read_b64_tr_b16 v[70:71], v2 offset:53760
  ds_read_b64_tr_b16 v[72:73], v2 offset:57344
  ds_read_b64_tr_b16 v[74:75], v2 offset:57856
  ds_read_b64_tr_b16 v[76:77], v2 offset:61440
  ds_read_b64_tr_b16 v[78:79], v2 offset:61952
  ds_read_b64_tr_b16 v[80:81], v3 offset:0
  ds_read_b64_tr_b16 v[82:83], v3 offset:512
  ds_read_b64_tr_b16 v[84:85], v3 offset:4096
  ds_read_b64_tr_b16 v[86:87], v3 offset:4608
  ds_read_b64_tr_b16 v[88:89], v3 offset:8192
  ds_read_b64_tr_b16 v[90:91], v3 offset:8704
  ds_read_b64_tr_b16 v[92:93], v3 offset:12288
  ds_read_b64_tr_b16 v[94:95], v3 offset:12800
  s_waitcnt lgkmcnt(15)
  v_dot2_f32_bf16 v12, v16, s80, 0
  v_dot2_f32_bf16 v13, v17, s80, 0
  s_waitcnt lgkmcnt(15)
  v_dot2_f32_bf16 v14, v18, s80, 0
  v_dot2_f32_bf16 v15, v19, s80, 0
  s_waitcnt lgkmcnt(15)
  v_dot2_f32_bf16 v12, v20, s80, v12
  v_dot2_f32_bf16 v13, v21, s80, v13
  s_waitcnt lgkmcnt(15)
  v_dot2_f32_bf16 v14, v22, s80, v14
  v_dot2_f32_bf16 v15, v23, s80, v15
  s_waitcnt lgkmcnt(15)
  v_dot2_f32_bf16 v12, v24, s80, v12
  v_dot2_f32_bf16 v13, v25, s80, v13
  s_waitcnt lgkmcnt(15)
  v_dot2_f32_bf16 v14, v26, s80, v14
  v_dot2_f32_bf16 v15, v27, s80, v15
  s_waitcnt lgkmcnt(15)
  v_dot2_f32_bf16 v12, v28, s80, v12
  v_dot2_f32_bf16 v13, v29, s80, v13
  s_waitcnt lgkmcnt(15)
  v_dot2_f32_bf16 v14, v30, s80, v14
  v_dot2_f32_bf16 v15, v31, s80, v15
  s_waitcnt lgkmcnt(15)
  v_dot2_f32_bf16 v12, v32, s80, v12
  v_dot2_f32_bf16 v13, v33, s80, v13
  s_waitcnt lgkmcnt(15)
  v_dot2_f32_bf16 v14, v34, s80, v14
  v_dot2_f32_bf16 v15, v35, s80, v15
  s_waitcnt lgkmcnt(15)
  v_dot2_f32_bf16 v12, v36, s80, v12
  v_dot2_f32_bf16 v13, v37, s80, v13
  s_waitcnt lgkmcnt(15)
  v_dot2_f32_bf16 v14, v38, s80, v14
  v_dot2_f32_bf16 v15, v39, s80, v15
  s_waitcnt lgkmcnt(15)
  v_dot2_f32_bf16 v12, v40, s80, v12
  v_dot2_f32_bf16 v13, v41, s80, v13
  s_waitcnt lgkmcnt(15)
  v_dot2_f32_bf16 v14, v42, s80, v14
  v_dot2_f32_bf16 v15, v43, s80, v15
  s_waitcnt lgkmcnt(15)
  v_dot2_f32_bf16 v12, v44, s80, v12
  v_dot2_f32_bf16 v13, v45, s80, v13
  s_waitcnt lgkmcnt(15)
  v_dot2_f32_bf16 v14, v46, s80, v14
  v_dot2_f32_bf16 v15, v47, s80, v15
  s_waitcnt lgkmcnt(15)
  v_dot2_f32_bf16 v12, v48, s80, v12
  v_dot2_f32_bf16 v13, v49, s80, v13
  s_waitcnt lgkmcnt(15)
  v_dot2_f32_bf16 v14, v50, s80, v14
  v_dot2_f32_bf16 v15, v51, s80, v15
  s_waitcnt lgkmcnt(15)
  v_dot2_f32_bf16 v12, v52, s80, v12
  v_dot2_f32_bf16 v13, v53, s80, v13
  s_waitcnt lgkmcnt(15)
  v_dot2_f32_bf16 v14, v54, s80, v14
  v_dot2_f32_bf16 v15, v55, s80, v15
  s_waitcnt lgkmcnt(15)
  v_dot2_f32_bf16 v12, v56, s80, v12
  v_dot2_f32_bf16 v13, v57, s80, v13
  s_waitcnt lgkmcnt(15)
  v_dot2_f32_bf16 v14, v58, s80, v14
  v_dot2_f32_bf16 v15, v59, s80, v15
  s_waitcnt lgkmcnt(15)
  v_dot2_f32_bf16 v12, v60, s80, v12
  v_dot2_f32_bf16 v13, v61, s80, v13
  s_waitcnt lgkmcnt(15)
  v_dot2_f32_bf16 v14, v62, s80, v14
  v_dot2_f32_bf16 v15, v63, s80, v15
  s_waitcnt lgkmcnt(15)
  v_dot2_f32_bf16 v12, v64, s80, v12
  v_dot2_f32_bf16 v13, v65, s80, v13
  s_waitcnt lgkmcnt(14)
  v_dot2_f32_bf16 v14, v66, s80, v14
  v_dot2_f32_bf16 v15, v67, s80, v15
  s_waitcnt lgkmcnt(13)
  v_dot2_f32_bf16 v12, v68, s80, v12
  v_dot2_f32_bf16 v13, v69, s80, v13
  s_waitcnt lgkmcnt(12)
  v_dot2_f32_bf16 v14, v70, s80, v14
  v_dot2_f32_bf16 v15, v71, s80, v15
  s_waitcnt lgkmcnt(11)
  v_dot2_f32_bf16 v12, v72, s80, v12
  v_dot2_f32_bf16 v13, v73, s80, v13
  s_waitcnt lgkmcnt(10)
  v_dot2_f32_bf16 v14, v74, s80, v14
  v_dot2_f32_bf16 v15, v75, s80, v15
  s_waitcnt lgkmcnt(9)
  v_dot2_f32_bf16 v12, v76, s80, v12
  v_dot2_f32_bf16 v13, v77, s80, v13
  s_waitcnt lgkmcnt(8)
  v_dot2_f32_bf16 v14, v78, s80, v14
  v_dot2_f32_bf16 v15, v79, s80, v15
  s_waitcnt lgkmcnt(7)
  v_dot2_f32_bf16 v12, v80, s80, v12
  v_dot2_f32_bf16 v13, v81, s80, v13
  s_waitcnt lgkmcnt(6)
  v_dot2_f32_bf16 v14, v82, s80, v14
  v_dot2_f32_bf16 v15, v83, s80, v15
  s_waitcnt lgkmcnt(5)
  v_dot2_f32_bf16 v12, v84, s80, v12
  v_dot2_f32_bf16 v13, v85, s80, v13
  s_waitcnt lgkmcnt(4)
  v_dot2_f32_bf16 v14, v86, s80, v14
  v_dot2_f32_bf16 v15, v87, s80, v15
  s_waitcnt lgkmcnt(3)
  v_dot2_f32_bf16 v12, v88, s80, v12
  v_dot2_f32_bf16 v13, v89, s80, v13
  s_waitcnt lgkmcnt(2)
  v_dot2_f32_bf16 v14, v90, s80, v14
  v_dot2_f32_bf16 v15, v91, s80, v15
  s_waitcnt lgkmcnt(1)
  v_dot2_f32_bf16 v12, v92, s80, v12
  v_dot2_f32_bf16 v13, v93, s80, v13
  s_waitcnt lgkmcnt(0)
  v_dot2_f32_bf16 v14, v94, s80, v14
  v_dot2_f32_bf16 v15, v95, s80, v15
  v_add_f32 v12, v12, v13
  s_nop 1
  v_add_f32 v14, v14, v15
  v_add_f32 v12, v12, v14
  v_mov_b32 v13, v12
  s_nop 1
  v_permlane16_swap_b32 v12, v13
  v_add_f32 v12, v12, v13
  v_mov_b32 v13, v12
  s_nop 1
  v_permlane32_swap_b32 v12, v13
  v_add_f32 v12, v12, v13
  v_mul_f32 v12, 0xbacccccd, v12
  v_dot2_f32_bf16 v100, v16, s81, v12
  v_dot2_f32_bf16 v101, v16, s82, v12
  v_dot2_f32_bf16 v102, v17, s81, v12
  v_dot2_f32_bf16 v103, v17, s82, v12
  v_dot2_f32_bf16 v104, v18, s81, v12
  v_dot2_f32_bf16 v105, v18, s82, v12
  v_dot2_f32_bf16 v106, v19, s81, v12
  v_dot2_f32_bf16 v107, v19, s82, v12
  v_cvt_pk_bf16_f32 v16, v100, v101
  v_cvt_pk_bf16_f32 v17, v102, v103
  v_cvt_pk_bf16_f32 v18, v104, v105
  v_cvt_pk_bf16_f32 v19, v106, v107
  buffer_store_dwordx4 v[16:19], v5, s[36:39], s60 offen offset:0 sc1
  v_dot2_f32_bf16 v100, v20, s81, v12
  v_dot2_f32_bf16 v101, v20, s82, v12
  v_dot2_f32_bf16 v102, v21, s81, v12
  v_dot2_f32_bf16 v103, v21, s82, v12
  v_dot2_f32_bf16 v104, v22, s81, v12
  v_dot2_f32_bf16 v105, v22, s82, v12
  v_dot2_f32_bf16 v106, v23, s81, v12
  v_dot2_f32_bf16 v107, v23, s82, v12
  v_cvt_pk_bf16_f32 v20, v100, v101
  v_cvt_pk_bf16_f32 v21, v102, v103
  v_cvt_pk_bf16_f32 v22, v104, v105
  v_cvt_pk_bf16_f32 v23, v106, v107
  buffer_store_dwordx4 v[20:23], v5, s[36:39], s60 offen offset:1024 sc1
  v_dot2_f32_bf16 v100, v24, s81, v12
  v_dot2_f32_bf16 v101, v24, s82, v12
  v_dot2_f32_bf16 v102, v25, s81, v12
  v_dot2_f32_bf16 v103, v25, s82, v12
  v_dot2_f32_bf16 v104, v26, s81, v12
  v_dot2_f32_bf16 v105, v26, s82, v12
  v_dot2_f32_bf16 v106, v27, s81, v12
  v_dot2_f32_bf16 v107, v27, s82, v12
  v_cvt_pk_bf16_f32 v24, v100, v101
  v_cvt_pk_bf16_f32 v25, v102, v103
  v_cvt_pk_bf16_f32 v26, v104, v105
  v_cvt_pk_bf16_f32 v27, v106, v107
  buffer_store_dwordx4 v[24:27], v5, s[36:39], s60 offen offset:2048 sc1
  v_dot2_f32_bf16 v100, v28, s81, v12
  v_dot2_f32_bf16 v101, v28, s82, v12
  v_dot2_f32_bf16 v102, v29, s81, v12
  v_dot2_f32_bf16 v103, v29, s82, v12
  v_dot2_f32_bf16 v104, v30, s81, v12
  v_dot2_f32_bf16 v105, v30, s82, v12
  v_dot2_f32_bf16 v106, v31, s81, v12
  v_dot2_f32_bf16 v107, v31, s82, v12
  v_cvt_pk_bf16_f32 v28, v100, v101
  v_cvt_pk_bf16_f32 v29, v102, v103
  v_cvt_pk_bf16_f32 v30, v104, v105
  v_cvt_pk_bf16_f32 v31, v106, v107
  buffer_store_dwordx4 v[28:31], v5, s[36:39], s60 offen offset:3072 sc1
  v_dot2_f32_bf16 v100, v32, s81, v12
  v_dot2_f32_bf16 v101, v32, s82, v12
  v_dot2_f32_bf16 v102, v33, s81, v12
  v_dot2_f32_bf16 v103, v33, s82, v12
  v_dot2_f32_bf16 v104, v34, s81, v12
  v_dot2_f32_bf16 v105, v34, s82, v12
  v_dot2_f32_bf16 v106, v35, s81, v12
  v_dot2_f32_bf16 v107, v35, s82, v12
  v_cvt_pk_bf16_f32 v32, v100, v101
  v_cvt_pk_bf16_f32 v33, v102, v103
  v_cvt_pk_bf16_f32 v34, v104, v105
  v_cvt_pk_bf16_f32 v35, v106, v107
  buffer_store_dwordx4 v[32:35], v6, s[36:39], s60 offen offset:0 sc1
  v_dot2_f32_bf16 v100, v36, s81, v12
  v_dot2_f32_bf16 v101, v36, s82, v12
  v_dot2_f32_bf16 v102, v37, s81, v12
  v_dot2_f32_bf16 v103, v37, s82, v12
  v_dot2_f32_bf16 v104, v38, s81, v12
  v_dot2_f32_bf16 v105, v38, s82, v12
  v_dot2_f32_bf16 v106, v39, s81, v12
  v_dot2_f32_bf16 v107, v39, s82, v12
  v_cvt_pk_bf16_f32 v36, v100, v101
  v_cvt_pk_bf16_f32 v37, v102, v103
  v_cvt_pk_bf16_f32 v38, v104, v105
  v_cvt_pk_bf16_f32 v39, v106, v107
  buffer_store_dwordx4 v[36:39], v6, s[36:39], s60 offen offset:1024 sc1
  v_dot2_f32_bf16 v100, v40, s81, v12
  v_dot2_f32_bf16 v101, v40, s82, v12
  v_dot2_f32_bf16 v102, v41, s81, v12
  v_dot2_f32_bf16 v103, v41, s82, v12
  v_dot2_f32_bf16 v104, v42, s81, v12
  v_dot2_f32_bf16 v105, v42, s82, v12
  v_dot2_f32_bf16 v106, v43, s81, v12
  v_dot2_f32_bf16 v107, v43, s82, v12
  v_cvt_pk_bf16_f32 v40, v100, v101
  v_cvt_pk_bf16_f32 v41, v102, v103
  v_cvt_pk_bf16_f32 v42, v104, v105
  v_cvt_pk_bf16_f32 v43, v106, v107
  buffer_store_dwordx4 v[40:43], v6, s[36:39], s60 offen offset:2048 sc1
  v_dot2_f32_bf16 v100, v44, s81, v12
  v_dot2_f32_bf16 v101, v44, s82, v12
  v_dot2_f32_bf16 v102, v45, s81, v12
  v_dot2_f32_bf16 v103, v45, s82, v12
  v_dot2_f32_bf16 v104, v46, s81, v12
  v_dot2_f32_bf16 v105, v46, s82, v12
  v_dot2_f32_bf16 v106, v47, s81, v12
  v_dot2_f32_bf16 v107, v47, s82, v12
  v_cvt_pk_bf16_f32 v44, v100, v101
  v_cvt_pk_bf16_f32 v45, v102, v103
  v_cvt_pk_bf16_f32 v46, v104, v105
  v_cvt_pk_bf16_f32 v47, v106, v107
  buffer_store_dwordx4 v[44:47], v6, s[36:39], s60 offen offset:3072 sc1
  v_dot2_f32_bf16 v100, v48, s81, v12
  v_dot2_f32_bf16 v101, v48, s82, v12
  v_dot2_f32_bf16 v102, v49, s81, v12
  v_dot2_f32_bf16 v103, v49, s82, v12
  v_dot2_f32_bf16 v104, v50, s81, v12
  v_dot2_f32_bf16 v105, v50, s82, v12
  v_dot2_f32_bf16 v106, v51, s81, v12
  v_dot2_f32_bf16 v107, v51, s82, v12
  v_cvt_pk_bf16_f32 v48, v100, v101
  v_cvt_pk_bf16_f32 v49, v102, v103
  v_cvt_pk_bf16_f32 v50, v104, v105
  v_cvt_pk_bf16_f32 v51, v106, v107
  buffer_store_dwordx4 v[48:51], v5, s[36:39], s61 offen offset:0 sc1
  v_dot2_f32_bf16 v100, v52, s81, v12
  v_dot2_f32_bf16 v101, v52, s82, v12
  v_dot2_f32_bf16 v102, v53, s81, v12
  v_dot2_f32_bf16 v103, v53, s82, v12
  v_dot2_f32_bf16 v104, v54, s81, v12
  v_dot2_f32_bf16 v105, v54, s82, v12
  v_dot2_f32_bf16 v106, v55, s81, v12
  v_dot2_f32_bf16 v107, v55, s82, v12
  v_cvt_pk_bf16_f32 v52, v100, v101
  v_cvt_pk_bf16_f32 v53, v102, v103
  v_cvt_pk_bf16_f32 v54, v104, v105
  v_cvt_pk_bf16_f32 v55, v106, v107
  buffer_store_dwordx4 v[52:55], v5, s[36:39], s61 offen offset:1024 sc1
  v_dot2_f32_bf16 v100, v56, s81, v12
  v_dot2_f32_bf16 v101, v56, s82, v12
  v_dot2_f32_bf16 v102, v57, s81, v12
  v_dot2_f32_bf16 v103, v57, s82, v12
  v_dot2_f32_bf16 v104, v58, s81, v12
  v_dot2_f32_bf16 v105, v58, s82, v12
  v_dot2_f32_bf16 v106, v59, s81, v12
  v_dot2_f32_bf16 v107, v59, s82, v12
  v_cvt_pk_bf16_f32 v56, v100, v101
  v_cvt_pk_bf16_f32 v57, v102, v103
  v_cvt_pk_bf16_f32 v58, v104, v105
  v_cvt_pk_bf16_f32 v59, v106, v107
  buffer_store_dwordx4 v[56:59], v5, s[36:39], s61 offen offset:2048 sc1
  v_dot2_f32_bf16 v100, v60, s81, v12
  v_dot2_f32_bf16 v101, v60, s82, v12
  v_dot2_f32_bf16 v102, v61, s81, v12
  v_dot2_f32_bf16 v103, v61, s82, v12
  v_dot2_f32_bf16 v104, v62, s81, v12
  v_dot2_f32_bf16 v105, v62, s82, v12
  v_dot2_f32_bf16 v106, v63, s81, v12
  v_dot2_f32_bf16 v107, v63, s82, v12
  v_cvt_pk_bf16_f32 v60, v100, v101
  v_cvt_pk_bf16_f32 v61, v102, v103
  v_cvt_pk_bf16_f32 v62, v104, v105
  v_cvt_pk_bf16_f32 v63, v106, v107
  buffer_store_dwordx4 v[60:63], v5, s[36:39], s61 offen offset:3072 sc1
  v_dot2_f32_bf16 v100, v64, s81, v12
  v_dot2_f32_bf16 v101, v64, s82, v12
  v_dot2_f32_bf16 v102, v65, s81, v12
  v_dot2_f32_bf16 v103, v65, s82, v12
  v_dot2_f32_bf16 v104, v66, s81, v12
  v_dot2_f32_bf16 v105, v66, s82, v12
  v_dot2_f32_bf16 v106, v67, s81, v12
  v_dot2_f32_bf16 v107, v67, s82, v12
  v_cvt_pk_bf16_f32 v64, v100, v101
  v_cvt_pk_bf16_f32 v65, v102, v103
  v_cvt_pk_bf16_f32 v66, v104, v105
  v_cvt_pk_bf16_f32 v67, v106, v107
  buffer_store_dwordx4 v[64:67], v6, s[36:39], s61 offen offset:0 sc1
  v_dot2_f32_bf16 v100, v68, s81, v12
  v_dot2_f32_bf16 v101, v68, s82, v12
  v_dot2_f32_bf16 v102, v69, s81, v12
  v_dot2_f32_bf16 v103, v69, s82, v12
  v_dot2_f32_bf16 v104, v70, s81, v12
  v_dot2_f32_bf16 v105, v70, s82, v12
  v_dot2_f32_bf16 v106, v71, s81, v12
  v_dot2_f32_bf16 v107, v71, s82, v12
  v_cvt_pk_bf16_f32 v68, v100, v101
  v_cvt_pk_bf16_f32 v69, v102, v103
  v_cvt_pk_bf16_f32 v70, v104, v105
  v_cvt_pk_bf16_f32 v71, v106, v107
  buffer_store_dwordx4 v[68:71], v6, s[36:39], s61 offen offset:1024 sc1
  v_dot2_f32_bf16 v100, v72, s81, v12
  v_dot2_f32_bf16 v101, v72, s82, v12
  v_dot2_f32_bf16 v102, v73, s81, v12
  v_dot2_f32_bf16 v103, v73, s82, v12
  v_dot2_f32_bf16 v104, v74, s81, v12
  v_dot2_f32_bf16 v105, v74, s82, v12
  v_dot2_f32_bf16 v106, v75, s81, v12
  v_dot2_f32_bf16 v107, v75, s82, v12
  v_cvt_pk_bf16_f32 v72, v100, v101
  v_cvt_pk_bf16_f32 v73, v102, v103
  v_cvt_pk_bf16_f32 v74, v104, v105
  v_cvt_pk_bf16_f32 v75, v106, v107
  buffer_store_dwordx4 v[72:75], v6, s[36:39], s61 offen offset:2048 sc1
  v_dot2_f32_bf16 v100, v76, s81, v12
  v_dot2_f32_bf16 v101, v76, s82, v12
  v_dot2_f32_bf16 v102, v77, s81, v12
  v_dot2_f32_bf16 v103, v77, s82, v12
  v_dot2_f32_bf16 v104, v78, s81, v12
  v_dot2_f32_bf16 v105, v78, s82, v12
  v_dot2_f32_bf16 v106, v79, s81, v12
  v_dot2_f32_bf16 v107, v79, s82, v12
  v_cvt_pk_bf16_f32 v76, v100, v101
  v_cvt_pk_bf16_f32 v77, v102, v103
  v_cvt_pk_bf16_f32 v78, v104, v105
  v_cvt_pk_bf16_f32 v79, v106, v107
  buffer_store_dwordx4 v[76:79], v6, s[36:39], s61 offen offset:3072 sc1
  v_dot2_f32_bf16 v100, v80, s81, v12
  v_dot2_f32_bf16 v101, v80, s82, v12
  v_dot2_f32_bf16 v102, v81, s81, v12
  v_dot2_f32_bf16 v103, v81, s82, v12
  v_dot2_f32_bf16 v104, v82, s81, v12
  v_dot2_f32_bf16 v105, v82, s82, v12
  v_dot2_f32_bf16 v106, v83, s81, v12
  v_dot2_f32_bf16 v107, v83, s82, v12
  v_cvt_pk_bf16_f32 v80, v100, v101
  v_cvt_pk_bf16_f32 v81, v102, v103
  v_cvt_pk_bf16_f32 v82, v104, v105
  v_cvt_pk_bf16_f32 v83, v106, v107
  buffer_store_dwordx4 v[80:83], v5, s[36:39], s62 offen offset:0 sc1
  v_dot2_f32_bf16 v100, v84, s81, v12
  v_dot2_f32_bf16 v101, v84, s82, v12
  v_dot2_f32_bf16 v102, v85, s81, v12
  v_dot2_f32_bf16 v103, v85, s82, v12
  v_dot2_f32_bf16 v104, v86, s81, v12
  v_dot2_f32_bf16 v105, v86, s82, v12
  v_dot2_f32_bf16 v106, v87, s81, v12
  v_dot2_f32_bf16 v107, v87, s82, v12
  v_cvt_pk_bf16_f32 v84, v100, v101
  v_cvt_pk_bf16_f32 v85, v102, v103
  v_cvt_pk_bf16_f32 v86, v104, v105
  v_cvt_pk_bf16_f32 v87, v106, v107
  buffer_store_dwordx4 v[84:87], v5, s[36:39], s62 offen offset:1024 sc1
  v_dot2_f32_bf16 v100, v88, s81, v12
  v_dot2_f32_bf16 v101, v88, s82, v12
  v_dot2_f32_bf16 v102, v89, s81, v12
  v_dot2_f32_bf16 v103, v89, s82, v12
  v_dot2_f32_bf16 v104, v90, s81, v12
  v_dot2_f32_bf16 v105, v90, s82, v12
  v_dot2_f32_bf16 v106, v91, s81, v12
  v_dot2_f32_bf16 v107, v91, s82, v12
  v_cvt_pk_bf16_f32 v88, v100, v101
  v_cvt_pk_bf16_f32 v89, v102, v103
  v_cvt_pk_bf16_f32 v90, v104, v105
  v_cvt_pk_bf16_f32 v91, v106, v107
  buffer_store_dwordx4 v[88:91], v5, s[36:39], s62 offen offset:2048 sc1
  v_dot2_f32_bf16 v100, v92, s81, v12
  v_dot2_f32_bf16 v101, v92, s82, v12
  v_dot2_f32_bf16 v102, v93, s81, v12
  v_dot2_f32_bf16 v103, v93, s82, v12
  v_dot2_f32_bf16 v104, v94, s81, v12
  v_dot2_f32_bf16 v105, v94, s82, v12
  v_dot2_f32_bf16 v106, v95, s81, v12
  v_dot2_f32_bf16 v107, v95, s82, v12
  v_cvt_pk_bf16_f32 v92, v100, v101
  v_cvt_pk_bf16_f32 v93, v102, v103
  v_cvt_pk_bf16_f32 v94, v104, v105
  v_cvt_pk_bf16_f32 v95, v106, v107
  buffer_store_dwordx4 v[92:95], v5, s[36:39], s62 offen offset:3072 sc1
  s_waitcnt vmcnt(0)
  v_readfirstlane_b32 s80, v99
  s_nop 0
  s_cmp_eq_u32 s80, 0
  s_cbranch_scc1 L_rc_39
L_rcb_40:
  s_mov_b32 s80, 157696
  s_barrier
  v_lshl_add_u32 v8, v1, 7, s80
  v_mov_b32 v9, 1
  s_cmp_eq_u32 s32, 0
  s_cselect_b32 exec_lo, 0xffff, 0
  s_mov_b32 exec_hi, 0
  buffer_atomic_add v9, v8, s[36:39], 0 offen sc1
  s_mov_b64 exec, -1
L_tail:
  s_mul_i32 s80, s95, 20480
  s_lshl_b32 s81, s32, 10
  s_add_u32 s80, s80, s81
  s_add_u32 s80, s80, 0xa00000
  v_lshrrev_b32 v138, 4, v1
  v_lshl_add_u32 v138, v138, 8, s80
  v_bfe_u32 v139, v1, 3, 1
  v_mul_u32_u24 v139, 20480, v139
  v_and_b32 v140, 7, v1
  v_lshl_add_u32 v139, v140, 4, v139
  v_add_u32 v109, v138, v139
  v_bfe_u32 v139, v1, 1, 1
  v_bfe_u32 v140, v1, 2, 2
  v_lshl_add_u32 v139, v139, 2, v140
  v_and_b32 v140, 1, v1
  v_lshl_add_u32 v139, v139, 1, v140
  v_lshl_add_u32 v110, v139, 4, v138
  s_mul_i32 s89, s32, 7168
  s_mul_i32 s80, s101, 276480
  s_mul_i32 s81, s32, 71680
  s_add_u32 s80, s80, s81
  s_add_u32 s80, s80, 0xf00000
  v_lshl_add_u32 v138, v1, 4, s80
  v_add_u32 v255, 4096, v138
  s_xor_b32 s81, s32, 0
  s_lshl_b32 s81, s81, 10
  v_add_u32 v251, s81, v138
  s_xor_b32 s81, s32, 1
  s_lshl_b32 s81, s81, 10
  v_add_u32 v252, s81, v138
  s_xor_b32 s81, s32, 2
  s_lshl_b32 s81, s81, 10
  v_add_u32 v253, s81, v138
  s_xor_b32 s81, s32, 3
  s_lshl_b32 s81, s81, 10
  v_add_u32 v254, s81, v138
  v_mov_b32 v111, 0x80000000
  v_lshlrev_b32 v102, 7, v1
  v_cmp_gt_u32 vcc, 16, v1
  s_nop 1
  v_cndmask_b32 v102, v111, v102, vcc
  v_cmp_eq_u32 vcc, 0, v1
  s_nop 1
  v_cndmask_b32 v111, v111, 0, vcc
  s_lshl_b32 s80, s2, 2
  s_add_u32 s80, s80, s32
  s_cmp_lg_u32 s80, 1000
  s_cbranch_scc1 L_gd_42
  v_lshlrev_b32 v2, 7, v1
  s_mov_b32 s34, 1048576
L_ga_41:
  buffer_load_dword v3, v2, s[36:39], s78 offen sc1
  s_sub_u32 s34, s34, 1
  s_cbranch_scc1 L_end
  s_waitcnt vmcnt(0)
  v_cmp_gt_u32 vcc, 10, v3
  s_nop 0
  s_mov_b64 exec, vcc
  s_cbranch_vccnz L_ga_41
  s_mov_b64 exec, 0xffff
  v_mov_b32 v3, 1
  buffer_store_dword v3, v2, s[36:39], s79 offen sc1
  s_mov_b64 exec, -1
L_gd_42:
  s_cmp_lg_u32 s32, 0
  s_cbranch_scc1 L_tw_43
  s_and_b32 s80, s2, 15
  s_lshl_b32 s80, s80, 7
  s_add_u32 s80, s80, 159744
  v_add_u32 v122, s80, v111
  buffer_load_dword v123, v122, s[36:39], 0 offen sc1
  s_waitcnt vmcnt(0)
  v_cmp_gt_u32 vcc, 42, v123
  s_nop 0
  s_and_b32 vcc_lo, vcc_lo, 0x1
  s_cbranch_scc1 L_cp_44
L_cpb_45:
  s_and_b32 s80, s2, 15
  s_lshl_b32 s80, s80, 7
  s_add_u32 s80, s80, 155648
  v_add_u32 v122, s80, v111
  buffer_load_dword v123, v122, s[36:39], 0 offen sc1
  s_waitcnt vmcnt(0)
  v_cmp_gt_u32 vcc, 1, v123
  s_nop 0
  s_and_b32 vcc_lo, vcc_lo, 0x1
  s_cbranch_scc1 L_cp_46
L_cpb_47:
L_tw_43:
  s_barrier
  s_mov_b32 s86, 0
  buffer_load_dwordx4 a[0:3], v251, s[36:39], s86 offen sc1
  buffer_load_dwordx4 a[4:7], v252, s[36:39], s86 offen sc1
  buffer_load_dwordx4 a[8:11], v253, s[36:39], s86 offen sc1
  buffer_load_dwordx4 a[12:15], v254, s[36:39], s86 offen sc1
  buffer_load_dwordx4 a[16:19], v255, s[36:39], s86 offen sc1
  s_mov_b32 s86, 5120
  buffer_load_dwordx4 a[20:23], v251, s[36:39], s86 offen sc1
  buffer_load_dwordx4 a[24:27], v252, s[36:39], s86 offen sc1
  buffer_load_dwordx4 a[28:31], v253, s[36:39], s86 offen sc1
  buffer_load_dwordx4 a[32:35], v254, s[36:39], s86 offen sc1
  buffer_load_dwordx4 a[36:39], v255, s[36:39], s86 offen sc1
  s_mov_b32 s86, 10240
  buffer_load_dwordx4 a[40:43], v251, s[36:39], s86 offen sc1
  buffer_load_dwordx4 a[44:47], v252, s[36:39], s86 offen sc1
  buffer_load_dwordx4 a[48:51], v253, s[36:39], s86 offen sc1
  buffer_load_dwordx4 a[52:55], v254, s[36:39], s86 offen sc1
  buffer_load_dwordx4 a[56:59], v255, s[36:39], s86 offen sc1
  s_mov_b32 s86, 15360
  buffer_load_dwordx4 a[60:63], v251, s[36:39], s86 offen sc1
  buffer_load_dwordx4 a[64:67], v252, s[36:39], s86 offen sc1
  buffer_load_dwordx4 a[68:71], v253, s[36:39], s86 offen sc1
  buffer_load_dwordx4 a[72:75], v254, s[36:39], s86 offen sc1
  buffer_load_dwordx4 a[76:79], v255, s[36:39], s86 offen sc1
  s_mov_b32 s86, 20480
  buffer_load_dwordx4 a[80:83], v251, s[36:39], s86 offen sc1
  buffer_load_dwordx4 a[84:87], v252, s[36:39], s86 offen sc1
  buffer_load_dwordx4 a[88:91], v253, s[36:39], s86 offen sc1
  buffer_load_dwordx4 a[92:95], v254, s[36:39], s86 offen sc1
  buffer_load_dwordx4 a[96:99], v255, s[36:39], s86 offen sc1
  s_mov_b32 s86, 25600
  buffer_load_dwordx4 a[100:103], v251, s[36:39], s86 offen sc1
  buffer_load_dwordx4 a[104:107], v252, s[36:39], s86 offen sc1
  buffer_load_dwordx4 a[108:111], v253, s[36:39], s86 offen sc1
  buffer_load_dwordx4 a[112:115], v254, s[36:39], s86 offen sc1
  buffer_load_dwordx4 a[116:119], v255, s[36:39], s86 offen sc1
  s_mov_b32 s86, 30720
  buffer_load_dwordx4 a[120:123], v251, s[36:39], s86 offen sc1
  buffer_load_dwordx4 a[124:127], v252, s[36:39], s86 offen sc1
  buffer_load_dwordx4 a[128:131], v253, s[36:39], s86 offen sc1
  s_cmp_lg_u32 s32, 0
  s_cbranch_scc1 L_tw_48
  s_and_b32 s80, s2, 15
  s_lshl_b32 s80, s80, 7
  s_add_u32 s80, s80, 157696
  v_add_u32 v122, s80, v111
  buffer_load_dword v123, v122, s[36:39], 0 offen sc1
  s_waitcnt vmcnt(0)
  v_cmp_gt_u32 vcc, 54, v123
  s_nop 0
  s_and_b32 vcc_lo, vcc_lo, 0x1
  s_cbranch_scc1 L_cp_49
L_cpb_50:
L_tw_48:
  s_barrier
  s_add_u32 m0, s89, 135168
  s_mov_b32 s88, 0
  buffer_load_dwordx4 v109, s[36:39], s88 offen sc1 lds
  s_add_u32 m0, s89, 136192
  s_mov_b32 s88, 128
  buffer_load_dwordx4 v109, s[36:39], s88 offen sc1 lds
  s_add_u32 m0, s89, 137216
  s_mov_b32 s88, 40960
  buffer_load_dwordx4 v109, s[36:39], s88 offen sc1 lds
  s_add_u32 m0, s89, 138240
  s_mov_b32 s88, 41088
  buffer_load_dwordx4 v109, s[36:39], s88 offen sc1 lds
  s_add_u32 m0, s89, 139264
  s_mov_b32 s88, 81920
  buffer_load_dwordx4 v109, s[36:39], s88 offen sc1 lds
  s_add_u32 m0, s89, 140288
  s_mov_b32 s88, 82048
  buffer_load_dwordx4 v109, s[36:39], s88 offen sc1 lds
  s_add_u32 m0, s89, 141312
  s_mov_b32 s88, 122880
  buffer_load_dwordx4 v110, s[36:39], s88 offen sc1 lds
  s_add_u32 m0, s89, 20480
  s_mov_b32 s88, 4096
  buffer_load_dwordx4 v109, s[36:39], s88 offen sc1 lds
  s_add_u32 m0, s89, 21504
  s_mov_b32 s88, 4224
  buffer_load_dwordx4 v109, s[36:39], s88 offen sc1 lds
  s_add_u32 m0, s89, 22528
  s_mov_b32 s88, 45056
  buffer_load_dwordx4 v109, s[36:39], s88 offen sc1 lds
  s_add_u32 m0, s89, 23552
  s_mov_b32 s88, 45184
  buffer_load_dwordx4 v109, s[36:39], s88 offen sc1 lds
  s_add_u32 m0, s89, 24576
  s_mov_b32 s88, 86016
  buffer_load_dwordx4 v109, s[36:39], s88 offen sc1 lds
  s_add_u32 m0, s89, 25600
  s_mov_b32 s88, 86144
  buffer_load_dwordx4 v109, s[36:39], s88 offen sc1 lds
  s_add_u32 m0, s89, 26624
  s_mov_b32 s88, 126976
  buffer_load_dwordx4 v110, s[36:39], s88 offen sc1 lds
  s_mov_b32 s42, 0x00800000
  s_mov_b32 s43, 0x00020000
  s_mov_b32 s46, 0x00800000
  s_mov_b32 s47, 0x00020000
  s_add_u32 s40, s28, 0x1200000
  s_addc_u32 s41, s29, 0
  v_and_b32 v212, 15, v1
  v_lshrrev_b32 v213, 4, v1
  v_lshlrev_b32 v14, 4, v1
  v_lshlrev_b32 v212, 4, v212
  v_lshl_add_u32 v214, v213, 11, v212
  s_lshl_b32 s80, s32, 8
  s_mul_i32 s81, s90, 327680
  s_add_u32 s81, s81, s80
  v_add_u32 v2, s81, v214
  s_lshl_b32 s80, s32, 8
  s_mul_i32 s81, s32, 114688
  s_lshl_b32 s82, s100, 8
  s_add_u32 s81, s81, s82
  s_mul_i32 s83, s30, 917504
  s_add_u32 s81, s81, s83
  v_add_u32 v3, s81, v214
  s_cmp_eq_u32 s32, 3
  s_cselect_b32 s81, 0x80000000, 0
  v_or_b32 v15, s81, v3
  v_add_u32 v5, 20480, v14
  v_add_u32 v6, 84992, v14
  v_add_u32 v7, 149504, v14
  s_lshl_b32 s81, s95, 11
  s_add_u32 s81, s81, s80
  s_mul_i32 s83, s90, 917504
  s_add_u32 s81, s81, s83
  v_lshl_add_u32 v214, v213, 10, v212
  v_add_u32 v8, s81, v214
  s_add_u32 s81, s81, 12288
  s_cmp_lt_u32 s91, 24
  s_cselect_b32 s81, s81, 0x80000000
  v_lshrrev_b32 v215, 1, v213
  v_lshl_add_u32 v9, v215, 10, v212
  v_and_b32 v215, 1, v213
  v_lshl_add_u32 v9, v215, 3, v9
  v_add_u32 v9, s81, v9
  s_mul_i32 s81, s101, 20480
  s_add_u32 s81, s81, s82
  s_mul_i32 s83, s30, 327680
  s_add_u32 s81, s81, s83
  s_lshl_b32 s83, s32, 12
  s_add_u32 s83, s83, s81
  v_add_u32 v10, s83, v214
  s_lshl_b32 s83, s32, 10
  s_add_u32 s81, s81, s83
  s_add_u32 s81, s81, 16384
  v_lshl_add_u32 v4, v213, 2, v212
  v_add_u32 v4, s81, v4
  s_lshl_b32 s81, s90, 12
  s_add_u32 s81, s81, s80
  s_add_u32 s81, s81, 0x2a00000
  v_add_u32 v12, s81, v212
  s_lshl_b32 s81, s30, 14
  s_lshl_b32 s83, s100, 11
  s_add_u32 s81, s81, s83
  s_add_u32 s81, s81, 0x2a80000
  v_lshl_add_u32 v13, v213, 9, v212
  v_add_u32 v13, s81, v13
  v_mov_b32 v206, 0x80000000
  v_lshlrev_b32 v11, 7, v1
  v_cmp_gt_u32 vcc, 16, v1
  s_nop 1
  v_cndmask_b32 v11, v206, v11, vcc
  v_cmp_eq_u32 vcc, 0, v1
  s_nop 1
  v_cndmask_b32 v206, v206, 0, vcc
  s_and_b32 s80, s90, 3
  s_lshl_b32 s80, s80, 2
  s_add_u32 s80, s80, s32
  s_lshl_b32 s80, s80, 9
  s_add_u32 s80, s80, 16384
  v_and_b32 v230, 0x80000180, v11
  v_add_u32 v230, s80, v230
  buffer_load_dword v231, v230, s[36:39], 0 offen sc1
  s_waitcnt vmcnt(0)
  v_cmp_gt_u32 vcc, 10, v231
  s_nop 0
  s_and_b32 vcc_lo, vcc_lo, 0xf
  s_cbranch_scc1 L_cp_51
L_cpb_52:
  s_barrier
  buffer_load_dwordx4 v[128:131], v2, s[40:43], s60 offen sc1
  buffer_load_dwordx4 v[132:135], v2, s[40:43], s60 offen offset:1024 sc1
  buffer_load_dwordx4 v[136:139], v2, s[40:43], s61 offen sc1
  buffer_load_dwordx4 v[140:143], v2, s[40:43], s61 offen offset:1024 sc1
  buffer_load_dwordx4 v[144:147], v2, s[40:43], s62 offen sc1
  buffer_load_dwordx4 v[148:151], v2, s[40:43], s62 offen offset:1024 sc1
  buffer_load_dwordx4 v[152:155], v2, s[40:43], s63 offen sc1
  buffer_load_dwordx4 v[156:159], v2, s[40:43], s63 offen offset:1024 sc1
  buffer_load_dwordx4 v[160:163], v2, s[40:43], s64 offen sc1
  buffer_load_dwordx4 v[164:167], v2, s[40:43], s64 offen offset:1024 sc1
  s_waitcnt vmcnt(0)
  s_branch L_g1
L_rc_1:
  s_mov_b32 s34, 1048576
L_rc_1_a:
  v_mov_b32 v66, 0
  buffer_load_dword v66, v66, s[96:99], 0 offen sc1
  s_waitcnt vmcnt(0)
  v_readfirstlane_b32 s80, v66
  s_nop 0
  s_cmp_lg_u32 s80, 0
  s_cbranch_scc1 L_rcb_2
  s_sub_u32 s34, s34, 1
  s_cbranch_scc0 L_rc_1_a
  s_branch L_end
L_cp_3:
  buffer_load_dword v67, v66, s[36:39], 0 offen sc1
  s_waitcnt vmcnt(0)
  v_or_b32 v64, s83, v111
  v_mov_b32 v65, 1
  buffer_atomic_add v65, v64, s[36:39], 0 offen sc1
  s_mov_b32 s83, 0x80000000
  v_cmp_gt_u32 vcc, 8, v67
  s_nop 0
  s_and_b32 vcc_lo, vcc_lo, 1
  s_cbranch_scc0 L_cpb_4
  s_mov_b32 s34, 1048576
  s_mov_b32 exec_hi, 0
L_cp_3_a:
  s_mov_b32 exec_lo, vcc_lo
  buffer_load_dword v67, v66, s[36:39], 0 offen sc1
  s_sub_u32 s34, s34, 1
  s_cbranch_scc1 L_end
  s_waitcnt vmcnt(0)
  v_cmp_gt_u32 vcc, 8, v67
  s_nop 0
  s_cbranch_vccnz L_cp_3_a
  s_mov_b64 exec, -1
  s_branch L_cpb_4
L_cp_5:
  s_mov_b32 s34, 1048576
  s_mov_b32 exec_hi, 0
L_cp_5_a:
  s_mov_b32 exec_lo, vcc_lo
  buffer_load_dword v123, v122, s[36:39], 0 offen sc1
  s_sub_u32 s34, s34, 1
  s_cbranch_scc1 L_end
  s_waitcnt vmcnt(0)
  v_cmp_gt_u32 vcc, 42, v123
  s_nop 0
  s_cbranch_vccnz L_cp_5_a
  s_mov_b64 exec, -1
  s_branch L_cpb_6
L_cp_7:
  s_mov_b32 s34, 1048576
  s_mov_b32 exec_hi, 0
L_cp_7_a:
  s_mov_b32 exec_lo, vcc_lo
  buffer_load_dword v123, v122, s[36:39], 0 offen sc1
  s_sub_u32 s34, s34, 1
  s_cbranch_scc1 L_end
  s_waitcnt vmcnt(0)
  v_cmp_gt_u32 vcc, 54, v123
  s_nop 0
  s_cbranch_vccnz L_cp_7_a
  s_mov_b64 exec, -1
  s_branch L_cpb_8
L_cp_9:
  s_mov_b32 s34, 1048576
  s_mov_b32 exec_hi, 0
L_cp_9_a:
  s_mov_b32 exec_lo, vcc_lo
  buffer_load_dword v123, v122, s[36:39], 0 offen sc1
  s_sub_u32 s34, s34, 1
  s_cbranch_scc1 L_end
  s_waitcnt vmcnt(0)
  v_cmp_gt_u32 vcc, 1, v123
  s_nop 0
  s_cbranch_vccnz L_cp_9_a
  s_mov_b64 exec, -1
  s_branch L_cpb_10
L_cp_11:
  s_mov_b32 s34, 1048576
  s_mov_b32 exec_hi, 0
L_cp_11_a:
  s_mov_b32 exec_lo, vcc_lo
  buffer_load_dword v123, v122, s[36:39], 0 offen sc1
  s_sub_u32 s34, s34, 1
  s_cbranch_scc1 L_end
  s_waitcnt vmcnt(0)
  v_cmp_gt_u32 vcc, 10, v123
  s_nop 0
  s_cbranch_vccnz L_cp_11_a
  s_mov_b64 exec, -1
  s_branch L_cpb_12
L_cp_13:
  s_mov_b32 s34, 1048576
  s_mov_b32 exec_hi, 0
L_cp_13_a:
  s_mov_b32 exec_lo, vcc_lo
  buffer_load_dword v231, v230, s[36:39], 0 offen sc1
  s_sub_u32 s34, s34, 1
  s_cbranch_scc1 L_end
  s_waitcnt vmcnt(0)
  v_cmp_gt_u32 vcc, 10, v231
  s_nop 0
  s_cbranch_vccnz L_cp_13_a
  s_mov_b64 exec, -1
  s_branch L_cpb_14
L_tp_15:
  s_mov_b32 s34, 1048576
L_tp_15_a:
  s_mov_b64 exec, vcc
  buffer_load_dwordx4 v[216:219], v12, s[36:39], 0 offen offset:0 sc1
  buffer_load_dwordx4 v[220:223], v12, s[36:39], 0 offen offset:1024 sc1
  s_sub_u32 s34, s34, 1
  s_cbranch_scc1 L_end
  s_waitcnt vmcnt(0)
  v_bitop3_b32 v224, v216, v217, v218 bitop3:0x80
  v_bitop3_b32 v225, v219, v220, v221 bitop3:0x80
  v_bitop3_b32 v224, v224, v222, v223 bitop3:0x80
  v_bitop3_b32 v224, v224, v225, 1 bitop3:0x80
  v_cmp_eq_u32 vcc, 0, v224
  s_nop 0
  s_cbranch_vccnz L_tp_15_a
  s_mov_b64 exec, -1
  s_branch L_tpb_16
L_tp_17:
  s_mov_b32 s34, 1048576
L_tp_17_a:
  s_mov_b64 exec, vcc
  buffer_load_dwordx4 v[216:219], v12, s[36:39], 0 offen offset:2048 sc1
  buffer_load_dwordx4 v[220:223], v12, s[36:39], 0 offen offset:3072 sc1
  s_sub_u32 s34, s34, 1
  s_cbranch_scc1 L_end
  s_waitcnt vmcnt(0)
  v_bitop3_b32 v224, v216, v217, v218 bitop3:0x80
  v_bitop3_b32 v225, v219, v220, v221 bitop3:0x80
  v_bitop3_b32 v224, v224, v222, v223 bitop3:0x80
  v_bitop3_b32 v224, v224, v225, 1 bitop3:0x80
  v_cmp_eq_u32 vcc, 0, v224
  s_nop 0
  s_cbranch_vccnz L_tp_17_a
  s_mov_b64 exec, -1
  s_branch L_tpb_18
L_cp_19:
  s_mov_b32 s34, 1048576
  s_mov_b32 exec_hi, 0
L_cp_19_a:
  s_mov_b32 exec_lo, vcc_lo
  buffer_load_dword v231, v230, s[36:39], 0 offen sc1
  s_sub_u32 s34, s34, 1
  s_cbranch_scc1 L_end
  s_waitcnt vmcnt(0)
  v_cmp_gt_u32 vcc, 8, v231
  s_nop 0
  s_cbranch_vccnz L_cp_19_a
  s_mov_b64 exec, -1
  s_branch L_cpb_20
L_cp_21:
  s_mov_b32 s34, 1048576
  s_mov_b32 exec_hi, 0
L_cp_21_a:
  s_mov_b32 exec_lo, vcc_lo
  buffer_load_dword v231, v230, s[36:39], 0 offen sc1
  s_sub_u32 s34, s34, 1
  s_cbranch_scc1 L_end
  s_waitcnt vmcnt(0)
  v_cmp_gt_u32 vcc, 8, v231
  s_nop 0
  s_cbranch_vccnz L_cp_21_a
  s_mov_b64 exec, -1
  s_branch L_cpb_22
L_tp_23:
  s_mov_b32 s34, 1048576
L_tp_23_a:
  s_mov_b64 exec, vcc
  buffer_load_dwordx4 v[216:219], v13, s[36:39], 0 offen offset:0 sc1
  buffer_load_dwordx4 v[220:223], v13, s[36:39], 0 offen offset:256 sc1
  s_sub_u32 s34, s34, 1
  s_cbranch_scc1 L_end
  s_waitcnt vmcnt(0)
  v_bitop3_b32 v224, v216, v217, v218 bitop3:0x80
  v_bitop3_b32 v225, v219, v220, v221 bitop3:0x80
  v_bitop3_b32 v224, v224, v222, v223 bitop3:0x80
  v_bitop3_b32 v224, v224, v225, 1 bitop3:0x80
  v_cmp_eq_u32 vcc, 0, v224
  s_nop 0
  s_cbranch_vccnz L_tp_23_a
  s_mov_b64 exec, -1
  s_branch L_tpb_24
L_cp_25:
  s_mov_b32 s34, 1048576
  s_mov_b32 exec_hi, 0
L_cp_25_a:
  s_mov_b32 exec_lo, vcc_lo
  buffer_load_dword v231, v230, s[36:39], 0 offen sc1
  s_sub_u32 s34, s34, 1
  s_cbranch_scc1 L_end
  s_waitcnt vmcnt(0)
  v_cmp_gt_u32 vcc, 8, v231
  s_nop 0
  s_cbranch_vccnz L_cp_25_a
  s_mov_b64 exec, -1
  s_branch L_cpb_26
L_tp_27:
  s_mov_b32 s34, 1048576
L_tp_27_a:
  s_mov_b64 exec, vcc
  buffer_load_dwordx4 v[216:219], v13, s[36:39], s61 offen offset:0 sc1
  buffer_load_dwordx4 v[220:223], v13, s[36:39], s61 offen offset:256 sc1
  s_sub_u32 s34, s34, 1
  s_cbranch_scc1 L_end
  s_waitcnt vmcnt(0)
  v_bitop3_b32 v224, v216, v217, v218 bitop3:0x80
  v_bitop3_b32 v225, v219, v220, v221 bitop3:0x80
  v_bitop3_b32 v224, v224, v222, v223 bitop3:0x80
  v_bitop3_b32 v224, v224, v225, 1 bitop3:0x80
  v_cmp_eq_u32 vcc, 0, v224
  s_nop 0
  s_cbranch_vccnz L_tp_27_a
  s_mov_b64 exec, -1
  s_branch L_tpb_28
L_cp_29:
  s_mov_b32 s34, 1048576
  s_mov_b32 exec_hi, 0
L_cp_29_a:
  s_mov_b32 exec_lo, vcc_lo
  buffer_load_dword v231, v230, s[36:39], 0 offen sc1
  s_sub_u32 s34, s34, 1
  s_cbranch_scc1 L_end
  s_waitcnt vmcnt(0)
  v_cmp_gt_u32 vcc, 8, v231
  s_nop 0
  s_cbranch_vccnz L_cp_29_a
  s_mov_b64 exec, -1
  s_branch L_cpb_30
L_cp_31:
  s_mov_b32 s34, 1048576
  s_mov_b32 exec_hi, 0
L_cp_31_a:
  s_mov_b32 exec_lo, vcc_lo
  buffer_load_dword v231, v230, s[36:39], 0 offen sc1
  s_sub_u32 s34, s34, 1
  s_cbranch_scc1 L_end
  s_waitcnt vmcnt(0)
  v_cmp_gt_u32 vcc, 8, v231
  s_nop 0
  s_cbranch_vccnz L_cp_31_a
  s_mov_b64 exec, -1
  s_branch L_cpb_32
L_cp_33:
  s_mov_b32 s34, 1048576
  s_mov_b32 exec_hi, 0
L_cp_33_a:
  s_mov_b32 exec_lo, vcc_lo
  buffer_load_dword v231, v230, s[36:39], 0 offen sc1
  s_sub_u32 s34, s34, 1
  s_cbranch_scc1 L_end
  s_waitcnt vmcnt(0)
  v_cmp_gt_u32 vcc, 8, v231
  s_nop 0
  s_cbranch_vccnz L_cp_33_a
  s_mov_b64 exec, -1
  s_branch L_cpb_34
L_rc_37:
  s_mov_b32 s34, 1048576
L_rc_37_a:
  v_mov_b32 v99, 0
  buffer_load_dword v99, v99, s[96:99], 0 offen sc1
  s_waitcnt vmcnt(0)
  v_readfirstlane_b32 s80, v99
  s_nop 0
  s_cmp_lg_u32 s80, 0
  s_cbranch_scc1 L_rcb_38
  s_sub_u32 s34, s34, 1
  s_cbranch_scc0 L_rc_37_a
  s_branch L_end
L_rc_39:
  s_mov_b32 s34, 1048576
L_rc_39_a:
  v_mov_b32 v99, 0
  buffer_load_dword v99, v99, s[96:99], 0 offen sc1
  s_waitcnt vmcnt(0)
  v_readfirstlane_b32 s80, v99
  s_nop 0
  s_cmp_lg_u32 s80, 0
  s_cbranch_scc1 L_rcb_40
  s_sub_u32 s34, s34, 1
  s_cbranch_scc0 L_rc_39_a
  s_branch L_end
L_cp_44:
  s_mov_b32 s34, 1048576
  s_mov_b32 exec_hi, 0
L_cp_44_a:
  s_mov_b32 exec_lo, vcc_lo
  buffer_load_dword v123, v122, s[36:39], 0 offen sc1
  s_sub_u32 s34, s34, 1
  s_cbranch_scc1 L_end
  s_waitcnt vmcnt(0)
  v_cmp_gt_u32 vcc, 42, v123
  s_nop 0
  s_cbranch_vccnz L_cp_44_a
  s_mov_b64 exec, -1
  s_branch L_cpb_45
L_cp_46:
  s_mov_b32 s34, 1048576
  s_mov_b32 exec_hi, 0
L_cp_46_a:
  s_mov_b32 exec_lo, vcc_lo
  buffer_load_dword v123, v122, s[36:39], 0 offen sc1
  s_sub_u32 s34, s34, 1
  s_cbranch_scc1 L_end
  s_waitcnt vmcnt(0)
  v_cmp_gt_u32 vcc, 1, v123
  s_nop 0
  s_cbranch_vccnz L_cp_46_a
  s_mov_b64 exec, -1
  s_branch L_cpb_47
L_cp_49:
  s_mov_b32 s34, 1048576
  s_mov_b32 exec_hi, 0
L_cp_49_a:
  s_mov_b32 exec_lo, vcc_lo
  buffer_load_dword v123, v122, s[36:39], 0 offen sc1
  s_sub_u32 s34, s34, 1
  s_cbranch_scc1 L_end
  s_waitcnt vmcnt(0)
  v_cmp_gt_u32 vcc, 54, v123
  s_nop 0
  s_cbranch_vccnz L_cp_49_a
  s_mov_b64 exec, -1
  s_branch L_cpb_50
L_cp_51:
  s_mov_b32 s34, 1048576
  s_mov_b32 exec_hi, 0
L_cp_51_a:
  s_mov_b32 exec_lo, vcc_lo
  buffer_load_dword v231, v230, s[36:39], 0 offen sc1
  s_sub_u32 s34, s34, 1
  s_cbranch_scc1 L_end
  s_waitcnt vmcnt(0)
  v_cmp_gt_u32 vcc, 10, v231
  s_nop 0
  s_cbranch_vccnz L_cp_51_a
  s_mov_b64 exec, -1
  s_branch L_cpb_52
L_end:
s_endpgm
.section .rodata,"a"
.p2align 6
.amdhsa_kernel interleave_layers__ssm_conv_h3__geglu_ffn__prompt_kernel
  .amdhsa_next_free_vgpr 512
  .amdhsa_next_free_sgpr 102
  .amdhsa_accum_offset 256
  .amdhsa_group_segment_fixed_size 0
  .amdhsa_kernarg_size 104
  .amdhsa_user_sgpr_count 2
  .amdhsa_user_sgpr_kernarg_segment_ptr 1
  .amdhsa_system_sgpr_workgroup_id_x 1
.end_amdhsa_kernel
```
